```python
import torch

def _softmax(x, axis=-1):
    return torch.softmax(x, dim=axis)

def _gelu(x):
    return torch.nn.functional.gelu(x, approximate='tanh')

def _silu(x):
    return torch.nn.functional.silu(x)

def _sigmoid(x):
    return torch.sigmoid(x)

def _layernorm(x, axis=-1, eps=1e-05):
    m = x.mean(dim=axis, keepdim=True)
    v = x.var(dim=axis, keepdim=True, unbiased=False)
    return (x - m) / torch.sqrt(v + eps)

def _scatter_add(tgt, idx, src, axis=0):
    return tgt.clone().index_add_(axis, idx, src)

def _segment_sum(src, seg, n):
    out = torch.zeros((n,) + src.shape[1:], dtype=src.dtype)
    return out.index_add_(0, seg, src)

def _pad(x, pw):
    flat = tuple((v for pair in reversed(pw) for v in pair))
    return torch.nn.functional.pad(x, flat)
kernel_name = 'adaLN_cond__mha_block__dense_activation_relu__prompt'

def setup_inputs():

    _w = lambda a: (lambda t: t.to(torch.bfloat16) if t.is_floating_point() else t)(torch.as_tensor(a))

    def _A_setup():
        B, S, D, H = (1, 2048, 640, 32)
        return {'x': _w((lambda *s: torch.randn(*s, dtype=torch.bfloat16) * 0.05)(B, S, D)), 'wqkv': _w((lambda *s: torch.randn(*s, dtype=torch.bfloat16) * 0.05)(D, 3 * D)), 'wo': _w((lambda *s: torch.randn(*s, dtype=torch.bfloat16) * 0.05)(D, D))}
    _A_in = _A_setup()

    def _B_setup():
        B, S, D, Dff = (1, 2048, 640, 1728)
        return {'x': _w((lambda *s: torch.randn(*s, dtype=torch.bfloat16) * 0.05)(B, S, D)), 'w1': _w((lambda *s: torch.randn(*s, dtype=torch.bfloat16) * 0.05)(D, Dff)), 'w2': _w((lambda *s: torch.randn(*s, dtype=torch.bfloat16) * 0.05)(Dff, D))}
    _B_in = _B_setup()
    return {'A_x': _A_in['x'], 'A_wqkv': _A_in['wqkv'], 'A_wo': _A_in['wo'], 'B_x': _B_in['x'], 'B_w1': _B_in['w1'], 'B_w2': _B_in['w2'], 'c': _w((lambda *s: torch.randn(*s, dtype=torch.bfloat16) * 0.1)(1, 640) * 8.0), 'w_mod': _w((lambda *s: torch.randn(*s, dtype=torch.bfloat16) * 0.1)(640, 6 * 640) * 640 ** (-0.5) * 8.0)}

def reference(A_x, A_wqkv, A_wo, B_x, B_w1, B_w2, c, w_mod):

    def _A_ref(x, wqkv, wo):
        B, S, D = x.shape
        H = 32
        Dh = D // H
        qkv = (lambda x, *d: x.permute(*d))((x @ wqkv).reshape(B, S, 3, H, Dh), 2, 0, 3, 1, 4)
        q, k, v = (qkv[0], qkv[1], qkv[2])
        scores = torch.einsum('bhqd,bhkd->bhqk', q, k) * Dh ** (-0.5)
        p = _softmax(scores, axis=-1)
        o = torch.einsum('bhqk,bhkd->bhqd', p, v)
        return (lambda x, *d: x.permute(*d))(o, 0, 2, 1, 3).reshape(B, S, D) @ wo

    def _B_ref(x, w1, w2):
        h = torch.einsum('bsd,df->bsf', x, w1)
        zero = torch.zeros_like(h)
        h = torch.maximum(h, zero)
        return torch.einsum('bsf,fd->bsd', h, w2)
    x = A_x
    mod = (_silu(c) @ w_mod).reshape(c.shape[0], 6, 1, -1)
    sa, ca, ga, sb, cb, gb = (mod[:, 0].clone(), mod[:, 1].clone(), mod[:, 2].clone(), mod[:, 3].clone(), mod[:, 4].clone(), mod[:, 5].clone())
    h = _layernorm(x, axis=-1) * (1 + ca) + sa
    x = x + ga * _A_ref(h, A_wqkv, A_wo)
    h = _layernorm(x, axis=-1) * (1 + cb) + sb
    x = x + gb * _B_ref(h, B_w1, B_w2)
    return x
```

```asm
; @launch grid=(256,1,1) block=(512,1,1) lds=163840
.amdgcn_target "amdgcn-amd-amdhsa--gfx950"
.text
.globl adaLN_cond__mha_block__dense_activation_relu__prompt_kernel
.p2align 8
.type adaLN_cond__mha_block__dense_activation_relu__prompt_kernel,@function
adaLN_cond__mha_block__dense_activation_relu__prompt_kernel:
    s_load_dwordx2 s[12:13], s[0:1], 56
    s_load_dwordx2 s[16:17], s[0:1], 48
    s_load_dwordx2 s[24:25], s[0:1], 0
    s_load_dwordx2 s[20:21], s[0:1], 80
    s_getpc_b64 s[100:101]
L_pc:
    s_lshr_b32 s4, s2, 3
    s_cmp_eq_u32 s4, 1
    s_cbranch_scc0 L_p_nopf
    v_lshlrev_b32 v2, 7, v0
    v_min_u32 v2, L_att_tail-L_pc-4, v2
    global_load_dword v251, v2, s[100:101]
L_p_nopf:
    v_lshrrev_b32 v2, 6, v0
    s_cmp_ge_u32 s2, 256
    v_readfirstlane_b32 s40, v2
    s_cbranch_scc1 L_end
    s_mov_b32 s14, 4915200
    s_mov_b32 s15, 0x20000
    s_movk_i32 s18, 1280
    s_mov_b32 s19, s15
    s_mov_b32 s26, 2621440
    s_mov_b32 s27, s15
    v_and_b32 v1, 63, v0
    s_sub_u32 s4, s4, 5
    s_and_b32 s4, s4, 0xfb
    s_cmp_eq_u32 s4, 0
    s_cbranch_scc1 L_probe
L_probed:
    s_cmp_ge_u32 s40, 4
    s_cbranch_scc0 L_p_x
    s_bfe_u32 s63, s2, 0x20003
    s_lshl_b32 s63, s63, 6
    s_lshr_b32 s4, s2, 5
    s_lshl_b32 s4, s4, 3
    s_add_u32 s63, s63, s4
    s_and_b32 s4, s2, 7
    s_add_u32 s63, s63, s4
    s_xor_b32 s63, s63, 255
    s_and_b32 s4, s63, 3
    s_lshr_b32 s5, s63, 2
    s_cmp_lt_u32 s5, 30
    s_cselect_b32 s7, 0, 20
    s_cmp_lt_u32 s5, 40
    s_cselect_b32 s7, s7, -10
    s_add_u32 s5, s5, s7
    s_mul_i32 s7, s4, 15360
    s_lshl_b32 s6, s5, 8
    s_add_u32 s7, s7, s6
    s_mul_i32 s4, s4, 160
    s_sub_u32 s4, s4, 32
    v_lshrrev_b32 v2, 3, v0
    v_add_u32 v2, s4, v2
    v_and_b32 v7, 7, v0
    v_mul_u32_u24 v3, 7680, v2
    v_lshl_add_u32 v3, v7, 4, v3
    v_min_u32 v4, 4, v7
    v_lshl_add_u32 v4, v4, 5, v2
    v_lshlrev_b32 v4, 1, v4
    s_lshl_b32 s4, s5, 7
    s_waitcnt lgkmcnt(0)
    s_cmp_lt_u32 s63, 80
    s_cbranch_scc0 L_p_common
    buffer_load_ushort v30, v4, s[16:19], 0 offen
    buffer_load_dwordx4 v[96:99], v3, s[12:15], s4 offen offset:0
    s_add_u32 s4, s4, 245760
    buffer_load_dwordx4 v[100:103], v3, s[12:15], s4 offen offset:0
    s_add_u32 s4, s4, 245760
    buffer_load_dwordx4 v[104:107], v3, s[12:15], s4 offen offset:0
    s_add_u32 s4, s4, 245760
    buffer_load_dwordx4 v[108:111], v3, s[12:15], s4 offen offset:0
    s_add_u32 s4, s4, 245760
    buffer_load_dwordx4 v[112:115], v3, s[12:15], s4 offen offset:0
    s_branch L_p_common
L_p_x:
    v_lshlrev_b32 v3, 4, v1
    v_lshlrev_b32 v4, 2, v1
    s_bfe_u32 s63, s2, 0x20001
    s_lshl_b32 s63, s63, 6
    s_lshr_b32 s46, s2, 3
    s_lshl_b32 s46, s46, 1
    s_add_u32 s63, s63, s46
    s_and_b32 s46, s2, 1
    s_add_u32 s63, s63, s46
    s_lshl_b32 s46, s63, 2
    s_add_u32 s46, s46, s40
    s_mul_i32 s46, s46, 2560
    s_waitcnt lgkmcnt(0)
    buffer_load_dwordx4 v[20:23], v3, s[24:27], s46 offen
    buffer_load_dword v24, v4, s[24:27], s46 offen offset:1024
    buffer_load_dwordx4 v[26:29], v3, s[24:27], s46 offen offset:1280
    buffer_load_dword v30, v4, s[24:27], s46 offen offset:2304
L_p_common:
    s_load_dwordx2 s[32:33], s[0:1], 32
    s_load_dwordx2 s[34:35], s[0:1], 8
    s_load_dwordx2 s[36:37], s[0:1], 40
    s_load_dwordx2 s[38:39], s[0:1], 16
    s_load_dwordx2 s[28:29], s[0:1], 64
    s_mov_b32 s22, 54525952
    s_mov_b32 s23, 0x20000
    s_mov_b32 s30, 2621440
    s_mov_b32 s31, 0x20000
    s_mov_b32 s60, 81920
    buffer_load_dword v248, off, s[20:23], s60
    s_cmp_ge_u32 s40, 4
    s_cbranch_scc0 L_p_compute
    s_cmp_lt_u32 s63, 80
    s_cbranch_scc0 L_p_nocrit
    s_waitcnt vmcnt(6)
    v_lshlrev_b32 v30, 16, v30
    v_mul_f32 v31, 0xbfb8aa3b, v30
    v_exp_f32 v31, v31
    v_lshrrev_b32 v38, 4, v1
    v_add_f32 v31, 1.0, v31
    v_rcp_f32 v31, v31
    v_lshlrev_b32 v38, 3, v38
    v_mul_f32 v30, v30, v31
    v_cvt_pk_bf16_f32 v30, v30, v30
    v_lshlrev_b32 v30, 16, v30
    v_lshl_add_u32 v38, v7, 5, v38
    s_lshl_b32 s55, s40, 8
    s_add_u32 s55, s55, 151552
    v_add_u32 v38, s55, v38
    ds_swizzle_b32 v20, v30 offset:24
    ds_swizzle_b32 v22, v30 offset:56
    ds_swizzle_b32 v24, v30 offset:88
    ds_swizzle_b32 v26, v30 offset:120
    ds_swizzle_b32 v28, v30 offset:152
    s_waitcnt vmcnt(5) lgkmcnt(0)
    v_lshlrev_b32 v80, 16, v96
    v_and_b32 v81, 0xffff0000, v96
    v_lshlrev_b32 v82, 16, v97
    v_and_b32 v83, 0xffff0000, v97
    v_lshlrev_b32 v84, 16, v98
    v_and_b32 v85, 0xffff0000, v98
    v_lshlrev_b32 v86, 16, v99
    v_and_b32 v87, 0xffff0000, v99
    v_pk_mul_f32 v[40:41], v[80:81], v[20:21] op_sel_hi:[1,0]
    v_pk_mul_f32 v[42:43], v[82:83], v[20:21] op_sel_hi:[1,0]
    v_pk_mul_f32 v[44:45], v[84:85], v[20:21] op_sel_hi:[1,0]
    v_pk_mul_f32 v[46:47], v[86:87], v[20:21] op_sel_hi:[1,0]
    s_waitcnt vmcnt(4)
    v_lshlrev_b32 v80, 16, v100
    v_and_b32 v81, 0xffff0000, v100
    v_lshlrev_b32 v82, 16, v101
    v_and_b32 v83, 0xffff0000, v101
    v_lshlrev_b32 v84, 16, v102
    v_and_b32 v85, 0xffff0000, v102
    v_lshlrev_b32 v86, 16, v103
    v_and_b32 v87, 0xffff0000, v103
    v_pk_fma_f32 v[40:41], v[80:81], v[22:23], v[40:41] op_sel_hi:[1,0,1]
    v_pk_fma_f32 v[42:43], v[82:83], v[22:23], v[42:43] op_sel_hi:[1,0,1]
    v_pk_fma_f32 v[44:45], v[84:85], v[22:23], v[44:45] op_sel_hi:[1,0,1]
    v_pk_fma_f32 v[46:47], v[86:87], v[22:23], v[46:47] op_sel_hi:[1,0,1]
    s_waitcnt vmcnt(3)
    v_lshlrev_b32 v80, 16, v104
    v_and_b32 v81, 0xffff0000, v104
    v_lshlrev_b32 v82, 16, v105
    v_and_b32 v83, 0xffff0000, v105
    v_lshlrev_b32 v84, 16, v106
    v_and_b32 v85, 0xffff0000, v106
    v_lshlrev_b32 v86, 16, v107
    v_and_b32 v87, 0xffff0000, v107
    v_pk_fma_f32 v[40:41], v[80:81], v[24:25], v[40:41] op_sel_hi:[1,0,1]
    v_pk_fma_f32 v[42:43], v[82:83], v[24:25], v[42:43] op_sel_hi:[1,0,1]
    v_pk_fma_f32 v[44:45], v[84:85], v[24:25], v[44:45] op_sel_hi:[1,0,1]
    v_pk_fma_f32 v[46:47], v[86:87], v[24:25], v[46:47] op_sel_hi:[1,0,1]
    s_waitcnt vmcnt(2)
    v_lshlrev_b32 v80, 16, v108
    v_and_b32 v81, 0xffff0000, v108
    v_lshlrev_b32 v82, 16, v109
    v_and_b32 v83, 0xffff0000, v109
    v_lshlrev_b32 v84, 16, v110
    v_and_b32 v85, 0xffff0000, v110
    v_lshlrev_b32 v86, 16, v111
    v_and_b32 v87, 0xffff0000, v111
    v_pk_fma_f32 v[40:41], v[80:81], v[26:27], v[40:41] op_sel_hi:[1,0,1]
    v_pk_fma_f32 v[42:43], v[82:83], v[26:27], v[42:43] op_sel_hi:[1,0,1]
    v_pk_fma_f32 v[44:45], v[84:85], v[26:27], v[44:45] op_sel_hi:[1,0,1]
    v_pk_fma_f32 v[46:47], v[86:87], v[26:27], v[46:47] op_sel_hi:[1,0,1]
    s_waitcnt vmcnt(1)
    v_lshlrev_b32 v80, 16, v112
    v_and_b32 v81, 0xffff0000, v112
    v_lshlrev_b32 v82, 16, v113
    v_and_b32 v83, 0xffff0000, v113
    v_lshlrev_b32 v84, 16, v114
    v_and_b32 v85, 0xffff0000, v114
    v_lshlrev_b32 v86, 16, v115
    v_and_b32 v87, 0xffff0000, v115
    v_pk_fma_f32 v[40:41], v[80:81], v[28:29], v[40:41] op_sel_hi:[1,0,1]
    v_pk_fma_f32 v[42:43], v[82:83], v[28:29], v[42:43] op_sel_hi:[1,0,1]
    v_pk_fma_f32 v[44:45], v[84:85], v[28:29], v[44:45] op_sel_hi:[1,0,1]
    v_pk_fma_f32 v[46:47], v[86:87], v[28:29], v[46:47] op_sel_hi:[1,0,1]
    s_nop 0
    v_permlane32_swap_b32 v40, v44
    v_permlane32_swap_b32 v41, v45
    v_permlane32_swap_b32 v42, v46
    v_permlane32_swap_b32 v43, v47
    v_pk_add_f32 v[40:41], v[40:41], v[44:45]
    v_pk_add_f32 v[42:43], v[42:43], v[46:47]
    s_nop 1
    v_permlane16_swap_b32 v40, v42
    v_permlane16_swap_b32 v41, v43
    v_pk_add_f32 v[40:41], v[40:41], v[42:43]
    s_nop 1
    v_add_f32_dpp v40, v40, v40 row_ror:8 row_mask:0xf bank_mask:0xf
    v_add_f32_dpp v41, v41, v41 row_ror:8 row_mask:0xf bank_mask:0xf
    ds_write_b64 v38, v[40:41] offset:0
    s_waitcnt lgkmcnt(0)
    s_barrier
    s_waitcnt vmcnt(0)
    v_readfirstlane_b32 s3, v248
    s_nop 0
    s_mul_i32 s3, s3, 0x9e3779b1
    s_add_u32 s3, s3, 0x7f4a7c15
    v_mov_b32 v248, s3
    s_cmp_eq_u32 s40, 4
    s_cbranch_scc0 L_g1_nog
    v_lshlrev_b32 v32, 2, v1
    v_add_u32 v33, 152576, v32
    ds_read2st64_b32 v[40:41], v33 offset0:0 offset1:1
    ds_read2st64_b32 v[42:43], v33 offset0:2 offset1:3
    v_and_b32 v34, 3, v1
    v_lshlrev_b32 v34, 3, v34
    v_bfe_u32 v34, s3, v34, 8
    s_mov_b32 s59, 0xffffff00
    s_waitcnt lgkmcnt(0)
    v_pk_add_f32 v[40:41], v[40:41], v[42:43]
    v_add_f32 v40, v40, v41
    v_add_u32 v40, 0x80, v40
    v_and_or_b32 v40, v40, s59, v34
    buffer_store_dword v40, v32, s[20:23], s7 offen offset:0 sc0 sc1
L_g1_nog:
    s_bfe_u32 s41, s2, 0x20001
    s_lshl_b32 s41, s41, 2
    s_bfe_u32 s44, s2, 0x20003
    s_add_u32 s41, s41, s44
    s_and_b32 s42, s2, 1
    s_lshl_b32 s42, s42, 3
    s_lshr_b32 s44, s2, 5
    s_add_u32 s42, s42, s44
    s_mov_b32 s48, 1.0
    s_cmp_lt_u32 s42, 5
    s_cselect_b32 s48, 1051011932, s48
    s_cmp_eq_u32 s42, 15
    s_cselect_b32 s45, 1, 0
    s_mov_b32 s43, 3840
    s_mov_b32 s8, s34
    s_mov_b32 s9, s35
    s_mov_b32 s10, 2457600
    s_mov_b32 s11, 0x20000
    s_min_u32 s46, s42, 14
    s_lshl_b32 s46, s46, 8
    s_sub_u32 s50, s40, 4
    v_lshrrev_b32 v10, 4, v1
    s_lshl_b32 s61, s50, 4
    v_add_u32 v11, s61, v10
    v_mul_lo_u32 v11, v11, s43
    v_lshlrev_b32 v10, 2, v10
    v_xor_b32 v10, v10, v1
    v_and_b32 v10, 15, v10
    v_lshl_add_u32 v11, v10, 4, v11
    v_add_u32 v220, s46, v11
    s_lshl_b32 s50, s50, 12
    s_lshl_b32 s61, s43, 2
    s_sub_u32 s61, s61, 1024
    v_add_u32 v221, s61, v220
    v_add_u32 v222, s61, v221
    v_add_u32 v223, s61, v222
    s_lshl_b32 s51, s43, 6
    s_mov_b32 s49, 1
    s_add_u32 m0, s50, 0
    s_mul_i32 s60, s51, 0
    buffer_load_dwordx4 v220, s[8:11], s60 offen offset:0 lds
    buffer_load_dwordx4 v221, s[8:11], s60 offen offset:1024 lds
    buffer_load_dwordx4 v222, s[8:11], s60 offen offset:2048 lds
    buffer_load_dwordx4 v223, s[8:11], s60 offen offset:3072 lds
    s_add_u32 m0, s50, 16384
    s_mul_i32 s60, s51, 1
    buffer_load_dwordx4 v220, s[8:11], s60 offen offset:0 lds
    buffer_load_dwordx4 v221, s[8:11], s60 offen offset:1024 lds
    buffer_load_dwordx4 v222, s[8:11], s60 offen offset:2048 lds
    buffer_load_dwordx4 v223, s[8:11], s60 offen offset:3072 lds
    s_add_u32 m0, s50, 32768
    s_mul_i32 s60, s51, 2
    buffer_load_dwordx4 v220, s[8:11], s60 offen offset:0 lds
    buffer_load_dwordx4 v221, s[8:11], s60 offen offset:1024 lds
    buffer_load_dwordx4 v222, s[8:11], s60 offen offset:2048 lds
    buffer_load_dwordx4 v223, s[8:11], s60 offen offset:3072 lds
L_p_noearly1:
    s_waitcnt vmcnt(0)
    s_barrier
    s_branch L_q_helper
L_p_nocrit:
    s_waitcnt lgkmcnt(0)
    s_bfe_u32 s41, s2, 0x20001
    s_lshl_b32 s41, s41, 2
    s_bfe_u32 s44, s2, 0x20003
    s_add_u32 s41, s41, s44
    s_and_b32 s42, s2, 1
    s_lshl_b32 s42, s42, 3
    s_lshr_b32 s44, s2, 5
    s_add_u32 s42, s42, s44
    s_mov_b32 s48, 1.0
    s_cmp_lt_u32 s42, 5
    s_cselect_b32 s48, 1051011932, s48
    s_cmp_eq_u32 s42, 15
    s_cselect_b32 s45, 1, 0
    s_mov_b32 s43, 3840
    s_mov_b32 s8, s34
    s_mov_b32 s9, s35
    s_mov_b32 s10, 2457600
    s_mov_b32 s11, 0x20000
    s_min_u32 s46, s42, 14
    s_lshl_b32 s46, s46, 8
    s_sub_u32 s50, s40, 4
    v_lshrrev_b32 v10, 4, v1
    s_lshl_b32 s61, s50, 4
    v_add_u32 v11, s61, v10
    v_mul_lo_u32 v11, v11, s43
    v_lshlrev_b32 v10, 2, v10
    v_xor_b32 v10, v10, v1
    v_and_b32 v10, 15, v10
    v_lshl_add_u32 v11, v10, 4, v11
    v_add_u32 v220, s46, v11
    s_lshl_b32 s50, s50, 12
    s_lshl_b32 s61, s43, 2
    s_sub_u32 s61, s61, 1024
    v_add_u32 v221, s61, v220
    v_add_u32 v222, s61, v221
    v_add_u32 v223, s61, v222
    s_lshl_b32 s51, s43, 6
    s_cmp_lt_u32 s63, 160
    s_cselect_b32 s49, 2, 0
    s_add_u32 m0, s50, 0
    s_mul_i32 s60, s51, 0
    buffer_load_dwordx4 v220, s[8:11], s60 offen offset:0 lds
    buffer_load_dwordx4 v221, s[8:11], s60 offen offset:1024 lds
    buffer_load_dwordx4 v222, s[8:11], s60 offen offset:2048 lds
    buffer_load_dwordx4 v223, s[8:11], s60 offen offset:3072 lds
    s_add_u32 m0, s50, 16384
    s_mul_i32 s60, s51, 1
    buffer_load_dwordx4 v220, s[8:11], s60 offen offset:0 lds
    buffer_load_dwordx4 v221, s[8:11], s60 offen offset:1024 lds
    buffer_load_dwordx4 v222, s[8:11], s60 offen offset:2048 lds
    buffer_load_dwordx4 v223, s[8:11], s60 offen offset:3072 lds
    s_cmp_eq_u32 s49, 2
    s_cbranch_scc1 L_p_noearly2
    s_add_u32 m0, s50, 32768
    s_mul_i32 s60, s51, 2
    buffer_load_dwordx4 v220, s[8:11], s60 offen offset:0 lds
    buffer_load_dwordx4 v221, s[8:11], s60 offen offset:1024 lds
    buffer_load_dwordx4 v222, s[8:11], s60 offen offset:2048 lds
    buffer_load_dwordx4 v223, s[8:11], s60 offen offset:3072 lds
L_p_noearly2:
    s_and_b32 s52, s41, 12
    s_add_u32 s52, s52, s40
    s_sub_u32 s52, s52, 4
    s_and_b32 s53, s41, 3
    s_min_u32 s53, s53, 1
    s_lshl_b32 s53, s53, 4
    s_add_u32 s52, s52, s53
    s_mul_i32 s52, s52, 14
    s_add_u32 s52, s52, 192
    v_lshrrev_b32 v10, 1, v1
    v_min_u32 v10, 13, v10
    v_add_u32 v10, s52, v10
    v_mul_lo_u32 v10, v10, s43
    v_and_b32 v11, 1, v1
    v_lshl_add_u32 v10, v11, 7, v10
    buffer_load_dword v11, v10, s[8:11], s46 offen
    s_cmp_eq_u32 s49, 2
    s_cbranch_scc0 L_p_nojob
    buffer_load_ushort v30, v4, s[16:19], 0 offen
    buffer_load_dwordx4 v[96:99], v3, s[12:15], s4 offen offset:0
    s_add_u32 s4, s4, 245760
    buffer_load_dwordx4 v[100:103], v3, s[12:15], s4 offen offset:0
    s_add_u32 s4, s4, 245760
    buffer_load_dwordx4 v[104:107], v3, s[12:15], s4 offen offset:0
    s_add_u32 s4, s4, 245760
    buffer_load_dwordx4 v[108:111], v3, s[12:15], s4 offen offset:0
    s_add_u32 s4, s4, 245760
    buffer_load_dwordx4 v[112:115], v3, s[12:15], s4 offen offset:0
L_p_nojob:
    s_barrier
    s_waitcnt vmcnt(0)
    v_readfirstlane_b32 s3, v248
    s_nop 0
    s_mul_i32 s3, s3, 0x9e3779b1
    s_add_u32 s3, s3, 0x7f4a7c15
    v_mov_b32 v248, s3
    s_barrier
    s_branch L_q_helper
L_probe:
    s_cmp_eq_u32 s40, 7
    s_cbranch_scc0 L_probe_bar
    s_load_dwordx2 s[8:9], s[0:1], 72
    s_mov_b32 s10, 256
    s_mov_b32 s11, 0x20000
    s_mov_b32 s22, 54525952
    s_mov_b32 s23, 0x20000
    s_and_b32 s4, s2, 63
    s_lshl_b32 s4, s4, 7
    s_add_u32 s4, s4, 29884416
    s_add_u32 s5, s4, 8192
    v_lshlrev_b32 v2, 2, v1
    v_mov_b32 v3, 0
    s_getreg_b32 s3, hwreg(HW_REG_XCC_ID, 0, 3)
    s_and_b32 s6, s3, 4
    s_lshl_b32 s6, s6, 1
    s_lshl_b32 s3, s3, 24
    s_cmp_eq_u32 s2, 40
    s_cselect_b32 s3, s3, 0
    s_add_u32 s3, s3, 0x10000
    s_mov_b32 exec_hi, 0
    s_waitcnt lgkmcnt(0)
    buffer_store_dword v3, v2, s[20:23], s4 offen sc0 sc1
    buffer_store_dword v3, v2, s[20:23], s5 offen sc0 sc1
    s_waitcnt vmcnt(1)
    ds_read_b32 v4, v3
    s_waitcnt lgkmcnt(0)
    ds_read_b32 v4, v3
    s_waitcnt lgkmcnt(0)
    s_getreg_b32 s7, hwreg(HW_REG_IB_STS, 0, 1)
    s_lshl_b32 s7, s7, s6
    s_add_u32 s7, s7, s3
    v_mov_b32 v4, s7
    s_mov_b64 exec, 1
    buffer_atomic_add v4, v3, s[8:11], 0 offen sc1
    s_mov_b64 exec, -1
L_probe_bar:
    s_barrier
    s_branch L_probed
L_p_compute:
    v_mul_u32_u24 v54, 144, v1
    s_lshl_b32 s55, s40, 5
    s_add_u32 s55, s55, 131072
    v_add_u32 v54, s55, v54
    v_lshrrev_b32 v56, 2, v1
    v_mul_u32_u24 v56, 144, v56
    v_and_b32 v57, 3, v1
    v_lshl_add_u32 v56, v57, 2, v56
    v_add_u32 v56, s55, v56
    v_lshrrev_b32 v53, 5, v1
    s_lshl_b32 s55, s40, 4
    s_add_u32 s55, s55, 158720
    v_lshl_add_u32 v53, v53, 3, s55
    s_waitcnt vmcnt(3)
    ds_write_b128 v54, v[20:23] offset:0
    ds_write_b32 v56, v24 offset:9216
    v_lshlrev_b32 v64, 16, v20
    v_and_b32 v65, 0xffff0000, v20
    v_lshlrev_b32 v66, 16, v21
    v_and_b32 v67, 0xffff0000, v21
    v_lshlrev_b32 v68, 16, v22
    v_and_b32 v69, 0xffff0000, v22
    v_lshlrev_b32 v70, 16, v23
    v_and_b32 v71, 0xffff0000, v23
    v_lshlrev_b32 v72, 16, v24
    v_and_b32 v73, 0xffff0000, v24
    v_pk_add_f32 v[40:41], v[64:65], v[66:67]
    v_pk_mul_f32 v[42:43], v[64:65], v[64:65]
    v_pk_fma_f32 v[42:43], v[66:67], v[66:67], v[42:43]
    v_pk_add_f32 v[40:41], v[40:41], v[68:69]
    v_pk_fma_f32 v[42:43], v[68:69], v[68:69], v[42:43]
    v_pk_add_f32 v[40:41], v[40:41], v[70:71]
    v_pk_fma_f32 v[42:43], v[70:71], v[70:71], v[42:43]
    v_pk_add_f32 v[40:41], v[40:41], v[72:73]
    v_pk_fma_f32 v[42:43], v[72:73], v[72:73], v[42:43]
    v_add_f32 v48, v40, v41
    v_add_f32 v49, v42, v43
    s_waitcnt vmcnt(1)
    ds_write_b128 v54, v[26:29] offset:16
    ds_write_b32 v56, v30 offset:9232
    v_lshlrev_b32 v74, 16, v26
    v_and_b32 v75, 0xffff0000, v26
    v_lshlrev_b32 v76, 16, v27
    v_and_b32 v77, 0xffff0000, v27
    v_lshlrev_b32 v78, 16, v28
    v_and_b32 v79, 0xffff0000, v28
    v_lshlrev_b32 v80, 16, v29
    v_and_b32 v81, 0xffff0000, v29
    v_lshlrev_b32 v82, 16, v30
    v_and_b32 v83, 0xffff0000, v30
    v_pk_add_f32 v[44:45], v[74:75], v[76:77]
    v_pk_mul_f32 v[46:47], v[74:75], v[74:75]
    v_pk_fma_f32 v[46:47], v[76:77], v[76:77], v[46:47]
    v_pk_add_f32 v[44:45], v[44:45], v[78:79]
    v_pk_fma_f32 v[46:47], v[78:79], v[78:79], v[46:47]
    v_pk_add_f32 v[44:45], v[44:45], v[80:81]
    v_pk_fma_f32 v[46:47], v[80:81], v[80:81], v[46:47]
    v_pk_add_f32 v[44:45], v[44:45], v[82:83]
    v_pk_fma_f32 v[46:47], v[82:83], v[82:83], v[46:47]
    v_add_f32 v50, v44, v45
    v_add_f32 v51, v46, v47
    s_nop 0
    v_permlane32_swap_b32 v48, v50
    v_permlane32_swap_b32 v49, v51
    v_pk_add_f32 v[48:49], v[48:49], v[50:51]
    v_mov_b64 v[50:51], v[48:49]
    s_nop 1
    v_permlane16_swap_b32 v48, v50
    v_permlane16_swap_b32 v49, v51
    v_pk_add_f32 v[48:49], v[48:49], v[50:51]
    s_nop 0
    s_nop 0
    v_add_f32_dpp v48, v48, v48 quad_perm:[1,0,3,2] row_mask:0xf bank_mask:0xf
    v_add_f32_dpp v49, v49, v49 quad_perm:[1,0,3,2] row_mask:0xf bank_mask:0xf
    s_nop 0
    v_add_f32_dpp v48, v48, v48 quad_perm:[2,3,0,1] row_mask:0xf bank_mask:0xf
    v_add_f32_dpp v49, v49, v49 quad_perm:[2,3,0,1] row_mask:0xf bank_mask:0xf
    s_nop 0
    v_add_f32_dpp v48, v48, v48 row_half_mirror row_mask:0xf bank_mask:0xf
    v_add_f32_dpp v49, v49, v49 row_half_mirror row_mask:0xf bank_mask:0xf
    s_nop 0
    v_add_f32_dpp v48, v48, v48 row_mirror row_mask:0xf bank_mask:0xf
    v_add_f32_dpp v49, v49, v49 row_mirror row_mask:0xf bank_mask:0xf
    v_mul_f32 v48, 0x3acccccd, v48
    v_mul_f32 v49, 0x3acccccd, v49
    v_fma_f32 v49, -v48, v48, v49
    v_max_f32 v49, 0, v49
    v_add_f32 v49, 0x3727c5ac, v49
    v_rsq_f32 v49, v49
    v_and_b32 v7, 7, v0
    v_mul_f32 v48, -v48, v49
    ds_write_b64 v53, v[48:49]
    v_lshrrev_b32 v57, 3, v0
    v_mul_u32_u24 v58, 144, v57
    v_lshl_add_u32 v58, v7, 4, v58
    v_add_u32 v58, 131072, v58
    v_lshlrev_b32 v53, 3, v7
    v_add_u32 v53, 158720, v53
    s_waitcnt lgkmcnt(0)
    s_barrier
    ds_read_b64 v[48:49], v53
    ds_read_b128 v[20:23], v58
    ds_read_b128 v[24:27], v58 offset:4608
    ds_read_b128 v[28:31], v58 offset:9216
    v_lshlrev_b32 v122, 5, v57
    v_add_u32 v122, 147456, v122
    v_and_b32 v120, 16, v57
    v_add_u32 v57, v57, v120
    v_lshlrev_b32 v57, 9, v57
    v_lshl_add_u32 v120, v7, 4, v57
    v_and_b32 v121, 0x80, v0
    v_lshl_or_b32 v121, v121, 23, v120
    s_waitcnt lgkmcnt(2)
    v_lshlrev_b32 v96, 16, v20
    v_and_b32 v97, 0xffff0000, v20
    v_lshlrev_b32 v98, 16, v21
    v_and_b32 v99, 0xffff0000, v21
    v_lshlrev_b32 v100, 16, v22
    v_and_b32 v101, 0xffff0000, v22
    v_lshlrev_b32 v102, 16, v23
    v_and_b32 v103, 0xffff0000, v23
    v_pk_fma_f32 v[96:97], v[96:97], v[48:49], v[48:49] op_sel:[0,1,0] op_sel_hi:[1,1,0]
    v_pk_fma_f32 v[98:99], v[98:99], v[48:49], v[48:49] op_sel:[0,1,0] op_sel_hi:[1,1,0]
    v_pk_fma_f32 v[100:101], v[100:101], v[48:49], v[48:49] op_sel:[0,1,0] op_sel_hi:[1,1,0]
    v_pk_fma_f32 v[102:103], v[102:103], v[48:49], v[48:49] op_sel:[0,1,0] op_sel_hi:[1,1,0]
    s_waitcnt lgkmcnt(1)
    v_lshlrev_b32 v104, 16, v24
    v_and_b32 v105, 0xffff0000, v24
    v_lshlrev_b32 v106, 16, v25
    v_and_b32 v107, 0xffff0000, v25
    v_lshlrev_b32 v108, 16, v26
    v_and_b32 v109, 0xffff0000, v26
    v_lshlrev_b32 v110, 16, v27
    v_and_b32 v111, 0xffff0000, v27
    v_pk_fma_f32 v[104:105], v[104:105], v[48:49], v[48:49] op_sel:[0,1,0] op_sel_hi:[1,1,0]
    v_pk_fma_f32 v[106:107], v[106:107], v[48:49], v[48:49] op_sel:[0,1,0] op_sel_hi:[1,1,0]
    v_pk_fma_f32 v[108:109], v[108:109], v[48:49], v[48:49] op_sel:[0,1,0] op_sel_hi:[1,1,0]
    v_pk_fma_f32 v[110:111], v[110:111], v[48:49], v[48:49] op_sel:[0,1,0] op_sel_hi:[1,1,0]
    s_waitcnt lgkmcnt(0)
    v_lshlrev_b32 v112, 16, v28
    v_and_b32 v113, 0xffff0000, v28
    v_lshlrev_b32 v114, 16, v29
    v_and_b32 v115, 0xffff0000, v29
    v_lshlrev_b32 v116, 16, v30
    v_and_b32 v117, 0xffff0000, v30
    v_lshlrev_b32 v118, 16, v31
    v_and_b32 v119, 0xffff0000, v31
    v_pk_fma_f32 v[112:113], v[112:113], v[48:49], v[48:49] op_sel:[0,1,0] op_sel_hi:[1,1,0]
    v_pk_fma_f32 v[114:115], v[114:115], v[48:49], v[48:49] op_sel:[0,1,0] op_sel_hi:[1,1,0]
    v_pk_fma_f32 v[116:117], v[116:117], v[48:49], v[48:49] op_sel:[0,1,0] op_sel_hi:[1,1,0]
    v_pk_fma_f32 v[118:119], v[118:119], v[48:49], v[48:49] op_sel:[0,1,0] op_sel_hi:[1,1,0]
    s_waitcnt vmcnt(0)
    v_readfirstlane_b32 s3, v248
    s_nop 0
    s_mul_i32 s3, s3, 0x9e3779b1
    s_add_u32 s3, s3, 0x7f4a7c15
    v_mov_b32 v248, s3
    s_bfe_u32 s41, s2, 0x20001
    s_lshl_b32 s41, s41, 2
    s_bfe_u32 s44, s2, 0x20003
    s_add_u32 s41, s41, s44
    s_and_b32 s42, s2, 1
    s_lshl_b32 s42, s42, 3
    s_lshr_b32 s44, s2, 5
    s_add_u32 s42, s42, s44
    s_mov_b32 s48, 1.0
    s_cmp_lt_u32 s42, 5
    s_cselect_b32 s48, 1051011932, s48
    s_cmp_eq_u32 s42, 15
    s_cselect_b32 s45, 1, 0
    s_mov_b32 s43, 3840
    s_mov_b32 s8, s34
    s_mov_b32 s9, s35
    s_mov_b32 s10, 2457600
    s_mov_b32 s11, 0x20000
    s_min_u32 s46, s42, 14
    s_lshl_b32 s46, s46, 8
    v_mov_b32 v239, 0x40000000
    v_mov_b32 v240, 0x40000000
    v_mov_b32 v241, 0x40000000
    v_mov_b32 v242, 0x40000000
    v_mov_b32 v243, 0x40000000
    v_mov_b32 v244, 0x40000000
    s_load_dwordx2 s[8:9], s[0:1], 72
    s_mov_b32 s10, 256
    s_mov_b32 s11, 0x20000
    s_waitcnt lgkmcnt(0)
    s_barrier
    s_cmp_eq_u32 s40, 3
    s_cbranch_scc0 L_q_tab
    s_mov_b32 s62, 0
L_pol:
    buffer_load_dword v2, off, s[8:11], 0 sc0 sc1
    s_cmp_eq_u32 s62, 0
    s_cbranch_scc0 L_pcue
    s_barrier
L_pcue:
    s_add_u32 s62, s62, 1
    s_waitcnt vmcnt(0)
    v_bfe_u32 v3, v2, 16, 8
    v_cmp_gt_u32 vcc, 16, v3
    s_cmp_gt_u32 s62, 400000
    s_cbranch_scc1 L_pol_done
    s_cbranch_vccz L_pol_done
    s_sleep 2
    s_branch L_pol
L_pol_done:
    v_and_b32 v3, 0xff, v2
    v_lshrrev_b32 v12, 24, v2
    v_bfe_u32 v2, v2, 8, 8
    v_cmp_gt_u32 vcc, v2, v3
    v_mov_b32 v2, 8192
    v_mov_b32 v3, 0
    v_cndmask_b32 v2, v3, v2, vcc
    v_or_b32 v2, v2, v12
    v_mov_b32 v3, 158784
    ds_write_b32 v3, v2
    s_branch L_q_notab
L_q_tab:
    v_subrev_u32 v2, 0, v0
    v_min_u32 v2, 159, v2
    v_lshlrev_b32 v3, 4, v2
    v_lshlrev_b32 v2, 4, v2
    v_add_u32 v3, 147456, v3
    s_and_b32 s4, s3, 0xff
    s_bfe_u32 s5, s3, 0x80008
    s_bfe_u32 s6, s3, 0x80010
    s_lshr_b32 s7, s3, 24
    s_mov_b32 s62, 0
L_gathera:
    s_mov_b32 s61, 0
    buffer_load_dwordx4 v[16:19], v2, s[20:23], s61 offen sc0 sc1
    s_mov_b32 s61, 15360
    buffer_load_dwordx4 v[20:23], v2, s[20:23], s61 offen sc0 sc1
    s_mov_b32 s61, 30720
    buffer_load_dwordx4 v[24:27], v2, s[20:23], s61 offen sc0 sc1
    s_mov_b32 s61, 46080
    buffer_load_dwordx4 v[28:31], v2, s[20:23], s61 offen sc0 sc1
    s_mov_b32 s61, 2560
    buffer_load_dwordx4 v[32:35], v2, s[20:23], s61 offen sc0 sc1
    s_mov_b32 s61, 17920
    buffer_load_dwordx4 v[36:39], v2, s[20:23], s61 offen sc0 sc1
    s_mov_b32 s61, 33280
    buffer_load_dwordx4 v[40:43], v2, s[20:23], s61 offen sc0 sc1
    s_mov_b32 s61, 48640
    buffer_load_dwordx4 v[44:47], v2, s[20:23], s61 offen sc0 sc1
    s_cmp_eq_u32 s62, 0
    s_cbranch_scc0 L_gcuea
    s_barrier
L_gcuea:
    s_add_u32 s62, s62, 1
    s_waitcnt vmcnt(7)
    v_xor_b32 v16, s4, v16
    v_xor_b32 v17, s5, v17
    v_xor_b32 v18, s6, v18
    v_xor_b32 v19, s7, v19
    v_or3_b32 v10, v16, v17, 0
    v_or3_b32 v10, v18, v19, v10
    s_waitcnt vmcnt(6)
    v_xor_b32 v20, s4, v20
    v_xor_b32 v21, s5, v21
    v_xor_b32 v22, s6, v22
    v_xor_b32 v23, s7, v23
    v_or3_b32 v10, v20, v21, v10
    v_or3_b32 v10, v22, v23, v10
    s_waitcnt vmcnt(5)
    v_xor_b32 v24, s4, v24
    v_xor_b32 v25, s5, v25
    v_xor_b32 v26, s6, v26
    v_xor_b32 v27, s7, v27
    v_or3_b32 v10, v24, v25, v10
    v_or3_b32 v10, v26, v27, v10
    s_waitcnt vmcnt(4)
    v_xor_b32 v28, s4, v28
    v_xor_b32 v29, s5, v29
    v_xor_b32 v30, s6, v30
    v_xor_b32 v31, s7, v31
    v_or3_b32 v10, v28, v29, v10
    v_or3_b32 v10, v30, v31, v10
    s_waitcnt vmcnt(3)
    v_xor_b32 v32, s4, v32
    v_xor_b32 v33, s5, v33
    v_xor_b32 v34, s6, v34
    v_xor_b32 v35, s7, v35
    v_or3_b32 v10, v32, v33, v10
    v_or3_b32 v10, v34, v35, v10
    s_waitcnt vmcnt(2)
    v_xor_b32 v36, s4, v36
    v_xor_b32 v37, s5, v37
    v_xor_b32 v38, s6, v38
    v_xor_b32 v39, s7, v39
    v_or3_b32 v10, v36, v37, v10
    v_or3_b32 v10, v38, v39, v10
    s_waitcnt vmcnt(1)
    v_xor_b32 v40, s4, v40
    v_xor_b32 v41, s5, v41
    v_xor_b32 v42, s6, v42
    v_xor_b32 v43, s7, v43
    v_or3_b32 v10, v40, v41, v10
    v_or3_b32 v10, v42, v43, v10
    s_waitcnt vmcnt(0)
    v_xor_b32 v44, s4, v44
    v_xor_b32 v45, s5, v45
    v_xor_b32 v46, s6, v46
    v_xor_b32 v47, s7, v47
    v_or3_b32 v10, v44, v45, v10
    v_or3_b32 v10, v46, v47, v10
    v_and_b32 v10, 0xff, v10
    v_cmp_ne_u32 vcc, 0, v10
    s_cmp_gt_u32 s62, 400000
    s_cbranch_scc1 L_gathera_done
    s_cbranch_vccz L_gathera_done
    s_sleep 6
    s_branch L_gathera
L_gathera_done:
    v_pk_add_f32 v[16:17], v[16:17], v[20:21]
    v_pk_add_f32 v[24:25], v[24:25], v[28:29]
    v_pk_add_f32 v[18:19], v[18:19], v[22:23]
    v_pk_add_f32 v[26:27], v[26:27], v[30:31]
    v_pk_add_f32 v[16:17], v[16:17], v[24:25]
    v_pk_add_f32 v[18:19], v[18:19], v[26:27]
    v_cvt_pk_bf16_f32 v20, v16, v17
    v_cvt_pk_bf16_f32 v21, v18, v19
    v_lshlrev_b32 v16, 16, v20
    v_and_b32 v17, 0xffff0000, v20
    v_lshlrev_b32 v18, 16, v21
    v_and_b32 v19, 0xffff0000, v21
    ds_write_b128 v3, v[16:19] offset:2560
    v_pk_add_f32 v[32:33], v[32:33], v[36:37]
    v_pk_add_f32 v[40:41], v[40:41], v[44:45]
    v_pk_add_f32 v[34:35], v[34:35], v[38:39]
    v_pk_add_f32 v[42:43], v[42:43], v[46:47]
    v_pk_add_f32 v[32:33], v[32:33], v[40:41]
    v_pk_add_f32 v[34:35], v[34:35], v[42:43]
    v_cvt_pk_bf16_f32 v36, v32, v33
    v_cvt_pk_bf16_f32 v37, v34, v35
    v_lshlrev_b32 v32, 16, v36
    v_and_b32 v33, 0xffff0000, v36
    v_lshlrev_b32 v34, 16, v37
    v_and_b32 v35, 0xffff0000, v37
    v_add_f32 v32, 1.0, v32
    v_add_f32 v33, 1.0, v33
    v_add_f32 v34, 1.0, v34
    v_add_f32 v35, 1.0, v35
    v_cvt_pk_bf16_f32 v36, v32, v33
    v_cvt_pk_bf16_f32 v37, v34, v35
    v_lshlrev_b32 v32, 16, v36
    v_and_b32 v33, 0xffff0000, v36
    v_lshlrev_b32 v34, 16, v37
    v_and_b32 v35, 0xffff0000, v37
    ds_write_b128 v3, v[32:35] offset:0
L_q_notab:
    s_waitcnt lgkmcnt(0)
    s_barrier
    v_mov_b32 v10, 158784
    ds_read_b32 v10, v10
    ds_read_b128 v[16:19], v122 offset:0
    ds_read_b128 v[24:27], v122 offset:2560
    ds_read_b128 v[20:23], v122 offset:16
    ds_read_b128 v[28:31], v122 offset:2576
    ds_read_b128 v[32:35], v122 offset:1024
    ds_read_b128 v[40:43], v122 offset:3584
    ds_read_b128 v[36:39], v122 offset:1040
    ds_read_b128 v[44:47], v122 offset:3600
    ds_read_b128 v[48:51], v122 offset:2048
    ds_read_b128 v[56:59], v122 offset:4608
    ds_read_b128 v[52:55], v122 offset:2064
    ds_read_b128 v[60:63], v122 offset:4624
    s_waitcnt lgkmcnt(12)
    v_readfirstlane_b32 s99, v10
    s_mov_b32 s47, s41
    s_add_u32 s60, s2, s99
    s_and_b32 s60, s60, 6
    s_and_b32 s2, s2, 0xf9
    s_or_b32 s2, s2, s60
    s_and_b32 s99, s99, 8192
    s_lshl_b32 s60, s60, 1
    s_and_b32 s41, s41, 3
    s_add_u32 s41, s41, s60
    s_lshr_b32 s57, s63, 2
    s_and_b32 s56, s57, 15
    s_mul_i32 s56, s56, 81920
    s_bfe_u32 s60, s57, 65540
    s_lshl_b32 s60, s60, 21
    s_add_u32 s56, s56, s60
    s_lshl_b32 s60, s57, 1
    s_xor_b32 s60, s60, s57
    s_and_b32 s60, s60, 32
    s_lshl_b32 s60, s60, 8
    s_xor_b32 s60, s60, s99
    s_add_u32 s56, s56, s60
    s_add_u32 s56, s56, 33554432
    s_and_b32 s57, s63, 3
    s_lshl_b32 s57, s57, 7
    s_add_u32 s56, s56, s57
    s_add_u32 s57, s56, 32768
    s_add_u32 s58, s56, 65536
    s_waitcnt lgkmcnt(8)
    v_pk_fma_f32 v[96:97], v[96:97], v[16:17], v[24:25]
    v_pk_fma_f32 v[98:99], v[98:99], v[18:19], v[26:27]
    v_pk_fma_f32 v[100:101], v[100:101], v[20:21], v[28:29]
    v_pk_fma_f32 v[102:103], v[102:103], v[22:23], v[30:31]
    v_cvt_pk_bf16_f32 v64, v96, v97
    v_cvt_pk_bf16_f32 v65, v98, v99
    v_cvt_pk_bf16_f32 v66, v100, v101
    v_cvt_pk_bf16_f32 v67, v102, v103
    buffer_store_dwordx4 v[64:67], v120, s[20:23], s56 offen sc0 sc1
    s_waitcnt lgkmcnt(4)
    v_pk_fma_f32 v[104:105], v[104:105], v[32:33], v[40:41]
    v_pk_fma_f32 v[106:107], v[106:107], v[34:35], v[42:43]
    v_pk_fma_f32 v[108:109], v[108:109], v[36:37], v[44:45]
    v_pk_fma_f32 v[110:111], v[110:111], v[38:39], v[46:47]
    v_cvt_pk_bf16_f32 v68, v104, v105
    v_cvt_pk_bf16_f32 v69, v106, v107
    v_cvt_pk_bf16_f32 v70, v108, v109
    v_cvt_pk_bf16_f32 v71, v110, v111
    buffer_store_dwordx4 v[68:71], v120, s[20:23], s57 offen sc0 sc1
    s_waitcnt lgkmcnt(0)
    v_pk_fma_f32 v[112:113], v[112:113], v[48:49], v[56:57]
    v_pk_fma_f32 v[114:115], v[114:115], v[50:51], v[58:59]
    v_pk_fma_f32 v[116:117], v[116:117], v[52:53], v[60:61]
    v_pk_fma_f32 v[118:119], v[118:119], v[54:55], v[62:63]
    v_cvt_pk_bf16_f32 v72, v112, v113
    v_cvt_pk_bf16_f32 v73, v114, v115
    v_cvt_pk_bf16_f32 v74, v116, v117
    v_cvt_pk_bf16_f32 v75, v118, v119
    buffer_store_dwordx4 v[72:75], v121, s[20:23], s58 offen sc0 sc1
    s_lshr_b32 s58, s63, 4
    s_and_b32 s60, s58, 3
    s_lshl_b32 s60, s60, 11
    s_and_b32 s59, s58, 4
    s_lshl_b32 s59, s59, 12
    s_add_u32 s60, s60, s59
    s_and_b32 s59, s58, 8
    s_lshl_b32 s59, s59, 10
    s_add_u32 s60, s60, s59
    s_xor_b32 s60, s60, s99
    s_add_u32 s60, s60, 29360128
    s_and_b32 s59, s63, 15
    s_lshl_b32 s59, s59, 7
    s_add_u32 s60, s60, s59
    v_lshl_add_u32 v249, v1, 2, s60
    s_and_b32 s60, s41, 3
    s_lshl_b32 s60, s60, 11
    s_and_b32 s59, s41, 4
    s_lshl_b32 s59, s59, 12
    s_add_u32 s60, s60, s59
    s_and_b32 s59, s41, 8
    s_lshl_b32 s59, s59, 10
    s_add_u32 s60, s60, s59
    s_xor_b32 s60, s60, s99
    s_add_u32 s60, s60, 29360128
    v_min_u32 v250, 15, v1
    v_lshl_add_u32 v250, v250, 7, s60
    v_bfe_u32 v10, v1, 2, 2
    v_lshrrev_b32 v11, 5, v1
    v_lshl_add_u32 v11, v11, 3, v10
    v_lshlrev_b32 v11, 8, v11
    v_bfe_u32 v12, v1, 4, 1
    v_lshl_add_u32 v11, v12, 5, v11
    v_and_b32 v12, 3, v1
    v_lshl_add_u32 v11, v12, 3, v11
    v_xor_b32 v12, 0, v10
    v_lshl_add_u32 v4, v12, 6, v11
    v_xor_b32 v12, 1, v10
    v_lshl_add_u32 v5, v12, 6, v11
    v_xor_b32 v12, 2, v10
    v_lshl_add_u32 v6, v12, 6, v11
    v_xor_b32 v12, 3, v10
    v_lshl_add_u32 v7, v12, 6, v11
    s_waitcnt vmcnt(0)
    s_barrier
    s_cmp_eq_u32 s40, 3
    s_cbranch_scc0 L_ho_xh_a
    s_mov_b32 exec_hi, 0
    buffer_store_dword v248, v249, s[20:23], 0 offen sc0 sc1
    s_mov_b64 exec, -1
L_ho_xh_a:
    s_cmp_eq_u32 s45, 1
    s_cbranch_scc1 L_q_side
    s_lshl_b32 s52, s41, 2
    s_add_u32 s52, s52, s40
    v_lshlrev_b32 v9, 4, v1
    s_and_b32 s57, s52, 15
    s_mul_i32 s57, s57, 81920
    s_bfe_u32 s60, s52, 65540
    s_lshl_b32 s60, s60, 21
    s_add_u32 s57, s57, s60
    s_lshl_b32 s60, s52, 1
    s_xor_b32 s60, s60, s52
    s_and_b32 s60, s60, 32
    s_lshl_b32 s60, s60, 8
    s_xor_b32 s60, s60, s99
    s_add_u32 s57, s57, s60
    s_add_u32 s57, s57, 33554432
    s_and_b32 s55, s52, 7
    s_mul_i32 s55, s55, 262144
    s_bfe_u32 s60, s52, 131075
    s_lshl_b32 s60, s60, 21
    s_add_u32 s55, s55, s60
    s_lshl_b32 s60, s52, 2
    s_xor_b32 s60, s60, s52
    s_and_b32 s60, s60, 32
    s_lshl_b32 s60, s60, 8
    s_xor_b32 s60, s60, s99
    s_add_u32 s55, s55, s60
    s_add_u32 s55, s55, 4194304
    s_lshl_b32 s56, s42, 14
    s_add_u32 s55, s55, s56
    s_add_u32 s56, s55, 4096
    s_cmp_eq_u32 s40, 3
    s_cbranch_scc0 L_ho_xh_done
    s_mov_b32 s62, 0
    s_waitcnt vmcnt(0)
L_ho_xh:
    buffer_load_dword v251, v250, s[20:23], 0 offen sc0 sc1
    s_add_u32 s62, s62, 1
    s_waitcnt vmcnt(0)
L_ho_xh_chk:
    v_cmp_ne_u32 vcc, s3, v251
    s_cmp_gt_u32 s62, 400000
    s_cbranch_scc1 L_ho_xh_done
    s_cbranch_vccz L_ho_xh_done
    s_branch L_ho_xh
L_ho_xh_done:
    s_cmp_ge_u32 s42, 10
    s_cbranch_scc1 L_q_vloop
    s_barrier
    buffer_load_dwordx4 v[128:131], v9, s[20:23], s57 offen offset:0 sc1
    buffer_load_dwordx4 v[132:135], v9, s[20:23], s57 offen offset:1024 sc1
    ds_read_b64_tr_b16 v[80:81], v4 offset:0
    ds_read_b64_tr_b16 v[82:83], v4 offset:1024
    ds_read_b64_tr_b16 v[84:85], v5 offset:0
    ds_read_b64_tr_b16 v[86:87], v5 offset:1024
    ds_read_b64_tr_b16 v[88:89], v6 offset:0
    ds_read_b64_tr_b16 v[90:91], v6 offset:1024
    ds_read_b64_tr_b16 v[92:93], v7 offset:0
    ds_read_b64_tr_b16 v[94:95], v7 offset:1024
    ds_read_b64_tr_b16 v[96:97], v4 offset:4096
    ds_read_b64_tr_b16 v[98:99], v4 offset:5120
    ds_read_b64_tr_b16 v[100:101], v5 offset:4096
    ds_read_b64_tr_b16 v[102:103], v5 offset:5120
    ds_read_b64_tr_b16 v[104:105], v6 offset:4096
    ds_read_b64_tr_b16 v[106:107], v6 offset:5120
    ds_read_b64_tr_b16 v[108:109], v7 offset:4096
    ds_read_b64_tr_b16 v[110:111], v7 offset:5120
    buffer_load_dwordx4 v[136:139], v9, s[20:23], s57 offen offset:2048 sc1
    buffer_load_dwordx4 v[140:143], v9, s[20:23], s57 offen offset:3072 sc1
    s_add_u32 s57, s57, 4096
    buffer_load_dwordx4 v[144:147], v9, s[20:23], s57 offen offset:0 sc1
    buffer_load_dwordx4 v[148:151], v9, s[20:23], s57 offen offset:1024 sc1
    buffer_load_dwordx4 v[152:155], v9, s[20:23], s57 offen offset:2048 sc1
    buffer_load_dwordx4 v[156:159], v9, s[20:23], s57 offen offset:3072 sc1
    s_waitcnt vmcnt(7) lgkmcnt(8)
    v_mfma_f32_32x32x16_bf16 v[16:31], v[80:83], v[128:131], 0
    ds_read_b64_tr_b16 v[80:81], v4 offset:8192
    ds_read_b64_tr_b16 v[82:83], v4 offset:9216
    v_mfma_f32_32x32x16_bf16 v[32:47], v[84:87], v[128:131], 0
    ds_read_b64_tr_b16 v[84:85], v5 offset:8192
    ds_read_b64_tr_b16 v[86:87], v5 offset:9216
    v_mfma_f32_32x32x16_bf16 v[48:63], v[88:91], v[128:131], 0
    ds_read_b64_tr_b16 v[88:89], v6 offset:8192
    ds_read_b64_tr_b16 v[90:91], v6 offset:9216
    v_mfma_f32_32x32x16_bf16 v[64:79], v[92:95], v[128:131], 0
    ds_read_b64_tr_b16 v[92:93], v7 offset:8192
    ds_read_b64_tr_b16 v[94:95], v7 offset:9216
    s_add_u32 s57, s57, 12288
    buffer_load_dwordx4 v[160:163], v9, s[20:23], s57 offen offset:0 sc1
    s_waitcnt vmcnt(7) lgkmcnt(8)
    v_mfma_f32_32x32x16_bf16 v[16:31], v[96:99], v[132:135], v[16:31]
    ds_read_b64_tr_b16 v[96:97], v4 offset:12288
    ds_read_b64_tr_b16 v[98:99], v4 offset:13312
    v_mfma_f32_32x32x16_bf16 v[32:47], v[100:103], v[132:135], v[32:47]
    ds_read_b64_tr_b16 v[100:101], v5 offset:12288
    ds_read_b64_tr_b16 v[102:103], v5 offset:13312
    v_mfma_f32_32x32x16_bf16 v[48:63], v[104:107], v[132:135], v[48:63]
    ds_read_b64_tr_b16 v[104:105], v6 offset:12288
    ds_read_b64_tr_b16 v[106:107], v6 offset:13312
    v_mfma_f32_32x32x16_bf16 v[64:79], v[108:111], v[132:135], v[64:79]
    ds_read_b64_tr_b16 v[108:109], v7 offset:12288
    ds_read_b64_tr_b16 v[110:111], v7 offset:13312
    buffer_load_dwordx4 v[164:167], v9, s[20:23], s57 offen offset:1024 sc1
    s_waitcnt vmcnt(7) lgkmcnt(8)
    v_mfma_f32_32x32x16_bf16 v[16:31], v[80:83], v[136:139], v[16:31]
    ds_read_b64_tr_b16 v[80:81], v4 offset:16384
    ds_read_b64_tr_b16 v[82:83], v4 offset:17408
    v_mfma_f32_32x32x16_bf16 v[32:47], v[84:87], v[136:139], v[32:47]
    ds_read_b64_tr_b16 v[84:85], v5 offset:16384
    ds_read_b64_tr_b16 v[86:87], v5 offset:17408
    v_mfma_f32_32x32x16_bf16 v[48:63], v[88:91], v[136:139], v[48:63]
    ds_read_b64_tr_b16 v[88:89], v6 offset:16384
    ds_read_b64_tr_b16 v[90:91], v6 offset:17408
    v_mfma_f32_32x32x16_bf16 v[64:79], v[92:95], v[136:139], v[64:79]
    ds_read_b64_tr_b16 v[92:93], v7 offset:16384
    ds_read_b64_tr_b16 v[94:95], v7 offset:17408
    buffer_load_dwordx4 v[168:171], v9, s[20:23], s57 offen offset:2048 sc1
    s_waitcnt vmcnt(7) lgkmcnt(8)
    v_mfma_f32_32x32x16_bf16 v[16:31], v[96:99], v[140:143], v[16:31]
    ds_read_b64_tr_b16 v[96:97], v4 offset:20480
    ds_read_b64_tr_b16 v[98:99], v4 offset:21504
    v_mfma_f32_32x32x16_bf16 v[32:47], v[100:103], v[140:143], v[32:47]
    ds_read_b64_tr_b16 v[100:101], v5 offset:20480
    ds_read_b64_tr_b16 v[102:103], v5 offset:21504
    v_mfma_f32_32x32x16_bf16 v[48:63], v[104:107], v[140:143], v[48:63]
    ds_read_b64_tr_b16 v[104:105], v6 offset:20480
    ds_read_b64_tr_b16 v[106:107], v6 offset:21504
    v_mfma_f32_32x32x16_bf16 v[64:79], v[108:111], v[140:143], v[64:79]
    ds_read_b64_tr_b16 v[108:109], v7 offset:20480
    ds_read_b64_tr_b16 v[110:111], v7 offset:21504
    buffer_load_dwordx4 v[172:175], v9, s[20:23], s57 offen offset:3072 sc1
    s_waitcnt vmcnt(7) lgkmcnt(8)
    v_mfma_f32_32x32x16_bf16 v[16:31], v[80:83], v[144:147], v[16:31]
    ds_read_b64_tr_b16 v[80:81], v4 offset:24576
    ds_read_b64_tr_b16 v[82:83], v4 offset:25600
    v_mfma_f32_32x32x16_bf16 v[32:47], v[84:87], v[144:147], v[32:47]
    ds_read_b64_tr_b16 v[84:85], v5 offset:24576
    ds_read_b64_tr_b16 v[86:87], v5 offset:25600
    s_add_u32 s57, s57, 4096
    buffer_load_dwordx4 v[176:179], v9, s[20:23], s57 offen offset:0 sc1
    v_mfma_f32_32x32x16_bf16 v[48:63], v[88:91], v[144:147], v[48:63]
    ds_read_b64_tr_b16 v[88:89], v6 offset:24576
    ds_read_b64_tr_b16 v[90:91], v6 offset:25600
    v_mfma_f32_32x32x16_bf16 v[64:79], v[92:95], v[144:147], v[64:79]
    ds_read_b64_tr_b16 v[92:93], v7 offset:24576
    ds_read_b64_tr_b16 v[94:95], v7 offset:25600
    buffer_load_dwordx4 v[180:183], v9, s[20:23], s57 offen offset:1024 sc1
    s_waitcnt vmcnt(8) lgkmcnt(8)
    v_mfma_f32_32x32x16_bf16 v[16:31], v[96:99], v[148:151], v[16:31]
    ds_read_b64_tr_b16 v[96:97], v4 offset:28672
    ds_read_b64_tr_b16 v[98:99], v4 offset:29696
    v_mfma_f32_32x32x16_bf16 v[32:47], v[100:103], v[148:151], v[32:47]
    ds_read_b64_tr_b16 v[100:101], v5 offset:28672
    ds_read_b64_tr_b16 v[102:103], v5 offset:29696
    v_mfma_f32_32x32x16_bf16 v[48:63], v[104:107], v[148:151], v[48:63]
    ds_read_b64_tr_b16 v[104:105], v6 offset:28672
    ds_read_b64_tr_b16 v[106:107], v6 offset:29696
    v_mfma_f32_32x32x16_bf16 v[64:79], v[108:111], v[148:151], v[64:79]
    ds_read_b64_tr_b16 v[108:109], v7 offset:28672
    ds_read_b64_tr_b16 v[110:111], v7 offset:29696
    buffer_load_dwordx4 v[184:187], v9, s[20:23], s57 offen offset:2048 sc1
    s_waitcnt vmcnt(8) lgkmcnt(8)
    v_mfma_f32_32x32x16_bf16 v[16:31], v[80:83], v[152:155], v[16:31]
    ds_read_b64_tr_b16 v[80:81], v4 offset:32768
    ds_read_b64_tr_b16 v[82:83], v4 offset:33792
    v_mfma_f32_32x32x16_bf16 v[32:47], v[84:87], v[152:155], v[32:47]
    ds_read_b64_tr_b16 v[84:85], v5 offset:32768
    ds_read_b64_tr_b16 v[86:87], v5 offset:33792
    buffer_load_dwordx4 v[188:191], v9, s[20:23], s57 offen offset:3072 sc1
    v_mfma_f32_32x32x16_bf16 v[48:63], v[88:91], v[152:155], v[48:63]
    ds_read_b64_tr_b16 v[88:89], v6 offset:32768
    ds_read_b64_tr_b16 v[90:91], v6 offset:33792
    v_mfma_f32_32x32x16_bf16 v[64:79], v[92:95], v[152:155], v[64:79]
    ds_read_b64_tr_b16 v[92:93], v7 offset:32768
    ds_read_b64_tr_b16 v[94:95], v7 offset:33792
    s_add_u32 s57, s57, 12288
    buffer_load_dwordx4 v[192:195], v9, s[20:23], s57 offen offset:0 sc1
    s_waitcnt vmcnt(9) lgkmcnt(8)
    v_mfma_f32_32x32x16_bf16 v[16:31], v[96:99], v[156:159], v[16:31]
    ds_read_b64_tr_b16 v[96:97], v4 offset:36864
    ds_read_b64_tr_b16 v[98:99], v4 offset:37888
    v_mfma_f32_32x32x16_bf16 v[32:47], v[100:103], v[156:159], v[32:47]
    ds_read_b64_tr_b16 v[100:101], v5 offset:36864
    ds_read_b64_tr_b16 v[102:103], v5 offset:37888
    v_mfma_f32_32x32x16_bf16 v[48:63], v[104:107], v[156:159], v[48:63]
    ds_read_b64_tr_b16 v[104:105], v6 offset:36864
    ds_read_b64_tr_b16 v[106:107], v6 offset:37888
    v_mfma_f32_32x32x16_bf16 v[64:79], v[108:111], v[156:159], v[64:79]
    ds_read_b64_tr_b16 v[108:109], v7 offset:36864
    ds_read_b64_tr_b16 v[110:111], v7 offset:37888
    buffer_load_dwordx4 v[196:199], v9, s[20:23], s57 offen offset:1024 sc1
    s_waitcnt vmcnt(9) lgkmcnt(8)
    v_mfma_f32_32x32x16_bf16 v[16:31], v[80:83], v[160:163], v[16:31]
    ds_read_b64_tr_b16 v[80:81], v4 offset:40960
    ds_read_b64_tr_b16 v[82:83], v4 offset:41984
    v_mfma_f32_32x32x16_bf16 v[32:47], v[84:87], v[160:163], v[32:47]
    ds_read_b64_tr_b16 v[84:85], v5 offset:40960
    ds_read_b64_tr_b16 v[86:87], v5 offset:41984
    buffer_load_dwordx4 v[200:203], v9, s[20:23], s57 offen offset:2048 sc1
    v_mfma_f32_32x32x16_bf16 v[48:63], v[88:91], v[160:163], v[48:63]
    ds_read_b64_tr_b16 v[88:89], v6 offset:40960
    ds_read_b64_tr_b16 v[90:91], v6 offset:41984
    v_mfma_f32_32x32x16_bf16 v[64:79], v[92:95], v[160:163], v[64:79]
    ds_read_b64_tr_b16 v[92:93], v7 offset:40960
    ds_read_b64_tr_b16 v[94:95], v7 offset:41984
    buffer_load_dwordx4 v[204:207], v9, s[20:23], s57 offen offset:3072 sc1
    s_waitcnt vmcnt(10) lgkmcnt(8)
    v_mfma_f32_32x32x16_bf16 v[16:31], v[96:99], v[164:167], v[16:31]
    ds_read_b64_tr_b16 v[96:97], v4 offset:45056
    ds_read_b64_tr_b16 v[98:99], v4 offset:46080
    v_mfma_f32_32x32x16_bf16 v[32:47], v[100:103], v[164:167], v[32:47]
    ds_read_b64_tr_b16 v[100:101], v5 offset:45056
    ds_read_b64_tr_b16 v[102:103], v5 offset:46080
    v_mfma_f32_32x32x16_bf16 v[48:63], v[104:107], v[164:167], v[48:63]
    ds_read_b64_tr_b16 v[104:105], v6 offset:45056
    ds_read_b64_tr_b16 v[106:107], v6 offset:46080
    v_mfma_f32_32x32x16_bf16 v[64:79], v[108:111], v[164:167], v[64:79]
    ds_read_b64_tr_b16 v[108:109], v7 offset:45056
    ds_read_b64_tr_b16 v[110:111], v7 offset:46080
    s_add_u32 s57, s57, 4096
    buffer_load_dwordx4 v[208:211], v9, s[20:23], s57 offen offset:0 sc1
    s_waitcnt vmcnt(10) lgkmcnt(8)
    v_mfma_f32_32x32x16_bf16 v[16:31], v[80:83], v[168:171], v[16:31]
    ds_read_b64_tr_b16 v[80:81], v4 offset:49152
    ds_read_b64_tr_b16 v[82:83], v4 offset:50176
    v_mfma_f32_32x32x16_bf16 v[32:47], v[84:87], v[168:171], v[32:47]
    ds_read_b64_tr_b16 v[84:85], v5 offset:49152
    ds_read_b64_tr_b16 v[86:87], v5 offset:50176
    buffer_load_dwordx4 v[212:215], v9, s[20:23], s57 offen offset:1024 sc1
    v_mfma_f32_32x32x16_bf16 v[48:63], v[88:91], v[168:171], v[48:63]
    ds_read_b64_tr_b16 v[88:89], v6 offset:49152
    ds_read_b64_tr_b16 v[90:91], v6 offset:50176
    v_mfma_f32_32x32x16_bf16 v[64:79], v[92:95], v[168:171], v[64:79]
    ds_read_b64_tr_b16 v[92:93], v7 offset:49152
    ds_read_b64_tr_b16 v[94:95], v7 offset:50176
    buffer_load_dwordx4 v[128:131], v9, s[20:23], s57 offen offset:2048 sc1
    s_waitcnt vmcnt(11) lgkmcnt(8)
    v_mfma_f32_32x32x16_bf16 v[16:31], v[96:99], v[172:175], v[16:31]
    ds_read_b64_tr_b16 v[96:97], v4 offset:53248
    ds_read_b64_tr_b16 v[98:99], v4 offset:54272
    v_mfma_f32_32x32x16_bf16 v[32:47], v[100:103], v[172:175], v[32:47]
    ds_read_b64_tr_b16 v[100:101], v5 offset:53248
    ds_read_b64_tr_b16 v[102:103], v5 offset:54272
    v_mfma_f32_32x32x16_bf16 v[48:63], v[104:107], v[172:175], v[48:63]
    ds_read_b64_tr_b16 v[104:105], v6 offset:53248
    ds_read_b64_tr_b16 v[106:107], v6 offset:54272
    v_mfma_f32_32x32x16_bf16 v[64:79], v[108:111], v[172:175], v[64:79]
    ds_read_b64_tr_b16 v[108:109], v7 offset:53248
    ds_read_b64_tr_b16 v[110:111], v7 offset:54272
    buffer_load_dwordx4 v[132:135], v9, s[20:23], s57 offen offset:3072 sc1
    s_waitcnt vmcnt(11) lgkmcnt(8)
    v_mfma_f32_32x32x16_bf16 v[16:31], v[80:83], v[176:179], v[16:31]
    ds_read_b64_tr_b16 v[80:81], v4 offset:57344
    ds_read_b64_tr_b16 v[82:83], v4 offset:58368
    v_mfma_f32_32x32x16_bf16 v[32:47], v[84:87], v[176:179], v[32:47]
    ds_read_b64_tr_b16 v[84:85], v5 offset:57344
    ds_read_b64_tr_b16 v[86:87], v5 offset:58368
    s_add_u32 s57, s57, 12288
    buffer_load_dwordx4 v[136:139], v9, s[20:23], s57 offen offset:0 sc1
    v_mfma_f32_32x32x16_bf16 v[48:63], v[88:91], v[176:179], v[48:63]
    ds_read_b64_tr_b16 v[88:89], v6 offset:57344
    ds_read_b64_tr_b16 v[90:91], v6 offset:58368
    v_mfma_f32_32x32x16_bf16 v[64:79], v[92:95], v[176:179], v[64:79]
    ds_read_b64_tr_b16 v[92:93], v7 offset:57344
    ds_read_b64_tr_b16 v[94:95], v7 offset:58368
    buffer_load_dwordx4 v[140:143], v9, s[20:23], s57 offen offset:1024 sc1
    s_waitcnt vmcnt(12) lgkmcnt(8)
    v_mfma_f32_32x32x16_bf16 v[16:31], v[96:99], v[180:183], v[16:31]
    ds_read_b64_tr_b16 v[96:97], v4 offset:61440
    ds_read_b64_tr_b16 v[98:99], v4 offset:62464
    v_mfma_f32_32x32x16_bf16 v[32:47], v[100:103], v[180:183], v[32:47]
    ds_read_b64_tr_b16 v[100:101], v5 offset:61440
    ds_read_b64_tr_b16 v[102:103], v5 offset:62464
    v_mfma_f32_32x32x16_bf16 v[48:63], v[104:107], v[180:183], v[48:63]
    ds_read_b64_tr_b16 v[104:105], v6 offset:61440
    ds_read_b64_tr_b16 v[106:107], v6 offset:62464
    v_mfma_f32_32x32x16_bf16 v[64:79], v[108:111], v[180:183], v[64:79]
    ds_read_b64_tr_b16 v[108:109], v7 offset:61440
    ds_read_b64_tr_b16 v[110:111], v7 offset:62464
    buffer_load_dwordx4 v[144:147], v9, s[20:23], s57 offen offset:2048 sc1
    s_waitcnt vmcnt(12) lgkmcnt(8)
    v_mfma_f32_32x32x16_bf16 v[16:31], v[80:83], v[184:187], v[16:31]
    v_add_u32 v4, 65536, v4
    ds_read_b64_tr_b16 v[80:81], v4 offset:0
    ds_read_b64_tr_b16 v[82:83], v4 offset:1024
    v_mfma_f32_32x32x16_bf16 v[32:47], v[84:87], v[184:187], v[32:47]
    v_add_u32 v5, 65536, v5
    ds_read_b64_tr_b16 v[84:85], v5 offset:0
    ds_read_b64_tr_b16 v[86:87], v5 offset:1024
    buffer_load_dwordx4 v[148:151], v9, s[20:23], s57 offen offset:3072 sc1
    v_mfma_f32_32x32x16_bf16 v[48:63], v[88:91], v[184:187], v[48:63]
    v_add_u32 v6, 65536, v6
    ds_read_b64_tr_b16 v[88:89], v6 offset:0
    ds_read_b64_tr_b16 v[90:91], v6 offset:1024
    v_mfma_f32_32x32x16_bf16 v[64:79], v[92:95], v[184:187], v[64:79]
    v_add_u32 v7, 65536, v7
    ds_read_b64_tr_b16 v[92:93], v7 offset:0
    ds_read_b64_tr_b16 v[94:95], v7 offset:1024
    s_add_u32 s57, s57, 4096
    buffer_load_dwordx4 v[152:155], v9, s[20:23], s57 offen offset:0 sc1
    s_waitcnt vmcnt(13) lgkmcnt(8)
    v_mfma_f32_32x32x16_bf16 v[16:31], v[96:99], v[188:191], v[16:31]
    ds_read_b64_tr_b16 v[96:97], v4 offset:4096
    ds_read_b64_tr_b16 v[98:99], v4 offset:5120
    v_mfma_f32_32x32x16_bf16 v[32:47], v[100:103], v[188:191], v[32:47]
    ds_read_b64_tr_b16 v[100:101], v5 offset:4096
    ds_read_b64_tr_b16 v[102:103], v5 offset:5120
    v_mfma_f32_32x32x16_bf16 v[48:63], v[104:107], v[188:191], v[48:63]
    ds_read_b64_tr_b16 v[104:105], v6 offset:4096
    ds_read_b64_tr_b16 v[106:107], v6 offset:5120
    v_mfma_f32_32x32x16_bf16 v[64:79], v[108:111], v[188:191], v[64:79]
    ds_read_b64_tr_b16 v[108:109], v7 offset:4096
    ds_read_b64_tr_b16 v[110:111], v7 offset:5120
    buffer_load_dwordx4 v[156:159], v9, s[20:23], s57 offen offset:1024 sc1
    s_waitcnt vmcnt(13) lgkmcnt(8)
    v_mfma_f32_32x32x16_bf16 v[16:31], v[80:83], v[192:195], v[16:31]
    ds_read_b64_tr_b16 v[80:81], v4 offset:8192
    ds_read_b64_tr_b16 v[82:83], v4 offset:9216
    v_mfma_f32_32x32x16_bf16 v[32:47], v[84:87], v[192:195], v[32:47]
    ds_read_b64_tr_b16 v[84:85], v5 offset:8192
    ds_read_b64_tr_b16 v[86:87], v5 offset:9216
    buffer_load_dwordx4 v[160:163], v9, s[20:23], s57 offen offset:2048 sc1
    v_mfma_f32_32x32x16_bf16 v[48:63], v[88:91], v[192:195], v[48:63]
    ds_read_b64_tr_b16 v[88:89], v6 offset:8192
    ds_read_b64_tr_b16 v[90:91], v6 offset:9216
    v_mfma_f32_32x32x16_bf16 v[64:79], v[92:95], v[192:195], v[64:79]
    ds_read_b64_tr_b16 v[92:93], v7 offset:8192
    ds_read_b64_tr_b16 v[94:95], v7 offset:9216
    buffer_load_dwordx4 v[164:167], v9, s[20:23], s57 offen offset:3072 sc1
    s_waitcnt vmcnt(14) lgkmcnt(8)
    v_mfma_f32_32x32x16_bf16 v[16:31], v[96:99], v[196:199], v[16:31]
    ds_read_b64_tr_b16 v[96:97], v4 offset:12288
    ds_read_b64_tr_b16 v[98:99], v4 offset:13312
    v_mfma_f32_32x32x16_bf16 v[32:47], v[100:103], v[196:199], v[32:47]
    ds_read_b64_tr_b16 v[100:101], v5 offset:12288
    ds_read_b64_tr_b16 v[102:103], v5 offset:13312
    v_mfma_f32_32x32x16_bf16 v[48:63], v[104:107], v[196:199], v[48:63]
    ds_read_b64_tr_b16 v[104:105], v6 offset:12288
    ds_read_b64_tr_b16 v[106:107], v6 offset:13312
    v_mfma_f32_32x32x16_bf16 v[64:79], v[108:111], v[196:199], v[64:79]
    ds_read_b64_tr_b16 v[108:109], v7 offset:12288
    ds_read_b64_tr_b16 v[110:111], v7 offset:13312
    s_add_u32 s57, s57, 12288
    buffer_load_dwordx4 v[168:171], v9, s[20:23], s57 offen offset:0 sc1
    s_waitcnt vmcnt(14) lgkmcnt(8)
    s_barrier
    v_mfma_f32_32x32x16_bf16 v[16:31], v[80:83], v[200:203], v[16:31]
    ds_read_b64_tr_b16 v[80:81], v4 offset:16384
    ds_read_b64_tr_b16 v[82:83], v4 offset:17408
    v_mfma_f32_32x32x16_bf16 v[32:47], v[84:87], v[200:203], v[32:47]
    ds_read_b64_tr_b16 v[84:85], v5 offset:16384
    ds_read_b64_tr_b16 v[86:87], v5 offset:17408
    buffer_load_dwordx4 v[172:175], v9, s[20:23], s57 offen offset:1024 sc1
    v_mfma_f32_32x32x16_bf16 v[48:63], v[88:91], v[200:203], v[48:63]
    ds_read_b64_tr_b16 v[88:89], v6 offset:16384
    ds_read_b64_tr_b16 v[90:91], v6 offset:17408
    v_mfma_f32_32x32x16_bf16 v[64:79], v[92:95], v[200:203], v[64:79]
    ds_read_b64_tr_b16 v[92:93], v7 offset:16384
    ds_read_b64_tr_b16 v[94:95], v7 offset:17408
    buffer_load_dwordx4 v[176:179], v9, s[20:23], s57 offen offset:2048 sc1
    s_waitcnt vmcnt(15) lgkmcnt(8)
    v_mfma_f32_32x32x16_bf16 v[16:31], v[96:99], v[204:207], v[16:31]
    ds_read_b64_tr_b16 v[96:97], v4 offset:20480
    ds_read_b64_tr_b16 v[98:99], v4 offset:21504
    v_mfma_f32_32x32x16_bf16 v[32:47], v[100:103], v[204:207], v[32:47]
    ds_read_b64_tr_b16 v[100:101], v5 offset:20480
    ds_read_b64_tr_b16 v[102:103], v5 offset:21504
    v_mfma_f32_32x32x16_bf16 v[48:63], v[104:107], v[204:207], v[48:63]
    ds_read_b64_tr_b16 v[104:105], v6 offset:20480
    ds_read_b64_tr_b16 v[106:107], v6 offset:21504
    v_mfma_f32_32x32x16_bf16 v[64:79], v[108:111], v[204:207], v[64:79]
    ds_read_b64_tr_b16 v[108:109], v7 offset:20480
    ds_read_b64_tr_b16 v[110:111], v7 offset:21504
    buffer_load_dwordx4 v[180:183], v9, s[20:23], s57 offen offset:3072 sc1
    s_waitcnt vmcnt(15) lgkmcnt(8)
    v_mfma_f32_32x32x16_bf16 v[16:31], v[80:83], v[208:211], v[16:31]
    ds_read_b64_tr_b16 v[80:81], v4 offset:24576
    ds_read_b64_tr_b16 v[82:83], v4 offset:25600
    v_mfma_f32_32x32x16_bf16 v[32:47], v[84:87], v[208:211], v[32:47]
    ds_read_b64_tr_b16 v[84:85], v5 offset:24576
    ds_read_b64_tr_b16 v[86:87], v5 offset:25600
    s_add_u32 s57, s57, 4096
    buffer_load_dwordx4 v[184:187], v9, s[20:23], s57 offen offset:0 sc1
    v_mfma_f32_32x32x16_bf16 v[48:63], v[88:91], v[208:211], v[48:63]
    ds_read_b64_tr_b16 v[88:89], v6 offset:24576
    ds_read_b64_tr_b16 v[90:91], v6 offset:25600
    v_mfma_f32_32x32x16_bf16 v[64:79], v[92:95], v[208:211], v[64:79]
    ds_read_b64_tr_b16 v[92:93], v7 offset:24576
    ds_read_b64_tr_b16 v[94:95], v7 offset:25600
    buffer_load_dwordx4 v[188:191], v9, s[20:23], s57 offen offset:1024 sc1
    s_waitcnt vmcnt(16) lgkmcnt(8)
    v_mfma_f32_32x32x16_bf16 v[16:31], v[96:99], v[212:215], v[16:31]
    ds_read_b64_tr_b16 v[96:97], v4 offset:28672
    ds_read_b64_tr_b16 v[98:99], v4 offset:29696
    v_mfma_f32_32x32x16_bf16 v[32:47], v[100:103], v[212:215], v[32:47]
    ds_read_b64_tr_b16 v[100:101], v5 offset:28672
    ds_read_b64_tr_b16 v[102:103], v5 offset:29696
    v_mfma_f32_32x32x16_bf16 v[48:63], v[104:107], v[212:215], v[48:63]
    ds_read_b64_tr_b16 v[104:105], v6 offset:28672
    ds_read_b64_tr_b16 v[106:107], v6 offset:29696
    v_mfma_f32_32x32x16_bf16 v[64:79], v[108:111], v[212:215], v[64:79]
    ds_read_b64_tr_b16 v[108:109], v7 offset:28672
    ds_read_b64_tr_b16 v[110:111], v7 offset:29696
    buffer_load_dwordx4 v[192:195], v9, s[20:23], s57 offen offset:2048 sc1
    s_waitcnt vmcnt(16) lgkmcnt(8)
    v_mfma_f32_32x32x16_bf16 v[16:31], v[80:83], v[128:131], v[16:31]
    ds_read_b64_tr_b16 v[80:81], v4 offset:32768
    ds_read_b64_tr_b16 v[82:83], v4 offset:33792
    v_mfma_f32_32x32x16_bf16 v[32:47], v[84:87], v[128:131], v[32:47]
    ds_read_b64_tr_b16 v[84:85], v4 offset:36864
    ds_read_b64_tr_b16 v[86:87], v4 offset:37888
    buffer_load_dwordx4 v[196:199], v9, s[20:23], s57 offen offset:3072 sc1
    v_mfma_f32_32x32x16_bf16 v[48:63], v[88:91], v[128:131], v[48:63]
    ds_read_b64_tr_b16 v[88:89], v4 offset:40960
    ds_read_b64_tr_b16 v[90:91], v4 offset:41984
    v_mfma_f32_32x32x16_bf16 v[64:79], v[92:95], v[128:131], v[64:79]
    ds_read_b64_tr_b16 v[92:93], v4 offset:45056
    ds_read_b64_tr_b16 v[94:95], v4 offset:46080
    s_waitcnt vmcnt(16) lgkmcnt(8)
    v_mfma_f32_32x32x16_bf16 v[16:31], v[96:99], v[132:135], v[16:31]
    ds_read_b64_tr_b16 v[96:97], v4 offset:49152
    ds_read_b64_tr_b16 v[98:99], v4 offset:50176
    v_mfma_f32_32x32x16_bf16 v[32:47], v[100:103], v[132:135], v[32:47]
    ds_read_b64_tr_b16 v[100:101], v4 offset:53248
    ds_read_b64_tr_b16 v[102:103], v4 offset:54272
    v_mfma_f32_32x32x16_bf16 v[48:63], v[104:107], v[132:135], v[48:63]
    ds_read_b64_tr_b16 v[104:105], v4 offset:57344
    ds_read_b64_tr_b16 v[106:107], v4 offset:58368
    v_mfma_f32_32x32x16_bf16 v[64:79], v[108:111], v[132:135], v[64:79]
    ds_read_b64_tr_b16 v[108:109], v4 offset:61440
    ds_read_b64_tr_b16 v[110:111], v4 offset:62464
    s_waitcnt vmcnt(12) lgkmcnt(8)
    v_mfma_f32_32x32x16_bf16 v[16:31], v[80:83], v[136:139], v[16:31]
    ds_read_b64_tr_b16 v[80:81], v5 offset:32768
    ds_read_b64_tr_b16 v[82:83], v5 offset:33792
    v_mfma_f32_32x32x16_bf16 v[16:31], v[84:87], v[140:143], v[16:31]
    ds_read_b64_tr_b16 v[84:85], v5 offset:36864
    ds_read_b64_tr_b16 v[86:87], v5 offset:37888
    v_mfma_f32_32x32x16_bf16 v[16:31], v[88:91], v[144:147], v[16:31]
    ds_read_b64_tr_b16 v[88:89], v5 offset:40960
    ds_read_b64_tr_b16 v[90:91], v5 offset:41984
    v_mfma_f32_32x32x16_bf16 v[16:31], v[92:95], v[148:151], v[16:31]
    ds_read_b64_tr_b16 v[92:93], v5 offset:45056
    ds_read_b64_tr_b16 v[94:95], v5 offset:46080
    s_waitcnt vmcnt(8) lgkmcnt(8)
    v_mfma_f32_32x32x16_bf16 v[16:31], v[96:99], v[152:155], v[16:31]
    ds_read_b64_tr_b16 v[96:97], v5 offset:49152
    ds_read_b64_tr_b16 v[98:99], v5 offset:50176
    v_mfma_f32_32x32x16_bf16 v[16:31], v[100:103], v[156:159], v[16:31]
    ds_read_b64_tr_b16 v[100:101], v5 offset:53248
    ds_read_b64_tr_b16 v[102:103], v5 offset:54272
    v_mfma_f32_32x32x16_bf16 v[16:31], v[104:107], v[160:163], v[16:31]
    ds_read_b64_tr_b16 v[104:105], v5 offset:57344
    ds_read_b64_tr_b16 v[106:107], v5 offset:58368
    v_mfma_f32_32x32x16_bf16 v[16:31], v[108:111], v[164:167], v[16:31]
    ds_read_b64_tr_b16 v[108:109], v5 offset:61440
    ds_read_b64_tr_b16 v[110:111], v5 offset:62464
    s_waitcnt lgkmcnt(8)
    s_barrier
    v_mfma_f32_32x32x16_bf16 v[32:47], v[80:83], v[136:139], v[32:47]
    v_add_u32 v4, 65536, v4
    ds_read_b64_tr_b16 v[80:81], v4 offset:0
    ds_read_b64_tr_b16 v[82:83], v4 offset:1024
    v_mfma_f32_32x32x16_bf16 v[32:47], v[84:87], v[140:143], v[32:47]
    ds_read_b64_tr_b16 v[84:85], v4 offset:4096
    ds_read_b64_tr_b16 v[86:87], v4 offset:5120
    v_mfma_f32_32x32x16_bf16 v[32:47], v[88:91], v[144:147], v[32:47]
    ds_read_b64_tr_b16 v[88:89], v4 offset:8192
    ds_read_b64_tr_b16 v[90:91], v4 offset:9216
    v_mfma_f32_32x32x16_bf16 v[32:47], v[92:95], v[148:151], v[32:47]
    ds_read_b64_tr_b16 v[92:93], v4 offset:12288
    ds_read_b64_tr_b16 v[94:95], v4 offset:13312
    s_waitcnt lgkmcnt(8)
    v_mfma_f32_32x32x16_bf16 v[32:47], v[96:99], v[152:155], v[32:47]
    v_subrev_u32 v4, 131072, v4
    ds_read_b64_tr_b16 v[96:97], v4 offset:0
    ds_read_b64_tr_b16 v[98:99], v4 offset:1024
    v_mfma_f32_32x32x16_bf16 v[32:47], v[100:103], v[156:159], v[32:47]
    ds_read_b64_tr_b16 v[100:101], v4 offset:4096
    ds_read_b64_tr_b16 v[102:103], v4 offset:5120
    v_mfma_f32_32x32x16_bf16 v[32:47], v[104:107], v[160:163], v[32:47]
    ds_read_b64_tr_b16 v[104:105], v4 offset:8192
    ds_read_b64_tr_b16 v[106:107], v4 offset:9216
    v_mfma_f32_32x32x16_bf16 v[32:47], v[108:111], v[164:167], v[32:47]
    ds_read_b64_tr_b16 v[108:109], v4 offset:12288
    ds_read_b64_tr_b16 v[110:111], v4 offset:13312
    s_waitcnt vmcnt(4) lgkmcnt(8)
    v_mfma_f32_32x32x16_bf16 v[16:31], v[80:83], v[168:171], v[16:31]
    v_add_u32 v5, 65536, v5
    ds_read_b64_tr_b16 v[80:81], v5 offset:0
    ds_read_b64_tr_b16 v[82:83], v5 offset:1024
    v_mfma_f32_32x32x16_bf16 v[16:31], v[84:87], v[172:175], v[16:31]
    ds_read_b64_tr_b16 v[84:85], v5 offset:4096
    ds_read_b64_tr_b16 v[86:87], v5 offset:5120
    v_mfma_f32_32x32x16_bf16 v[16:31], v[88:91], v[176:179], v[16:31]
    ds_read_b64_tr_b16 v[88:89], v5 offset:8192
    ds_read_b64_tr_b16 v[90:91], v5 offset:9216
    v_mfma_f32_32x32x16_bf16 v[16:31], v[92:95], v[180:183], v[16:31]
    ds_read_b64_tr_b16 v[92:93], v5 offset:12288
    ds_read_b64_tr_b16 v[94:95], v5 offset:13312
    s_waitcnt vmcnt(0) lgkmcnt(8)
    v_mfma_f32_32x32x16_bf16 v[16:31], v[96:99], v[184:187], v[16:31]
    v_subrev_u32 v5, 131072, v5
    ds_read_b64_tr_b16 v[96:97], v5 offset:0
    ds_read_b64_tr_b16 v[98:99], v5 offset:1024
    v_mfma_f32_32x32x16_bf16 v[16:31], v[100:103], v[188:191], v[16:31]
    ds_read_b64_tr_b16 v[100:101], v5 offset:4096
    ds_read_b64_tr_b16 v[102:103], v5 offset:5120
    v_mfma_f32_32x32x16_bf16 v[16:31], v[104:107], v[192:195], v[16:31]
    ds_read_b64_tr_b16 v[104:105], v5 offset:8192
    ds_read_b64_tr_b16 v[106:107], v5 offset:9216
    v_mfma_f32_32x32x16_bf16 v[16:31], v[108:111], v[196:199], v[16:31]
    ds_read_b64_tr_b16 v[108:109], v5 offset:12288
    ds_read_b64_tr_b16 v[110:111], v5 offset:13312
    s_waitcnt lgkmcnt(8)
    v_mfma_f32_32x32x16_bf16 v[32:47], v[80:83], v[168:171], v[32:47]
    ds_read_b64_tr_b16 v[80:81], v6 offset:32768
    ds_read_b64_tr_b16 v[82:83], v6 offset:33792
    v_mfma_f32_32x32x16_bf16 v[32:47], v[84:87], v[172:175], v[32:47]
    ds_read_b64_tr_b16 v[84:85], v6 offset:36864
    ds_read_b64_tr_b16 v[86:87], v6 offset:37888
    v_mfma_f32_32x32x16_bf16 v[32:47], v[88:91], v[176:179], v[32:47]
    ds_read_b64_tr_b16 v[88:89], v6 offset:40960
    ds_read_b64_tr_b16 v[90:91], v6 offset:41984
    v_mfma_f32_32x32x16_bf16 v[32:47], v[92:95], v[180:183], v[32:47]
    ds_read_b64_tr_b16 v[92:93], v6 offset:45056
    ds_read_b64_tr_b16 v[94:95], v6 offset:46080
    v_mul_f32 v16, s48, v16
    v_mul_f32 v17, s48, v17
    v_mul_f32 v18, s48, v18
    v_mul_f32 v19, s48, v19
    s_waitcnt lgkmcnt(8)
    v_mfma_f32_32x32x16_bf16 v[32:47], v[96:99], v[184:187], v[32:47]
    ds_read_b64_tr_b16 v[96:97], v6 offset:49152
    ds_read_b64_tr_b16 v[98:99], v6 offset:50176
    v_mul_f32 v20, s48, v20
    v_mul_f32 v21, s48, v21
    v_mul_f32 v22, s48, v22
    v_mul_f32 v23, s48, v23
    v_mfma_f32_32x32x16_bf16 v[32:47], v[100:103], v[188:191], v[32:47]
    ds_read_b64_tr_b16 v[100:101], v6 offset:53248
    ds_read_b64_tr_b16 v[102:103], v6 offset:54272
    v_mul_f32 v24, s48, v24
    v_mul_f32 v25, s48, v25
    v_mul_f32 v26, s48, v26
    v_mul_f32 v27, s48, v27
    v_mfma_f32_32x32x16_bf16 v[32:47], v[104:107], v[192:195], v[32:47]
    ds_read_b64_tr_b16 v[104:105], v6 offset:57344
    ds_read_b64_tr_b16 v[106:107], v6 offset:58368
    v_mul_f32 v28, s48, v28
    v_mul_f32 v29, s48, v29
    v_mul_f32 v30, s48, v30
    v_mul_f32 v31, s48, v31
    v_mfma_f32_32x32x16_bf16 v[32:47], v[108:111], v[196:199], v[32:47]
    ds_read_b64_tr_b16 v[108:109], v6 offset:61440
    ds_read_b64_tr_b16 v[110:111], v6 offset:62464
    v_cvt_pk_bf16_f32 v112, v16, v17
    v_cvt_pk_bf16_f32 v113, v18, v19
    v_cvt_pk_bf16_f32 v114, v20, v21
    v_cvt_pk_bf16_f32 v115, v22, v23
    s_waitcnt lgkmcnt(8)
    v_mfma_f32_32x32x16_bf16 v[48:63], v[80:83], v[136:139], v[48:63]
    v_add_u32 v6, 65536, v6
    ds_read_b64_tr_b16 v[80:81], v6 offset:0
    ds_read_b64_tr_b16 v[82:83], v6 offset:1024
    v_cvt_pk_bf16_f32 v116, v24, v25
    v_cvt_pk_bf16_f32 v117, v26, v27
    v_cvt_pk_bf16_f32 v118, v28, v29
    v_cvt_pk_bf16_f32 v119, v30, v31
    v_mfma_f32_32x32x16_bf16 v[48:63], v[84:87], v[140:143], v[48:63]
    ds_read_b64_tr_b16 v[84:85], v6 offset:4096
    ds_read_b64_tr_b16 v[86:87], v6 offset:5120
    s_nop 0
    v_permlane32_swap_b32 v112, v114
    v_permlane32_swap_b32 v113, v115
    v_permlane32_swap_b32 v116, v118
    v_mfma_f32_32x32x16_bf16 v[48:63], v[88:91], v[144:147], v[48:63]
    ds_read_b64_tr_b16 v[88:89], v6 offset:8192
    ds_read_b64_tr_b16 v[90:91], v6 offset:9216
    v_permlane32_swap_b32 v117, v119
    buffer_store_dwordx4 v[112:115], v9, s[20:23], s55 offen offset:0 sc0 sc1
    buffer_store_dwordx4 v[116:119], v9, s[20:23], s55 offen offset:1024 sc0 sc1
    v_mfma_f32_32x32x16_bf16 v[48:63], v[92:95], v[148:151], v[48:63]
    ds_read_b64_tr_b16 v[92:93], v6 offset:12288
    ds_read_b64_tr_b16 v[94:95], v6 offset:13312
    v_mul_f32 v32, s48, v32
    v_mul_f32 v33, s48, v33
    v_mul_f32 v34, s48, v34
    v_mul_f32 v35, s48, v35
    s_waitcnt lgkmcnt(8)
    v_mfma_f32_32x32x16_bf16 v[48:63], v[96:99], v[152:155], v[48:63]
    v_subrev_u32 v6, 131072, v6
    ds_read_b64_tr_b16 v[96:97], v6 offset:0
    ds_read_b64_tr_b16 v[98:99], v6 offset:1024
    v_mul_f32 v36, s48, v36
    v_mul_f32 v37, s48, v37
    v_mul_f32 v38, s48, v38
    v_mul_f32 v39, s48, v39
    v_mfma_f32_32x32x16_bf16 v[48:63], v[100:103], v[156:159], v[48:63]
    ds_read_b64_tr_b16 v[100:101], v6 offset:4096
    ds_read_b64_tr_b16 v[102:103], v6 offset:5120
    v_mul_f32 v40, s48, v40
    v_mul_f32 v41, s48, v41
    v_mul_f32 v42, s48, v42
    v_mul_f32 v43, s48, v43
    v_mfma_f32_32x32x16_bf16 v[48:63], v[104:107], v[160:163], v[48:63]
    ds_read_b64_tr_b16 v[104:105], v6 offset:8192
    ds_read_b64_tr_b16 v[106:107], v6 offset:9216
    v_mul_f32 v44, s48, v44
    v_mul_f32 v45, s48, v45
    v_mul_f32 v46, s48, v46
    v_mul_f32 v47, s48, v47
    v_mfma_f32_32x32x16_bf16 v[48:63], v[108:111], v[164:167], v[48:63]
    ds_read_b64_tr_b16 v[108:109], v6 offset:12288
    ds_read_b64_tr_b16 v[110:111], v6 offset:13312
    v_cvt_pk_bf16_f32 v120, v32, v33
    v_cvt_pk_bf16_f32 v121, v34, v35
    v_cvt_pk_bf16_f32 v122, v36, v37
    v_cvt_pk_bf16_f32 v123, v38, v39
    s_waitcnt lgkmcnt(8)
    v_mfma_f32_32x32x16_bf16 v[48:63], v[80:83], v[168:171], v[48:63]
    ds_read_b64_tr_b16 v[80:81], v7 offset:32768
    ds_read_b64_tr_b16 v[82:83], v7 offset:33792
    v_cvt_pk_bf16_f32 v124, v40, v41
    v_cvt_pk_bf16_f32 v125, v42, v43
    v_cvt_pk_bf16_f32 v126, v44, v45
    v_cvt_pk_bf16_f32 v127, v46, v47
    v_mfma_f32_32x32x16_bf16 v[48:63], v[84:87], v[172:175], v[48:63]
    ds_read_b64_tr_b16 v[84:85], v7 offset:36864
    ds_read_b64_tr_b16 v[86:87], v7 offset:37888
    s_nop 0
    v_permlane32_swap_b32 v120, v122
    v_permlane32_swap_b32 v121, v123
    v_permlane32_swap_b32 v124, v126
    v_mfma_f32_32x32x16_bf16 v[48:63], v[88:91], v[176:179], v[48:63]
    ds_read_b64_tr_b16 v[88:89], v7 offset:40960
    ds_read_b64_tr_b16 v[90:91], v7 offset:41984
    v_permlane32_swap_b32 v125, v127
    buffer_store_dwordx4 v[120:123], v9, s[20:23], s55 offen offset:2048 sc0 sc1
    buffer_store_dwordx4 v[124:127], v9, s[20:23], s55 offen offset:3072 sc0 sc1
    v_mfma_f32_32x32x16_bf16 v[48:63], v[92:95], v[180:183], v[48:63]
    ds_read_b64_tr_b16 v[92:93], v7 offset:45056
    ds_read_b64_tr_b16 v[94:95], v7 offset:46080
    s_waitcnt lgkmcnt(8)
    v_mfma_f32_32x32x16_bf16 v[48:63], v[96:99], v[184:187], v[48:63]
    ds_read_b64_tr_b16 v[96:97], v7 offset:49152
    ds_read_b64_tr_b16 v[98:99], v7 offset:50176
    v_mfma_f32_32x32x16_bf16 v[48:63], v[100:103], v[188:191], v[48:63]
    ds_read_b64_tr_b16 v[100:101], v7 offset:53248
    ds_read_b64_tr_b16 v[102:103], v7 offset:54272
    v_mfma_f32_32x32x16_bf16 v[48:63], v[104:107], v[192:195], v[48:63]
    ds_read_b64_tr_b16 v[104:105], v7 offset:57344
    ds_read_b64_tr_b16 v[106:107], v7 offset:58368
    v_mfma_f32_32x32x16_bf16 v[48:63], v[108:111], v[196:199], v[48:63]
    ds_read_b64_tr_b16 v[108:109], v7 offset:61440
    ds_read_b64_tr_b16 v[110:111], v7 offset:62464
    s_waitcnt lgkmcnt(8)
    v_mfma_f32_32x32x16_bf16 v[64:79], v[80:83], v[136:139], v[64:79]
    v_add_u32 v7, 65536, v7
    ds_read_b64_tr_b16 v[80:81], v7 offset:0
    ds_read_b64_tr_b16 v[82:83], v7 offset:1024
    v_mfma_f32_32x32x16_bf16 v[64:79], v[84:87], v[140:143], v[64:79]
    ds_read_b64_tr_b16 v[84:85], v7 offset:4096
    ds_read_b64_tr_b16 v[86:87], v7 offset:5120
    v_mfma_f32_32x32x16_bf16 v[64:79], v[88:91], v[144:147], v[64:79]
    ds_read_b64_tr_b16 v[88:89], v7 offset:8192
    ds_read_b64_tr_b16 v[90:91], v7 offset:9216
    v_mfma_f32_32x32x16_bf16 v[64:79], v[92:95], v[148:151], v[64:79]
    ds_read_b64_tr_b16 v[92:93], v7 offset:12288
    ds_read_b64_tr_b16 v[94:95], v7 offset:13312
    v_mul_f32 v48, s48, v48
    v_mul_f32 v49, s48, v49
    v_mul_f32 v50, s48, v50
    v_mul_f32 v51, s48, v51
    s_waitcnt lgkmcnt(8)
    v_mfma_f32_32x32x16_bf16 v[64:79], v[96:99], v[152:155], v[64:79]
    v_subrev_u32 v7, 131072, v7
    ds_read_b64_tr_b16 v[96:97], v7 offset:0
    ds_read_b64_tr_b16 v[98:99], v7 offset:1024
    v_mul_f32 v52, s48, v52
    v_mul_f32 v53, s48, v53
    v_mul_f32 v54, s48, v54
    v_mul_f32 v55, s48, v55
    v_mfma_f32_32x32x16_bf16 v[64:79], v[100:103], v[156:159], v[64:79]
    ds_read_b64_tr_b16 v[100:101], v7 offset:4096
    ds_read_b64_tr_b16 v[102:103], v7 offset:5120
    v_mul_f32 v56, s48, v56
    v_mul_f32 v57, s48, v57
    v_mul_f32 v58, s48, v58
    v_mul_f32 v59, s48, v59
    v_mfma_f32_32x32x16_bf16 v[64:79], v[104:107], v[160:163], v[64:79]
    ds_read_b64_tr_b16 v[104:105], v7 offset:8192
    ds_read_b64_tr_b16 v[106:107], v7 offset:9216
    v_mul_f32 v60, s48, v60
    v_mul_f32 v61, s48, v61
    v_mul_f32 v62, s48, v62
    v_mul_f32 v63, s48, v63
    v_mfma_f32_32x32x16_bf16 v[64:79], v[108:111], v[164:167], v[64:79]
    ds_read_b64_tr_b16 v[108:109], v7 offset:12288
    ds_read_b64_tr_b16 v[110:111], v7 offset:13312
    v_cvt_pk_bf16_f32 v112, v48, v49
    v_cvt_pk_bf16_f32 v113, v50, v51
    v_cvt_pk_bf16_f32 v114, v52, v53
    v_cvt_pk_bf16_f32 v115, v54, v55
    s_waitcnt lgkmcnt(8)
    v_mfma_f32_32x32x16_bf16 v[64:79], v[80:83], v[168:171], v[64:79]
    v_cvt_pk_bf16_f32 v116, v56, v57
    v_cvt_pk_bf16_f32 v117, v58, v59
    v_cvt_pk_bf16_f32 v118, v60, v61
    v_cvt_pk_bf16_f32 v119, v62, v63
    v_mfma_f32_32x32x16_bf16 v[64:79], v[84:87], v[172:175], v[64:79]
    s_nop 0
    v_permlane32_swap_b32 v112, v114
    v_permlane32_swap_b32 v113, v115
    v_permlane32_swap_b32 v116, v118
    v_mfma_f32_32x32x16_bf16 v[64:79], v[88:91], v[176:179], v[64:79]
    v_permlane32_swap_b32 v117, v119
    buffer_store_dwordx4 v[112:115], v9, s[20:23], s56 offen offset:0 sc0 sc1
    buffer_store_dwordx4 v[116:119], v9, s[20:23], s56 offen offset:1024 sc0 sc1
    v_mfma_f32_32x32x16_bf16 v[64:79], v[92:95], v[180:183], v[64:79]
    s_waitcnt lgkmcnt(0)
    v_mfma_f32_32x32x16_bf16 v[64:79], v[96:99], v[184:187], v[64:79]
    v_mfma_f32_32x32x16_bf16 v[64:79], v[100:103], v[188:191], v[64:79]
    v_mfma_f32_32x32x16_bf16 v[64:79], v[104:107], v[192:195], v[64:79]
    v_mfma_f32_32x32x16_bf16 v[64:79], v[108:111], v[196:199], v[64:79]
    s_nop 11
    v_mul_f32 v64, s48, v64
    v_mul_f32 v65, s48, v65
    v_mul_f32 v66, s48, v66
    v_mul_f32 v67, s48, v67
    v_mul_f32 v68, s48, v68
    v_mul_f32 v69, s48, v69
    v_mul_f32 v70, s48, v70
    v_mul_f32 v71, s48, v71
    v_mul_f32 v72, s48, v72
    v_mul_f32 v73, s48, v73
    v_mul_f32 v74, s48, v74
    v_mul_f32 v75, s48, v75
    v_mul_f32 v76, s48, v76
    v_mul_f32 v77, s48, v77
    v_mul_f32 v78, s48, v78
    v_mul_f32 v79, s48, v79
    v_cvt_pk_bf16_f32 v120, v64, v65
    v_cvt_pk_bf16_f32 v121, v66, v67
    v_cvt_pk_bf16_f32 v122, v68, v69
    v_cvt_pk_bf16_f32 v123, v70, v71
    v_cvt_pk_bf16_f32 v124, v72, v73
    v_cvt_pk_bf16_f32 v125, v74, v75
    v_cvt_pk_bf16_f32 v126, v76, v77
    v_cvt_pk_bf16_f32 v127, v78, v79
    s_nop 0
    v_permlane32_swap_b32 v120, v122
    v_permlane32_swap_b32 v121, v123
    v_permlane32_swap_b32 v124, v126
    v_permlane32_swap_b32 v125, v127
    buffer_store_dwordx4 v[120:123], v9, s[20:23], s56 offen offset:2048 sc0 sc1
    buffer_store_dwordx4 v[124:127], v9, s[20:23], s56 offen offset:3072 sc0 sc1
    s_branch L_q_done
L_q_helper:
    s_barrier
    s_cmp_eq_u32 s45, 1
    s_cbranch_scc1 L_qh_nomid
    s_cmp_eq_u32 s49, 0
    s_cbranch_scc1 L_qh_had
    s_cmp_eq_u32 s49, 1
    s_cbranch_scc1 L_qh_crit
    s_add_u32 m0, s50, 32768
    s_mul_i32 s60, s51, 2
    buffer_load_dwordx4 v220, s[8:11], s60 offen offset:0 lds
    buffer_load_dwordx4 v221, s[8:11], s60 offen offset:1024 lds
    buffer_load_dwordx4 v222, s[8:11], s60 offen offset:2048 lds
    buffer_load_dwordx4 v223, s[8:11], s60 offen offset:3072 lds
L_qh_crit:
L_qh_had:
    s_add_u32 m0, s50, 49152
    s_mul_i32 s60, s51, 3
    buffer_load_dwordx4 v220, s[8:11], s60 offen offset:0 lds
    buffer_load_dwordx4 v221, s[8:11], s60 offen offset:1024 lds
    buffer_load_dwordx4 v222, s[8:11], s60 offen offset:2048 lds
    buffer_load_dwordx4 v223, s[8:11], s60 offen offset:3072 lds
    s_add_u32 m0, s50, 65536
    s_mul_i32 s60, s51, 4
    buffer_load_dwordx4 v220, s[8:11], s60 offen offset:0 lds
    buffer_load_dwordx4 v221, s[8:11], s60 offen offset:1024 lds
    buffer_load_dwordx4 v222, s[8:11], s60 offen offset:2048 lds
    buffer_load_dwordx4 v223, s[8:11], s60 offen offset:3072 lds
L_qh_nomid:
    s_barrier
    v_mov_b32 v10, 158784
    ds_read_b32 v10, v10
    s_waitcnt lgkmcnt(0)
    v_readfirstlane_b32 s99, v10
    s_mov_b32 s47, s41
    s_add_u32 s60, s2, s99
    s_and_b32 s60, s60, 6
    s_and_b32 s2, s2, 0xf9
    s_or_b32 s2, s2, s60
    s_and_b32 s99, s99, 8192
    s_lshl_b32 s60, s60, 1
    s_and_b32 s41, s41, 3
    s_add_u32 s41, s41, s60
    s_cmp_eq_u32 s49, 2
    s_cbranch_scc0 L_qh_nojob
    s_waitcnt vmcnt(45)
    v_lshlrev_b32 v30, 16, v30
    v_mul_f32 v31, 0xbfb8aa3b, v30
    v_exp_f32 v31, v31
    v_lshrrev_b32 v38, 4, v1
    v_add_f32 v31, 1.0, v31
    v_rcp_f32 v31, v31
    v_lshlrev_b32 v38, 3, v38
    v_mul_f32 v30, v30, v31
    v_cvt_pk_bf16_f32 v30, v30, v30
    v_lshlrev_b32 v30, 16, v30
    v_lshl_add_u32 v38, v7, 5, v38
    s_lshl_b32 s55, s40, 8
    s_add_u32 s55, s55, 151552
    v_add_u32 v38, s55, v38
    ds_swizzle_b32 v20, v30 offset:24
    ds_swizzle_b32 v22, v30 offset:56
    ds_swizzle_b32 v24, v30 offset:88
    ds_swizzle_b32 v26, v30 offset:120
    ds_swizzle_b32 v28, v30 offset:152
    s_waitcnt vmcnt(44) lgkmcnt(0)
    v_lshlrev_b32 v80, 16, v96
    v_and_b32 v81, 0xffff0000, v96
    v_lshlrev_b32 v82, 16, v97
    v_and_b32 v83, 0xffff0000, v97
    v_lshlrev_b32 v84, 16, v98
    v_and_b32 v85, 0xffff0000, v98
    v_lshlrev_b32 v86, 16, v99
    v_and_b32 v87, 0xffff0000, v99
    v_pk_mul_f32 v[40:41], v[80:81], v[20:21] op_sel_hi:[1,0]
    v_pk_mul_f32 v[42:43], v[82:83], v[20:21] op_sel_hi:[1,0]
    v_pk_mul_f32 v[44:45], v[84:85], v[20:21] op_sel_hi:[1,0]
    v_pk_mul_f32 v[46:47], v[86:87], v[20:21] op_sel_hi:[1,0]
    s_waitcnt vmcnt(43)
    v_lshlrev_b32 v80, 16, v100
    v_and_b32 v81, 0xffff0000, v100
    v_lshlrev_b32 v82, 16, v101
    v_and_b32 v83, 0xffff0000, v101
    v_lshlrev_b32 v84, 16, v102
    v_and_b32 v85, 0xffff0000, v102
    v_lshlrev_b32 v86, 16, v103
    v_and_b32 v87, 0xffff0000, v103
    v_pk_fma_f32 v[40:41], v[80:81], v[22:23], v[40:41] op_sel_hi:[1,0,1]
    v_pk_fma_f32 v[42:43], v[82:83], v[22:23], v[42:43] op_sel_hi:[1,0,1]
    v_pk_fma_f32 v[44:45], v[84:85], v[22:23], v[44:45] op_sel_hi:[1,0,1]
    v_pk_fma_f32 v[46:47], v[86:87], v[22:23], v[46:47] op_sel_hi:[1,0,1]
    s_waitcnt vmcnt(42)
    v_lshlrev_b32 v80, 16, v104
    v_and_b32 v81, 0xffff0000, v104
    v_lshlrev_b32 v82, 16, v105
    v_and_b32 v83, 0xffff0000, v105
    v_lshlrev_b32 v84, 16, v106
    v_and_b32 v85, 0xffff0000, v106
    v_lshlrev_b32 v86, 16, v107
    v_and_b32 v87, 0xffff0000, v107
    v_pk_fma_f32 v[40:41], v[80:81], v[24:25], v[40:41] op_sel_hi:[1,0,1]
    v_pk_fma_f32 v[42:43], v[82:83], v[24:25], v[42:43] op_sel_hi:[1,0,1]
    v_pk_fma_f32 v[44:45], v[84:85], v[24:25], v[44:45] op_sel_hi:[1,0,1]
    v_pk_fma_f32 v[46:47], v[86:87], v[24:25], v[46:47] op_sel_hi:[1,0,1]
    s_waitcnt vmcnt(41)
    v_lshlrev_b32 v80, 16, v108
    v_and_b32 v81, 0xffff0000, v108
    v_lshlrev_b32 v82, 16, v109
    v_and_b32 v83, 0xffff0000, v109
    v_lshlrev_b32 v84, 16, v110
    v_and_b32 v85, 0xffff0000, v110
    v_lshlrev_b32 v86, 16, v111
    v_and_b32 v87, 0xffff0000, v111
    v_pk_fma_f32 v[40:41], v[80:81], v[26:27], v[40:41] op_sel_hi:[1,0,1]
    v_pk_fma_f32 v[42:43], v[82:83], v[26:27], v[42:43] op_sel_hi:[1,0,1]
    v_pk_fma_f32 v[44:45], v[84:85], v[26:27], v[44:45] op_sel_hi:[1,0,1]
    v_pk_fma_f32 v[46:47], v[86:87], v[26:27], v[46:47] op_sel_hi:[1,0,1]
    s_waitcnt vmcnt(40)
    v_lshlrev_b32 v80, 16, v112
    v_and_b32 v81, 0xffff0000, v112
    v_lshlrev_b32 v82, 16, v113
    v_and_b32 v83, 0xffff0000, v113
    v_lshlrev_b32 v84, 16, v114
    v_and_b32 v85, 0xffff0000, v114
    v_lshlrev_b32 v86, 16, v115
    v_and_b32 v87, 0xffff0000, v115
    v_pk_fma_f32 v[40:41], v[80:81], v[28:29], v[40:41] op_sel_hi:[1,0,1]
    v_pk_fma_f32 v[42:43], v[82:83], v[28:29], v[42:43] op_sel_hi:[1,0,1]
    v_pk_fma_f32 v[44:45], v[84:85], v[28:29], v[44:45] op_sel_hi:[1,0,1]
    v_pk_fma_f32 v[46:47], v[86:87], v[28:29], v[46:47] op_sel_hi:[1,0,1]
    s_nop 0
    v_permlane32_swap_b32 v40, v44
    v_permlane32_swap_b32 v41, v45
    v_permlane32_swap_b32 v42, v46
    v_permlane32_swap_b32 v43, v47
    v_pk_add_f32 v[40:41], v[40:41], v[44:45]
    v_pk_add_f32 v[42:43], v[42:43], v[46:47]
    s_nop 1
    v_permlane16_swap_b32 v40, v42
    v_permlane16_swap_b32 v41, v43
    v_pk_add_f32 v[40:41], v[40:41], v[42:43]
    s_nop 1
    v_add_f32_dpp v40, v40, v40 row_ror:8 row_mask:0xf bank_mask:0xf
    v_add_f32_dpp v41, v41, v41 row_ror:8 row_mask:0xf bank_mask:0xf
    ds_write_b64 v38, v[40:41] offset:0
    s_waitcnt lgkmcnt(0)
    s_barrier
    s_cmp_eq_u32 s40, 4
    s_cbranch_scc0 L_g2_nog
    v_lshlrev_b32 v32, 2, v1
    v_add_u32 v33, 152576, v32
    ds_read2st64_b32 v[40:41], v33 offset0:0 offset1:1
    ds_read2st64_b32 v[42:43], v33 offset0:2 offset1:3
    v_and_b32 v34, 3, v1
    v_lshlrev_b32 v34, 3, v34
    v_bfe_u32 v34, s3, v34, 8
    s_mov_b32 s59, 0xffffff00
    s_waitcnt lgkmcnt(0)
    v_pk_add_f32 v[40:41], v[40:41], v[42:43]
    v_add_f32 v40, v40, v41
    v_add_u32 v40, 0x80, v40
    v_and_or_b32 v40, v40, s59, v34
    buffer_store_dword v40, v32, s[20:23], s7 offen offset:0 sc0 sc1
L_g2_nog:
    s_branch L_qh_job
L_qh_nojob:
    s_barrier
L_qh_job:
    s_cmp_eq_u32 s45, 1
    s_cbranch_scc1 L_qh_side
    s_add_u32 m0, s50, 81920
    s_mul_i32 s60, s51, 5
    buffer_load_dwordx4 v220, s[8:11], s60 offen offset:0 lds
    s_waitcnt vmcnt(8)
    buffer_load_dwordx4 v221, s[8:11], s60 offen offset:1024 lds
    s_waitcnt vmcnt(8)
    buffer_load_dwordx4 v222, s[8:11], s60 offen offset:2048 lds
    s_waitcnt vmcnt(8)
    buffer_load_dwordx4 v223, s[8:11], s60 offen offset:3072 lds
    s_waitcnt vmcnt(8)
    s_add_u32 m0, s50, 98304
    s_mul_i32 s60, s51, 6
    buffer_load_dwordx4 v220, s[8:11], s60 offen offset:0 lds
    s_waitcnt vmcnt(8)
    buffer_load_dwordx4 v221, s[8:11], s60 offen offset:1024 lds
    s_waitcnt vmcnt(8)
    buffer_load_dwordx4 v222, s[8:11], s60 offen offset:2048 lds
    s_waitcnt vmcnt(8)
    buffer_load_dwordx4 v223, s[8:11], s60 offen offset:3072 lds
    s_waitcnt vmcnt(8)
    s_waitcnt vmcnt(8)
    s_barrier
    s_add_u32 m0, s50, 114688
    s_mul_i32 s60, s51, 7
    buffer_load_dwordx4 v220, s[8:11], s60 offen offset:0 lds
    s_waitcnt vmcnt(8)
    buffer_load_dwordx4 v221, s[8:11], s60 offen offset:1024 lds
    s_waitcnt vmcnt(8)
    buffer_load_dwordx4 v222, s[8:11], s60 offen offset:2048 lds
    s_waitcnt vmcnt(8)
    buffer_load_dwordx4 v223, s[8:11], s60 offen offset:3072 lds
    s_waitcnt vmcnt(8)
    s_add_u32 m0, s50, 131072
    s_mul_i32 s60, s51, 8
    buffer_load_dwordx4 v220, s[8:11], s60 offen offset:0 lds
    s_waitcnt vmcnt(8)
    buffer_load_dwordx4 v221, s[8:11], s60 offen offset:1024 lds
    s_waitcnt vmcnt(8)
    buffer_load_dwordx4 v222, s[8:11], s60 offen offset:2048 lds
    s_waitcnt vmcnt(8)
    buffer_load_dwordx4 v223, s[8:11], s60 offen offset:3072 lds
    s_waitcnt vmcnt(8)
    s_waitcnt vmcnt(4)
    s_barrier
    s_cmp_eq_u32 s40, 4
    s_cbranch_scc0 L_qh_nopw
    s_lshl_b32 s52, s41, 4
    s_add_u32 s52, s52, s42
    s_lshr_b32 s58, s52, 4
    s_and_b32 s60, s58, 3
    s_lshl_b32 s60, s60, 11
    s_and_b32 s59, s58, 4
    s_lshl_b32 s59, s59, 12
    s_add_u32 s60, s60, s59
    s_and_b32 s59, s58, 8
    s_lshl_b32 s59, s59, 10
    s_add_u32 s60, s60, s59
    s_xor_b32 s60, s60, s99
    s_add_u32 s60, s60, 29491200
    s_and_b32 s59, s52, 15
    s_lshl_b32 s59, s59, 7
    s_add_u32 s60, s60, s59
    v_lshl_add_u32 v249, v1, 2, s60
    v_not_b32 v251, v248
    s_mov_b32 exec_hi, 0
    buffer_store_dword v251, v249, s[20:23], 0 offen sc0 sc1
    s_mov_b32 exec_hi, -1
L_qh_nopw:
    s_add_u32 m0, s50, 0
    s_mul_i32 s60, s51, 9
    buffer_load_dwordx4 v220, s[8:11], s60 offen offset:0 lds
    buffer_load_dwordx4 v221, s[8:11], s60 offen offset:1024 lds
    buffer_load_dwordx4 v222, s[8:11], s60 offen offset:2048 lds
    buffer_load_dwordx4 v223, s[8:11], s60 offen offset:3072 lds
    s_cmp_eq_u32 s40, 5
    s_cbranch_scc0 L_qh_noones
    s_sub_u32 s52, s42, 10
    s_cmp_lt_u32 s52, 5
    s_cbranch_scc0 L_qh_noones
    s_lshl_b32 s53, s41, 2
    s_and_b32 s54, s53, 7
    s_mul_i32 s54, s54, 262144
    s_bfe_u32 s60, s53, 131075
    s_lshl_b32 s60, s60, 21
    s_add_u32 s54, s54, s60
    s_lshl_b32 s60, s53, 2
    s_xor_b32 s60, s60, s53
    s_and_b32 s60, s60, 32
    s_lshl_b32 s60, s60, 8
    s_xor_b32 s60, s60, s99
    s_add_u32 s54, s54, s60
    s_add_u32 s54, s54, 4194304
    s_lshl_b32 s52, s52, 7
    s_add_u32 s52, s52, s54
    s_add_u32 s52, s52, 245760
    v_lshrrev_b32 v10, 3, v1
    v_lshlrev_b32 v10, 18, v10
    v_and_b32 v11, 7, v1
    v_lshl_add_u32 v10, v11, 4, v10
    v_mov_b32 v12, 0x3f803f80
    v_mov_b32 v13, 0x3f803f80
    v_mov_b32 v14, 0x3f803f80
    v_mov_b32 v15, 0x3f803f80
    s_mov_b32 exec_hi, 0
    buffer_store_dwordx4 v[12:15], v10, s[20:23], s52 offen sc0 sc1
    s_mov_b64 exec, -1
L_qh_noones:
    s_waitcnt vmcnt(0)
    s_barrier
L_qh_def:
    v_lshrrev_b32 v10, 3, v1
    v_mul_u32_u24 v12, 1280, v10
    v_and_b32 v11, 7, v1
    v_lshl_add_u32 v12, v11, 4, v12
    v_mul_u32_u24 v245, 192, v10
    v_lshl_add_u32 v245, v11, 4, v245
    s_and_b32 s52, s40, 3
    s_mul_i32 s53, s52, 4608
    s_add_u32 s53, s53, 126976
    v_add_u32 v245, s53, v245
    v_bfe_u32 v10, v1, 2, 2
    v_mul_u32_u24 v246, 192, v10
    v_and_b32 v10, 48, v1
    v_lshl_add_u32 v246, v10, 1, v246
    v_and_b32 v10, 3, v1
    v_lshl_add_u32 v246, v10, 3, v246
    v_add_u32 v246, s53, v246
    s_lshl_b32 s53, s2, 2
    s_add_u32 s52, s52, s53
    s_mov_b32 s12, s36
    s_mov_b32 s13, s37
    s_mov_b32 s14, 2211840
    s_mov_b32 s15, 0x20000
    s_cmp_lt_u32 s52, 112
    s_cselect_b32 s16, s36, s38
    s_cselect_b32 s17, s37, s39
    s_cselect_b32 s18, s14, 819200
    s_mov_b32 s19, 0x20000
    s_add_u32 s53, s52, 0
    s_min_u32 s53, s53, 2959
    s_sub_u32 s54, s53, 2160
    s_cmp_lt_u32 s53, 2160
    s_cselect_b32 s53, s53, s54
    s_mov_b32 s57, 102400
    s_mov_b32 s58, 23265280
    s_cselect_b32 s57, 276480, s57
    s_cselect_b32 s58, 24084480, s58
    s_mul_i32 s54, s53, 6554
    s_lshr_b32 s54, s54, 16
    s_mul_i32 s55, s54, 10
    s_sub_u32 s55, s53, s55
    s_mul_i32 s56, s54, 10240
    s_lshl_b32 s59, s55, 7
    s_add_u32 s56, s56, s59
    v_add_u32 v239, s56, v12
    s_lshl_b32 s55, s55, 2
    v_lshrrev_b32 v10, 4, v1
    v_add_u32 v10, s55, v10
    v_mul_u32_u24 v11, 205, v10
    v_lshrrev_b32 v11, 10, v11
    v_mul_u32_u24 v13, 5, v11
    v_sub_u32 v10, v10, v13
    v_mul_lo_u32 v11, v11, s57
    v_lshl_add_u32 v10, v10, 10, v11
    v_and_b32 v11, 15, v1
    v_lshl_add_u32 v10, v11, 4, v10
    s_lshr_b32 s55, s54, 2
    s_mul_i32 s55, s55, 5120
    s_and_b32 s54, s54, 3
    s_lshl_b32 s54, s54, 8
    s_add_u32 s55, s55, s54
    s_add_u32 s55, s55, s58
    v_add_u32 v242, s55, v10
    s_add_u32 s53, s52, 1024
    s_min_u32 s53, s53, 2959
    s_sub_u32 s54, s53, 2160
    s_cmp_lt_u32 s53, 2160
    s_cselect_b32 s53, s53, s54
    s_mov_b32 s57, 102400
    s_mov_b32 s58, 23265280
    s_cselect_b32 s57, 276480, s57
    s_cselect_b32 s58, 24084480, s58
    s_mul_i32 s54, s53, 6554
    s_lshr_b32 s54, s54, 16
    s_mul_i32 s55, s54, 10
    s_sub_u32 s55, s53, s55
    s_mul_i32 s56, s54, 10240
    s_lshl_b32 s59, s55, 7
    s_add_u32 s56, s56, s59
    v_add_u32 v240, s56, v12
    s_lshl_b32 s55, s55, 2
    v_lshrrev_b32 v10, 4, v1
    v_add_u32 v10, s55, v10
    v_mul_u32_u24 v11, 205, v10
    v_lshrrev_b32 v11, 10, v11
    v_mul_u32_u24 v13, 5, v11
    v_sub_u32 v10, v10, v13
    v_mul_lo_u32 v11, v11, s57
    v_lshl_add_u32 v10, v10, 10, v11
    v_and_b32 v11, 15, v1
    v_lshl_add_u32 v10, v11, 4, v10
    s_lshr_b32 s55, s54, 2
    s_mul_i32 s55, s55, 5120
    s_and_b32 s54, s54, 3
    s_lshl_b32 s54, s54, 8
    s_add_u32 s55, s55, s54
    s_add_u32 s55, s55, s58
    v_add_u32 v243, s55, v10
    s_add_u32 s53, s52, 2048
    s_min_u32 s53, s53, 2959
    s_sub_u32 s54, s53, 2160
    s_cmp_lt_u32 s53, 2160
    s_cselect_b32 s53, s53, s54
    s_mov_b32 s57, 102400
    s_mov_b32 s58, 23265280
    s_cselect_b32 s57, 276480, s57
    s_cselect_b32 s58, 24084480, s58
    s_mul_i32 s54, s53, 6554
    s_lshr_b32 s54, s54, 16
    s_mul_i32 s55, s54, 10
    s_sub_u32 s55, s53, s55
    s_mul_i32 s56, s54, 10240
    s_lshl_b32 s59, s55, 7
    s_add_u32 s56, s56, s59
    v_add_u32 v241, s56, v12
    s_lshl_b32 s55, s55, 2
    v_lshrrev_b32 v10, 4, v1
    v_add_u32 v10, s55, v10
    v_mul_u32_u24 v11, 205, v10
    v_lshrrev_b32 v11, 10, v11
    v_mul_u32_u24 v13, 5, v11
    v_sub_u32 v10, v10, v13
    v_mul_lo_u32 v11, v11, s57
    v_lshl_add_u32 v10, v10, 10, v11
    v_and_b32 v11, 15, v1
    v_lshl_add_u32 v10, v11, 4, v10
    s_lshr_b32 s55, s54, 2
    s_mul_i32 s55, s55, 5120
    s_and_b32 s54, s54, 3
    s_lshl_b32 s54, s54, 8
    s_add_u32 s55, s55, s54
    s_add_u32 s55, s55, s58
    v_add_u32 v244, s55, v10
    s_branch L_q_setup
L_qh_side:
    s_lshr_b32 s63, s47, 2
    s_mul_i32 s63, s63, 20
    s_add_u32 s63, s63, 160
    s_and_b32 s4, s47, 3
    s_add_u32 s63, s63, s4
    s_and_b32 s4, s63, 3
    s_lshr_b32 s5, s63, 2
    s_cmp_lt_u32 s5, 30
    s_cselect_b32 s7, 0, 20
    s_cmp_lt_u32 s5, 40
    s_cselect_b32 s7, s7, -10
    s_add_u32 s5, s5, s7
    s_mul_i32 s7, s4, 15360
    s_lshl_b32 s6, s5, 8
    s_add_u32 s7, s7, s6
    s_mul_i32 s4, s4, 160
    s_sub_u32 s4, s4, 32
    v_lshrrev_b32 v2, 3, v0
    v_add_u32 v2, s4, v2
    v_and_b32 v7, 7, v0
    v_mul_u32_u24 v3, 7680, v2
    v_lshl_add_u32 v3, v7, 4, v3
    v_min_u32 v4, 4, v7
    v_lshl_add_u32 v4, v4, 5, v2
    v_lshlrev_b32 v4, 1, v4
    s_lshl_b32 s4, s5, 7
    buffer_load_ushort v30, v4, s[16:19], 0 offen
    buffer_load_dwordx4 v[96:99], v3, s[12:15], s4 offen offset:0
    buffer_load_dwordx4 v[116:119], v3, s[12:15], s4 offen offset:128
    buffer_load_dwordx4 v[136:139], v3, s[12:15], s4 offen offset:256
    buffer_load_dwordx4 v[156:159], v3, s[12:15], s4 offen offset:384
    buffer_load_dwordx4 v[176:179], v3, s[12:15], s4 offen offset:512
    s_add_u32 s4, s4, 245760
    buffer_load_dwordx4 v[100:103], v3, s[12:15], s4 offen offset:0
    buffer_load_dwordx4 v[120:123], v3, s[12:15], s4 offen offset:128
    buffer_load_dwordx4 v[140:143], v3, s[12:15], s4 offen offset:256
    buffer_load_dwordx4 v[160:163], v3, s[12:15], s4 offen offset:384
    buffer_load_dwordx4 v[180:183], v3, s[12:15], s4 offen offset:512
    s_add_u32 s4, s4, 245760
    buffer_load_dwordx4 v[104:107], v3, s[12:15], s4 offen offset:0
    buffer_load_dwordx4 v[124:127], v3, s[12:15], s4 offen offset:128
    buffer_load_dwordx4 v[144:147], v3, s[12:15], s4 offen offset:256
    buffer_load_dwordx4 v[164:167], v3, s[12:15], s4 offen offset:384
    buffer_load_dwordx4 v[184:187], v3, s[12:15], s4 offen offset:512
    s_add_u32 s4, s4, 245760
    buffer_load_dwordx4 v[108:111], v3, s[12:15], s4 offen offset:0
    buffer_load_dwordx4 v[128:131], v3, s[12:15], s4 offen offset:128
    buffer_load_dwordx4 v[148:151], v3, s[12:15], s4 offen offset:256
    buffer_load_dwordx4 v[168:171], v3, s[12:15], s4 offen offset:384
    buffer_load_dwordx4 v[188:191], v3, s[12:15], s4 offen offset:512
    s_add_u32 s4, s4, 245760
    buffer_load_dwordx4 v[112:115], v3, s[12:15], s4 offen offset:0
    buffer_load_dwordx4 v[132:135], v3, s[12:15], s4 offen offset:128
    buffer_load_dwordx4 v[152:155], v3, s[12:15], s4 offen offset:256
    buffer_load_dwordx4 v[172:175], v3, s[12:15], s4 offen offset:384
    buffer_load_dwordx4 v[192:195], v3, s[12:15], s4 offen offset:512
    s_waitcnt vmcnt(25)
    v_lshlrev_b32 v30, 16, v30
    v_mul_f32 v31, 0xbfb8aa3b, v30
    v_exp_f32 v31, v31
    v_lshrrev_b32 v38, 4, v1
    v_add_f32 v31, 1.0, v31
    v_rcp_f32 v31, v31
    v_lshlrev_b32 v38, 3, v38
    v_mul_f32 v30, v30, v31
    v_cvt_pk_bf16_f32 v30, v30, v30
    v_lshlrev_b32 v30, 16, v30
    v_lshl_add_u32 v38, v7, 5, v38
    s_lshl_b32 s55, s40, 8
    s_add_u32 s55, s55, 152576
    v_add_u32 v38, s55, v38
    ds_swizzle_b32 v20, v30 offset:24
    ds_swizzle_b32 v22, v30 offset:56
    ds_swizzle_b32 v24, v30 offset:88
    ds_swizzle_b32 v26, v30 offset:120
    ds_swizzle_b32 v28, v30 offset:152
    s_waitcnt vmcnt(24) lgkmcnt(0)
    v_lshlrev_b32 v80, 16, v96
    v_and_b32 v81, 0xffff0000, v96
    v_lshlrev_b32 v82, 16, v97
    v_and_b32 v83, 0xffff0000, v97
    v_lshlrev_b32 v84, 16, v98
    v_and_b32 v85, 0xffff0000, v98
    v_lshlrev_b32 v86, 16, v99
    v_and_b32 v87, 0xffff0000, v99
    v_pk_mul_f32 v[40:41], v[80:81], v[20:21] op_sel_hi:[1,0]
    v_pk_mul_f32 v[42:43], v[82:83], v[20:21] op_sel_hi:[1,0]
    v_pk_mul_f32 v[44:45], v[84:85], v[20:21] op_sel_hi:[1,0]
    v_pk_mul_f32 v[46:47], v[86:87], v[20:21] op_sel_hi:[1,0]
    s_waitcnt vmcnt(23)
    v_lshlrev_b32 v80, 16, v116
    v_and_b32 v81, 0xffff0000, v116
    v_lshlrev_b32 v82, 16, v117
    v_and_b32 v83, 0xffff0000, v117
    v_lshlrev_b32 v84, 16, v118
    v_and_b32 v85, 0xffff0000, v118
    v_lshlrev_b32 v86, 16, v119
    v_and_b32 v87, 0xffff0000, v119
    v_pk_mul_f32 v[48:49], v[80:81], v[20:21] op_sel_hi:[1,0]
    v_pk_mul_f32 v[50:51], v[82:83], v[20:21] op_sel_hi:[1,0]
    v_pk_mul_f32 v[52:53], v[84:85], v[20:21] op_sel_hi:[1,0]
    v_pk_mul_f32 v[54:55], v[86:87], v[20:21] op_sel_hi:[1,0]
    s_waitcnt vmcnt(22)
    v_lshlrev_b32 v80, 16, v136
    v_and_b32 v81, 0xffff0000, v136
    v_lshlrev_b32 v82, 16, v137
    v_and_b32 v83, 0xffff0000, v137
    v_lshlrev_b32 v84, 16, v138
    v_and_b32 v85, 0xffff0000, v138
    v_lshlrev_b32 v86, 16, v139
    v_and_b32 v87, 0xffff0000, v139
    v_pk_mul_f32 v[56:57], v[80:81], v[20:21] op_sel_hi:[1,0]
    v_pk_mul_f32 v[58:59], v[82:83], v[20:21] op_sel_hi:[1,0]
    v_pk_mul_f32 v[60:61], v[84:85], v[20:21] op_sel_hi:[1,0]
    v_pk_mul_f32 v[62:63], v[86:87], v[20:21] op_sel_hi:[1,0]
    s_waitcnt vmcnt(21)
    v_lshlrev_b32 v80, 16, v156
    v_and_b32 v81, 0xffff0000, v156
    v_lshlrev_b32 v82, 16, v157
    v_and_b32 v83, 0xffff0000, v157
    v_lshlrev_b32 v84, 16, v158
    v_and_b32 v85, 0xffff0000, v158
    v_lshlrev_b32 v86, 16, v159
    v_and_b32 v87, 0xffff0000, v159
    v_pk_mul_f32 v[64:65], v[80:81], v[20:21] op_sel_hi:[1,0]
    v_pk_mul_f32 v[66:67], v[82:83], v[20:21] op_sel_hi:[1,0]
    v_pk_mul_f32 v[68:69], v[84:85], v[20:21] op_sel_hi:[1,0]
    v_pk_mul_f32 v[70:71], v[86:87], v[20:21] op_sel_hi:[1,0]
    s_waitcnt vmcnt(20)
    v_lshlrev_b32 v80, 16, v176
    v_and_b32 v81, 0xffff0000, v176
    v_lshlrev_b32 v82, 16, v177
    v_and_b32 v83, 0xffff0000, v177
    v_lshlrev_b32 v84, 16, v178
    v_and_b32 v85, 0xffff0000, v178
    v_lshlrev_b32 v86, 16, v179
    v_and_b32 v87, 0xffff0000, v179
    v_pk_mul_f32 v[72:73], v[80:81], v[20:21] op_sel_hi:[1,0]
    v_pk_mul_f32 v[74:75], v[82:83], v[20:21] op_sel_hi:[1,0]
    v_pk_mul_f32 v[76:77], v[84:85], v[20:21] op_sel_hi:[1,0]
    v_pk_mul_f32 v[78:79], v[86:87], v[20:21] op_sel_hi:[1,0]
    s_waitcnt vmcnt(19)
    v_lshlrev_b32 v80, 16, v100
    v_and_b32 v81, 0xffff0000, v100
    v_lshlrev_b32 v82, 16, v101
    v_and_b32 v83, 0xffff0000, v101
    v_lshlrev_b32 v84, 16, v102
    v_and_b32 v85, 0xffff0000, v102
    v_lshlrev_b32 v86, 16, v103
    v_and_b32 v87, 0xffff0000, v103
    v_pk_fma_f32 v[40:41], v[80:81], v[22:23], v[40:41] op_sel_hi:[1,0,1]
    v_pk_fma_f32 v[42:43], v[82:83], v[22:23], v[42:43] op_sel_hi:[1,0,1]
    v_pk_fma_f32 v[44:45], v[84:85], v[22:23], v[44:45] op_sel_hi:[1,0,1]
    v_pk_fma_f32 v[46:47], v[86:87], v[22:23], v[46:47] op_sel_hi:[1,0,1]
    s_waitcnt vmcnt(18)
    v_lshlrev_b32 v80, 16, v120
    v_and_b32 v81, 0xffff0000, v120
    v_lshlrev_b32 v82, 16, v121
    v_and_b32 v83, 0xffff0000, v121
    v_lshlrev_b32 v84, 16, v122
    v_and_b32 v85, 0xffff0000, v122
    v_lshlrev_b32 v86, 16, v123
    v_and_b32 v87, 0xffff0000, v123
    v_pk_fma_f32 v[48:49], v[80:81], v[22:23], v[48:49] op_sel_hi:[1,0,1]
    v_pk_fma_f32 v[50:51], v[82:83], v[22:23], v[50:51] op_sel_hi:[1,0,1]
    v_pk_fma_f32 v[52:53], v[84:85], v[22:23], v[52:53] op_sel_hi:[1,0,1]
    v_pk_fma_f32 v[54:55], v[86:87], v[22:23], v[54:55] op_sel_hi:[1,0,1]
    s_waitcnt vmcnt(17)
    v_lshlrev_b32 v80, 16, v140
    v_and_b32 v81, 0xffff0000, v140
    v_lshlrev_b32 v82, 16, v141
    v_and_b32 v83, 0xffff0000, v141
    v_lshlrev_b32 v84, 16, v142
    v_and_b32 v85, 0xffff0000, v142
    v_lshlrev_b32 v86, 16, v143
    v_and_b32 v87, 0xffff0000, v143
    v_pk_fma_f32 v[56:57], v[80:81], v[22:23], v[56:57] op_sel_hi:[1,0,1]
    v_pk_fma_f32 v[58:59], v[82:83], v[22:23], v[58:59] op_sel_hi:[1,0,1]
    v_pk_fma_f32 v[60:61], v[84:85], v[22:23], v[60:61] op_sel_hi:[1,0,1]
    v_pk_fma_f32 v[62:63], v[86:87], v[22:23], v[62:63] op_sel_hi:[1,0,1]
    s_waitcnt vmcnt(16)
    v_lshlrev_b32 v80, 16, v160
    v_and_b32 v81, 0xffff0000, v160
    v_lshlrev_b32 v82, 16, v161
    v_and_b32 v83, 0xffff0000, v161
    v_lshlrev_b32 v84, 16, v162
    v_and_b32 v85, 0xffff0000, v162
    v_lshlrev_b32 v86, 16, v163
    v_and_b32 v87, 0xffff0000, v163
    v_pk_fma_f32 v[64:65], v[80:81], v[22:23], v[64:65] op_sel_hi:[1,0,1]
    v_pk_fma_f32 v[66:67], v[82:83], v[22:23], v[66:67] op_sel_hi:[1,0,1]
    v_pk_fma_f32 v[68:69], v[84:85], v[22:23], v[68:69] op_sel_hi:[1,0,1]
    v_pk_fma_f32 v[70:71], v[86:87], v[22:23], v[70:71] op_sel_hi:[1,0,1]
    s_waitcnt vmcnt(15)
    v_lshlrev_b32 v80, 16, v180
    v_and_b32 v81, 0xffff0000, v180
    v_lshlrev_b32 v82, 16, v181
    v_and_b32 v83, 0xffff0000, v181
    v_lshlrev_b32 v84, 16, v182
    v_and_b32 v85, 0xffff0000, v182
    v_lshlrev_b32 v86, 16, v183
    v_and_b32 v87, 0xffff0000, v183
    v_pk_fma_f32 v[72:73], v[80:81], v[22:23], v[72:73] op_sel_hi:[1,0,1]
    v_pk_fma_f32 v[74:75], v[82:83], v[22:23], v[74:75] op_sel_hi:[1,0,1]
    v_pk_fma_f32 v[76:77], v[84:85], v[22:23], v[76:77] op_sel_hi:[1,0,1]
    v_pk_fma_f32 v[78:79], v[86:87], v[22:23], v[78:79] op_sel_hi:[1,0,1]
    s_waitcnt vmcnt(14)
    v_lshlrev_b32 v80, 16, v104
    v_and_b32 v81, 0xffff0000, v104
    v_lshlrev_b32 v82, 16, v105
    v_and_b32 v83, 0xffff0000, v105
    v_lshlrev_b32 v84, 16, v106
    v_and_b32 v85, 0xffff0000, v106
    v_lshlrev_b32 v86, 16, v107
    v_and_b32 v87, 0xffff0000, v107
    v_pk_fma_f32 v[40:41], v[80:81], v[24:25], v[40:41] op_sel_hi:[1,0,1]
    v_pk_fma_f32 v[42:43], v[82:83], v[24:25], v[42:43] op_sel_hi:[1,0,1]
    v_pk_fma_f32 v[44:45], v[84:85], v[24:25], v[44:45] op_sel_hi:[1,0,1]
    v_pk_fma_f32 v[46:47], v[86:87], v[24:25], v[46:47] op_sel_hi:[1,0,1]
    s_waitcnt vmcnt(13)
    v_lshlrev_b32 v80, 16, v124
    v_and_b32 v81, 0xffff0000, v124
    v_lshlrev_b32 v82, 16, v125
    v_and_b32 v83, 0xffff0000, v125
    v_lshlrev_b32 v84, 16, v126
    v_and_b32 v85, 0xffff0000, v126
    v_lshlrev_b32 v86, 16, v127
    v_and_b32 v87, 0xffff0000, v127
    v_pk_fma_f32 v[48:49], v[80:81], v[24:25], v[48:49] op_sel_hi:[1,0,1]
    v_pk_fma_f32 v[50:51], v[82:83], v[24:25], v[50:51] op_sel_hi:[1,0,1]
    v_pk_fma_f32 v[52:53], v[84:85], v[24:25], v[52:53] op_sel_hi:[1,0,1]
    v_pk_fma_f32 v[54:55], v[86:87], v[24:25], v[54:55] op_sel_hi:[1,0,1]
    s_waitcnt vmcnt(12)
    v_lshlrev_b32 v80, 16, v144
    v_and_b32 v81, 0xffff0000, v144
    v_lshlrev_b32 v82, 16, v145
    v_and_b32 v83, 0xffff0000, v145
    v_lshlrev_b32 v84, 16, v146
    v_and_b32 v85, 0xffff0000, v146
    v_lshlrev_b32 v86, 16, v147
    v_and_b32 v87, 0xffff0000, v147
    v_pk_fma_f32 v[56:57], v[80:81], v[24:25], v[56:57] op_sel_hi:[1,0,1]
    v_pk_fma_f32 v[58:59], v[82:83], v[24:25], v[58:59] op_sel_hi:[1,0,1]
    v_pk_fma_f32 v[60:61], v[84:85], v[24:25], v[60:61] op_sel_hi:[1,0,1]
    v_pk_fma_f32 v[62:63], v[86:87], v[24:25], v[62:63] op_sel_hi:[1,0,1]
    s_waitcnt vmcnt(11)
    v_lshlrev_b32 v80, 16, v164
    v_and_b32 v81, 0xffff0000, v164
    v_lshlrev_b32 v82, 16, v165
    v_and_b32 v83, 0xffff0000, v165
    v_lshlrev_b32 v84, 16, v166
    v_and_b32 v85, 0xffff0000, v166
    v_lshlrev_b32 v86, 16, v167
    v_and_b32 v87, 0xffff0000, v167
    v_pk_fma_f32 v[64:65], v[80:81], v[24:25], v[64:65] op_sel_hi:[1,0,1]
    v_pk_fma_f32 v[66:67], v[82:83], v[24:25], v[66:67] op_sel_hi:[1,0,1]
    v_pk_fma_f32 v[68:69], v[84:85], v[24:25], v[68:69] op_sel_hi:[1,0,1]
    v_pk_fma_f32 v[70:71], v[86:87], v[24:25], v[70:71] op_sel_hi:[1,0,1]
    s_waitcnt vmcnt(10)
    v_lshlrev_b32 v80, 16, v184
    v_and_b32 v81, 0xffff0000, v184
    v_lshlrev_b32 v82, 16, v185
    v_and_b32 v83, 0xffff0000, v185
    v_lshlrev_b32 v84, 16, v186
    v_and_b32 v85, 0xffff0000, v186
    v_lshlrev_b32 v86, 16, v187
    v_and_b32 v87, 0xffff0000, v187
    v_pk_fma_f32 v[72:73], v[80:81], v[24:25], v[72:73] op_sel_hi:[1,0,1]
    v_pk_fma_f32 v[74:75], v[82:83], v[24:25], v[74:75] op_sel_hi:[1,0,1]
    v_pk_fma_f32 v[76:77], v[84:85], v[24:25], v[76:77] op_sel_hi:[1,0,1]
    v_pk_fma_f32 v[78:79], v[86:87], v[24:25], v[78:79] op_sel_hi:[1,0,1]
    s_waitcnt vmcnt(9)
    v_lshlrev_b32 v80, 16, v108
    v_and_b32 v81, 0xffff0000, v108
    v_lshlrev_b32 v82, 16, v109
    v_and_b32 v83, 0xffff0000, v109
    v_lshlrev_b32 v84, 16, v110
    v_and_b32 v85, 0xffff0000, v110
    v_lshlrev_b32 v86, 16, v111
    v_and_b32 v87, 0xffff0000, v111
    v_pk_fma_f32 v[40:41], v[80:81], v[26:27], v[40:41] op_sel_hi:[1,0,1]
    v_pk_fma_f32 v[42:43], v[82:83], v[26:27], v[42:43] op_sel_hi:[1,0,1]
    v_pk_fma_f32 v[44:45], v[84:85], v[26:27], v[44:45] op_sel_hi:[1,0,1]
    v_pk_fma_f32 v[46:47], v[86:87], v[26:27], v[46:47] op_sel_hi:[1,0,1]
    s_waitcnt vmcnt(8)
    v_lshlrev_b32 v80, 16, v128
    v_and_b32 v81, 0xffff0000, v128
    v_lshlrev_b32 v82, 16, v129
    v_and_b32 v83, 0xffff0000, v129
    v_lshlrev_b32 v84, 16, v130
    v_and_b32 v85, 0xffff0000, v130
    v_lshlrev_b32 v86, 16, v131
    v_and_b32 v87, 0xffff0000, v131
    v_pk_fma_f32 v[48:49], v[80:81], v[26:27], v[48:49] op_sel_hi:[1,0,1]
    v_pk_fma_f32 v[50:51], v[82:83], v[26:27], v[50:51] op_sel_hi:[1,0,1]
    v_pk_fma_f32 v[52:53], v[84:85], v[26:27], v[52:53] op_sel_hi:[1,0,1]
    v_pk_fma_f32 v[54:55], v[86:87], v[26:27], v[54:55] op_sel_hi:[1,0,1]
    s_waitcnt vmcnt(7)
    v_lshlrev_b32 v80, 16, v148
    v_and_b32 v81, 0xffff0000, v148
    v_lshlrev_b32 v82, 16, v149
    v_and_b32 v83, 0xffff0000, v149
    v_lshlrev_b32 v84, 16, v150
    v_and_b32 v85, 0xffff0000, v150
    v_lshlrev_b32 v86, 16, v151
    v_and_b32 v87, 0xffff0000, v151
    v_pk_fma_f32 v[56:57], v[80:81], v[26:27], v[56:57] op_sel_hi:[1,0,1]
    v_pk_fma_f32 v[58:59], v[82:83], v[26:27], v[58:59] op_sel_hi:[1,0,1]
    v_pk_fma_f32 v[60:61], v[84:85], v[26:27], v[60:61] op_sel_hi:[1,0,1]
    v_pk_fma_f32 v[62:63], v[86:87], v[26:27], v[62:63] op_sel_hi:[1,0,1]
    s_waitcnt vmcnt(6)
    v_lshlrev_b32 v80, 16, v168
    v_and_b32 v81, 0xffff0000, v168
    v_lshlrev_b32 v82, 16, v169
    v_and_b32 v83, 0xffff0000, v169
    v_lshlrev_b32 v84, 16, v170
    v_and_b32 v85, 0xffff0000, v170
    v_lshlrev_b32 v86, 16, v171
    v_and_b32 v87, 0xffff0000, v171
    v_pk_fma_f32 v[64:65], v[80:81], v[26:27], v[64:65] op_sel_hi:[1,0,1]
    v_pk_fma_f32 v[66:67], v[82:83], v[26:27], v[66:67] op_sel_hi:[1,0,1]
    v_pk_fma_f32 v[68:69], v[84:85], v[26:27], v[68:69] op_sel_hi:[1,0,1]
    v_pk_fma_f32 v[70:71], v[86:87], v[26:27], v[70:71] op_sel_hi:[1,0,1]
    s_waitcnt vmcnt(5)
    v_lshlrev_b32 v80, 16, v188
    v_and_b32 v81, 0xffff0000, v188
    v_lshlrev_b32 v82, 16, v189
    v_and_b32 v83, 0xffff0000, v189
    v_lshlrev_b32 v84, 16, v190
    v_and_b32 v85, 0xffff0000, v190
    v_lshlrev_b32 v86, 16, v191
    v_and_b32 v87, 0xffff0000, v191
    v_pk_fma_f32 v[72:73], v[80:81], v[26:27], v[72:73] op_sel_hi:[1,0,1]
    v_pk_fma_f32 v[74:75], v[82:83], v[26:27], v[74:75] op_sel_hi:[1,0,1]
    v_pk_fma_f32 v[76:77], v[84:85], v[26:27], v[76:77] op_sel_hi:[1,0,1]
    v_pk_fma_f32 v[78:79], v[86:87], v[26:27], v[78:79] op_sel_hi:[1,0,1]
    s_waitcnt vmcnt(4)
    v_lshlrev_b32 v80, 16, v112
    v_and_b32 v81, 0xffff0000, v112
    v_lshlrev_b32 v82, 16, v113
    v_and_b32 v83, 0xffff0000, v113
    v_lshlrev_b32 v84, 16, v114
    v_and_b32 v85, 0xffff0000, v114
    v_lshlrev_b32 v86, 16, v115
    v_and_b32 v87, 0xffff0000, v115
    v_pk_fma_f32 v[40:41], v[80:81], v[28:29], v[40:41] op_sel_hi:[1,0,1]
    v_pk_fma_f32 v[42:43], v[82:83], v[28:29], v[42:43] op_sel_hi:[1,0,1]
    v_pk_fma_f32 v[44:45], v[84:85], v[28:29], v[44:45] op_sel_hi:[1,0,1]
    v_pk_fma_f32 v[46:47], v[86:87], v[28:29], v[46:47] op_sel_hi:[1,0,1]
    s_waitcnt vmcnt(3)
    v_lshlrev_b32 v80, 16, v132
    v_and_b32 v81, 0xffff0000, v132
    v_lshlrev_b32 v82, 16, v133
    v_and_b32 v83, 0xffff0000, v133
    v_lshlrev_b32 v84, 16, v134
    v_and_b32 v85, 0xffff0000, v134
    v_lshlrev_b32 v86, 16, v135
    v_and_b32 v87, 0xffff0000, v135
    v_pk_fma_f32 v[48:49], v[80:81], v[28:29], v[48:49] op_sel_hi:[1,0,1]
    v_pk_fma_f32 v[50:51], v[82:83], v[28:29], v[50:51] op_sel_hi:[1,0,1]
    v_pk_fma_f32 v[52:53], v[84:85], v[28:29], v[52:53] op_sel_hi:[1,0,1]
    v_pk_fma_f32 v[54:55], v[86:87], v[28:29], v[54:55] op_sel_hi:[1,0,1]
    s_waitcnt vmcnt(2)
    v_lshlrev_b32 v80, 16, v152
    v_and_b32 v81, 0xffff0000, v152
    v_lshlrev_b32 v82, 16, v153
    v_and_b32 v83, 0xffff0000, v153
    v_lshlrev_b32 v84, 16, v154
    v_and_b32 v85, 0xffff0000, v154
    v_lshlrev_b32 v86, 16, v155
    v_and_b32 v87, 0xffff0000, v155
    v_pk_fma_f32 v[56:57], v[80:81], v[28:29], v[56:57] op_sel_hi:[1,0,1]
    v_pk_fma_f32 v[58:59], v[82:83], v[28:29], v[58:59] op_sel_hi:[1,0,1]
    v_pk_fma_f32 v[60:61], v[84:85], v[28:29], v[60:61] op_sel_hi:[1,0,1]
    v_pk_fma_f32 v[62:63], v[86:87], v[28:29], v[62:63] op_sel_hi:[1,0,1]
    s_waitcnt vmcnt(1)
    v_lshlrev_b32 v80, 16, v172
    v_and_b32 v81, 0xffff0000, v172
    v_lshlrev_b32 v82, 16, v173
    v_and_b32 v83, 0xffff0000, v173
    v_lshlrev_b32 v84, 16, v174
    v_and_b32 v85, 0xffff0000, v174
    v_lshlrev_b32 v86, 16, v175
    v_and_b32 v87, 0xffff0000, v175
    v_pk_fma_f32 v[64:65], v[80:81], v[28:29], v[64:65] op_sel_hi:[1,0,1]
    v_pk_fma_f32 v[66:67], v[82:83], v[28:29], v[66:67] op_sel_hi:[1,0,1]
    v_pk_fma_f32 v[68:69], v[84:85], v[28:29], v[68:69] op_sel_hi:[1,0,1]
    v_pk_fma_f32 v[70:71], v[86:87], v[28:29], v[70:71] op_sel_hi:[1,0,1]
    s_waitcnt vmcnt(0)
    v_lshlrev_b32 v80, 16, v192
    v_and_b32 v81, 0xffff0000, v192
    v_lshlrev_b32 v82, 16, v193
    v_and_b32 v83, 0xffff0000, v193
    v_lshlrev_b32 v84, 16, v194
    v_and_b32 v85, 0xffff0000, v194
    v_lshlrev_b32 v86, 16, v195
    v_and_b32 v87, 0xffff0000, v195
    v_pk_fma_f32 v[72:73], v[80:81], v[28:29], v[72:73] op_sel_hi:[1,0,1]
    v_pk_fma_f32 v[74:75], v[82:83], v[28:29], v[74:75] op_sel_hi:[1,0,1]
    v_pk_fma_f32 v[76:77], v[84:85], v[28:29], v[76:77] op_sel_hi:[1,0,1]
    v_pk_fma_f32 v[78:79], v[86:87], v[28:29], v[78:79] op_sel_hi:[1,0,1]
    s_nop 0
    v_permlane32_swap_b32 v40, v44
    v_permlane32_swap_b32 v41, v45
    v_permlane32_swap_b32 v42, v46
    v_permlane32_swap_b32 v43, v47
    v_pk_add_f32 v[40:41], v[40:41], v[44:45]
    v_pk_add_f32 v[42:43], v[42:43], v[46:47]
    s_nop 1
    v_permlane16_swap_b32 v40, v42
    v_permlane16_swap_b32 v41, v43
    v_pk_add_f32 v[40:41], v[40:41], v[42:43]
    s_nop 1
    v_add_f32_dpp v40, v40, v40 row_ror:8 row_mask:0xf bank_mask:0xf
    v_add_f32_dpp v41, v41, v41 row_ror:8 row_mask:0xf bank_mask:0xf
    ds_write_b64 v38, v[40:41] offset:0
    s_nop 0
    v_permlane32_swap_b32 v48, v52
    v_permlane32_swap_b32 v49, v53
    v_permlane32_swap_b32 v50, v54
    v_permlane32_swap_b32 v51, v55
    v_pk_add_f32 v[48:49], v[48:49], v[52:53]
    v_pk_add_f32 v[50:51], v[50:51], v[54:55]
    s_nop 1
    v_permlane16_swap_b32 v48, v50
    v_permlane16_swap_b32 v49, v51
    v_pk_add_f32 v[48:49], v[48:49], v[50:51]
    s_nop 1
    v_add_f32_dpp v48, v48, v48 row_ror:8 row_mask:0xf bank_mask:0xf
    v_add_f32_dpp v49, v49, v49 row_ror:8 row_mask:0xf bank_mask:0xf
    ds_write_b64 v38, v[48:49] offset:1024
    s_nop 0
    v_permlane32_swap_b32 v56, v60
    v_permlane32_swap_b32 v57, v61
    v_permlane32_swap_b32 v58, v62
    v_permlane32_swap_b32 v59, v63
    v_pk_add_f32 v[56:57], v[56:57], v[60:61]
    v_pk_add_f32 v[58:59], v[58:59], v[62:63]
    s_nop 1
    v_permlane16_swap_b32 v56, v58
    v_permlane16_swap_b32 v57, v59
    v_pk_add_f32 v[56:57], v[56:57], v[58:59]
    s_nop 1
    v_add_f32_dpp v56, v56, v56 row_ror:8 row_mask:0xf bank_mask:0xf
    v_add_f32_dpp v57, v57, v57 row_ror:8 row_mask:0xf bank_mask:0xf
    ds_write_b64 v38, v[56:57] offset:2048
    s_nop 0
    v_permlane32_swap_b32 v64, v68
    v_permlane32_swap_b32 v65, v69
    v_permlane32_swap_b32 v66, v70
    v_permlane32_swap_b32 v67, v71
    v_pk_add_f32 v[64:65], v[64:65], v[68:69]
    v_pk_add_f32 v[66:67], v[66:67], v[70:71]
    s_nop 1
    v_permlane16_swap_b32 v64, v66
    v_permlane16_swap_b32 v65, v67
    v_pk_add_f32 v[64:65], v[64:65], v[66:67]
    s_nop 1
    v_add_f32_dpp v64, v64, v64 row_ror:8 row_mask:0xf bank_mask:0xf
    v_add_f32_dpp v65, v65, v65 row_ror:8 row_mask:0xf bank_mask:0xf
    ds_write_b64 v38, v[64:65] offset:3072
    s_nop 0
    v_permlane32_swap_b32 v72, v76
    v_permlane32_swap_b32 v73, v77
    v_permlane32_swap_b32 v74, v78
    v_permlane32_swap_b32 v75, v79
    v_pk_add_f32 v[72:73], v[72:73], v[76:77]
    v_pk_add_f32 v[74:75], v[74:75], v[78:79]
    s_nop 1
    v_permlane16_swap_b32 v72, v74
    v_permlane16_swap_b32 v73, v75
    v_pk_add_f32 v[72:73], v[72:73], v[74:75]
    s_nop 1
    v_add_f32_dpp v72, v72, v72 row_ror:8 row_mask:0xf bank_mask:0xf
    v_add_f32_dpp v73, v73, v73 row_ror:8 row_mask:0xf bank_mask:0xf
    ds_write_b64 v38, v[72:73] offset:4096
    s_waitcnt lgkmcnt(0)
    s_barrier
    s_cmp_eq_u32 s40, 4
    s_cbranch_scc0 L_g3_nog
    v_lshlrev_b32 v32, 2, v1
    v_add_u32 v33, 153600, v32
    ds_read2st64_b32 v[40:41], v33 offset0:0 offset1:1
    ds_read2st64_b32 v[42:43], v33 offset0:2 offset1:3
    ds_read2st64_b32 v[44:45], v33 offset0:4 offset1:5
    ds_read2st64_b32 v[46:47], v33 offset0:6 offset1:7
    ds_read2st64_b32 v[48:49], v33 offset0:8 offset1:9
    ds_read2st64_b32 v[50:51], v33 offset0:10 offset1:11
    ds_read2st64_b32 v[52:53], v33 offset0:12 offset1:13
    ds_read2st64_b32 v[54:55], v33 offset0:14 offset1:15
    ds_read2st64_b32 v[56:57], v33 offset0:16 offset1:17
    ds_read2st64_b32 v[58:59], v33 offset0:18 offset1:19
    v_and_b32 v34, 3, v1
    v_lshlrev_b32 v34, 3, v34
    v_bfe_u32 v34, s3, v34, 8
    s_mov_b32 s59, 0xffffff00
    s_waitcnt lgkmcnt(0)
    v_pk_add_f32 v[40:41], v[40:41], v[42:43]
    v_add_f32 v40, v40, v41
    v_add_u32 v40, 0x80, v40
    v_and_or_b32 v40, v40, s59, v34
    buffer_store_dword v40, v32, s[20:23], s7 offen offset:0 sc0 sc1
    v_pk_add_f32 v[44:45], v[44:45], v[46:47]
    v_add_f32 v44, v44, v45
    v_add_u32 v44, 0x80, v44
    v_and_or_b32 v44, v44, s59, v34
    buffer_store_dword v44, v32, s[20:23], s7 offen offset:256 sc0 sc1
    v_pk_add_f32 v[48:49], v[48:49], v[50:51]
    v_add_f32 v48, v48, v49
    v_add_u32 v48, 0x80, v48
    v_and_or_b32 v48, v48, s59, v34
    buffer_store_dword v48, v32, s[20:23], s7 offen offset:512 sc0 sc1
    v_pk_add_f32 v[52:53], v[52:53], v[54:55]
    v_add_f32 v52, v52, v53
    v_add_u32 v52, 0x80, v52
    v_and_or_b32 v52, v52, s59, v34
    buffer_store_dword v52, v32, s[20:23], s7 offen offset:768 sc0 sc1
    v_pk_add_f32 v[56:57], v[56:57], v[58:59]
    v_add_f32 v56, v56, v57
    v_add_u32 v56, 0x80, v56
    v_and_or_b32 v56, v56, s59, v34
    buffer_store_dword v56, v32, s[20:23], s7 offen offset:1024 sc0 sc1
L_g3_nog:
    s_branch L_qh_def
L_q_vloop:
    v_lshrrev_b32 v2, 5, v1
    v_lshlrev_b32 v2, 11, v2
    v_and_b32 v3, 31, v1
    v_lshl_add_u32 v2, v3, 4, v2
    s_barrier
    buffer_load_dwordx4 v[128:131], v9, s[20:23], s57 offen offset:0 sc1
    buffer_load_dwordx4 v[132:135], v9, s[20:23], s57 offen offset:1024 sc1
    ds_read_b64_tr_b16 v[80:81], v4 offset:0
    ds_read_b64_tr_b16 v[82:83], v4 offset:1024
    ds_read_b64_tr_b16 v[84:85], v5 offset:0
    ds_read_b64_tr_b16 v[86:87], v5 offset:1024
    ds_read_b64_tr_b16 v[88:89], v6 offset:0
    ds_read_b64_tr_b16 v[90:91], v6 offset:1024
    ds_read_b64_tr_b16 v[92:93], v7 offset:0
    ds_read_b64_tr_b16 v[94:95], v7 offset:1024
    ds_read_b64_tr_b16 v[96:97], v4 offset:4096
    ds_read_b64_tr_b16 v[98:99], v4 offset:5120
    ds_read_b64_tr_b16 v[100:101], v5 offset:4096
    ds_read_b64_tr_b16 v[102:103], v5 offset:5120
    ds_read_b64_tr_b16 v[104:105], v6 offset:4096
    ds_read_b64_tr_b16 v[106:107], v6 offset:5120
    ds_read_b64_tr_b16 v[108:109], v7 offset:4096
    ds_read_b64_tr_b16 v[110:111], v7 offset:5120
    buffer_load_dwordx4 v[136:139], v9, s[20:23], s57 offen offset:2048 sc1
    buffer_load_dwordx4 v[140:143], v9, s[20:23], s57 offen offset:3072 sc1
    s_add_u32 s57, s57, 4096
    buffer_load_dwordx4 v[144:147], v9, s[20:23], s57 offen offset:0 sc1
    buffer_load_dwordx4 v[148:151], v9, s[20:23], s57 offen offset:1024 sc1
    buffer_load_dwordx4 v[152:155], v9, s[20:23], s57 offen offset:2048 sc1
    buffer_load_dwordx4 v[156:159], v9, s[20:23], s57 offen offset:3072 sc1
    s_waitcnt vmcnt(7) lgkmcnt(8)
    v_mfma_f32_32x32x16_bf16 v[16:31], v[128:131], v[80:83], 0
    ds_read_b64_tr_b16 v[80:81], v4 offset:8192
    ds_read_b64_tr_b16 v[82:83], v4 offset:9216
    v_mfma_f32_32x32x16_bf16 v[32:47], v[128:131], v[84:87], 0
    ds_read_b64_tr_b16 v[84:85], v5 offset:8192
    ds_read_b64_tr_b16 v[86:87], v5 offset:9216
    v_mfma_f32_32x32x16_bf16 v[48:63], v[128:131], v[88:91], 0
    ds_read_b64_tr_b16 v[88:89], v6 offset:8192
    ds_read_b64_tr_b16 v[90:91], v6 offset:9216
    v_mfma_f32_32x32x16_bf16 v[64:79], v[128:131], v[92:95], 0
    ds_read_b64_tr_b16 v[92:93], v7 offset:8192
    ds_read_b64_tr_b16 v[94:95], v7 offset:9216
    s_add_u32 s57, s57, 12288
    buffer_load_dwordx4 v[160:163], v9, s[20:23], s57 offen offset:0 sc1
    s_waitcnt vmcnt(7) lgkmcnt(8)
    v_mfma_f32_32x32x16_bf16 v[16:31], v[132:135], v[96:99], v[16:31]
    ds_read_b64_tr_b16 v[96:97], v4 offset:12288
    ds_read_b64_tr_b16 v[98:99], v4 offset:13312
    v_mfma_f32_32x32x16_bf16 v[32:47], v[132:135], v[100:103], v[32:47]
    ds_read_b64_tr_b16 v[100:101], v5 offset:12288
    ds_read_b64_tr_b16 v[102:103], v5 offset:13312
    v_mfma_f32_32x32x16_bf16 v[48:63], v[132:135], v[104:107], v[48:63]
    ds_read_b64_tr_b16 v[104:105], v6 offset:12288
    ds_read_b64_tr_b16 v[106:107], v6 offset:13312
    v_mfma_f32_32x32x16_bf16 v[64:79], v[132:135], v[108:111], v[64:79]
    ds_read_b64_tr_b16 v[108:109], v7 offset:12288
    ds_read_b64_tr_b16 v[110:111], v7 offset:13312
    buffer_load_dwordx4 v[164:167], v9, s[20:23], s57 offen offset:1024 sc1
    s_waitcnt vmcnt(7) lgkmcnt(8)
    v_mfma_f32_32x32x16_bf16 v[16:31], v[136:139], v[80:83], v[16:31]
    ds_read_b64_tr_b16 v[80:81], v4 offset:16384
    ds_read_b64_tr_b16 v[82:83], v4 offset:17408
    v_mfma_f32_32x32x16_bf16 v[32:47], v[136:139], v[84:87], v[32:47]
    ds_read_b64_tr_b16 v[84:85], v5 offset:16384
    ds_read_b64_tr_b16 v[86:87], v5 offset:17408
    v_mfma_f32_32x32x16_bf16 v[48:63], v[136:139], v[88:91], v[48:63]
    ds_read_b64_tr_b16 v[88:89], v6 offset:16384
    ds_read_b64_tr_b16 v[90:91], v6 offset:17408
    v_mfma_f32_32x32x16_bf16 v[64:79], v[136:139], v[92:95], v[64:79]
    ds_read_b64_tr_b16 v[92:93], v7 offset:16384
    ds_read_b64_tr_b16 v[94:95], v7 offset:17408
    buffer_load_dwordx4 v[168:171], v9, s[20:23], s57 offen offset:2048 sc1
    s_waitcnt vmcnt(7) lgkmcnt(8)
    v_mfma_f32_32x32x16_bf16 v[16:31], v[140:143], v[96:99], v[16:31]
    ds_read_b64_tr_b16 v[96:97], v4 offset:20480
    ds_read_b64_tr_b16 v[98:99], v4 offset:21504
    v_mfma_f32_32x32x16_bf16 v[32:47], v[140:143], v[100:103], v[32:47]
    ds_read_b64_tr_b16 v[100:101], v5 offset:20480
    ds_read_b64_tr_b16 v[102:103], v5 offset:21504
    v_mfma_f32_32x32x16_bf16 v[48:63], v[140:143], v[104:107], v[48:63]
    ds_read_b64_tr_b16 v[104:105], v6 offset:20480
    ds_read_b64_tr_b16 v[106:107], v6 offset:21504
    v_mfma_f32_32x32x16_bf16 v[64:79], v[140:143], v[108:111], v[64:79]
    ds_read_b64_tr_b16 v[108:109], v7 offset:20480
    ds_read_b64_tr_b16 v[110:111], v7 offset:21504
    buffer_load_dwordx4 v[172:175], v9, s[20:23], s57 offen offset:3072 sc1
    s_waitcnt vmcnt(7) lgkmcnt(8)
    v_mfma_f32_32x32x16_bf16 v[16:31], v[144:147], v[80:83], v[16:31]
    ds_read_b64_tr_b16 v[80:81], v4 offset:24576
    ds_read_b64_tr_b16 v[82:83], v4 offset:25600
    v_mfma_f32_32x32x16_bf16 v[32:47], v[144:147], v[84:87], v[32:47]
    ds_read_b64_tr_b16 v[84:85], v5 offset:24576
    ds_read_b64_tr_b16 v[86:87], v5 offset:25600
    s_add_u32 s57, s57, 4096
    buffer_load_dwordx4 v[176:179], v9, s[20:23], s57 offen offset:0 sc1
    v_mfma_f32_32x32x16_bf16 v[48:63], v[144:147], v[88:91], v[48:63]
    ds_read_b64_tr_b16 v[88:89], v6 offset:24576
    ds_read_b64_tr_b16 v[90:91], v6 offset:25600
    v_mfma_f32_32x32x16_bf16 v[64:79], v[144:147], v[92:95], v[64:79]
    ds_read_b64_tr_b16 v[92:93], v7 offset:24576
    ds_read_b64_tr_b16 v[94:95], v7 offset:25600
    buffer_load_dwordx4 v[180:183], v9, s[20:23], s57 offen offset:1024 sc1
    s_waitcnt vmcnt(8) lgkmcnt(8)
    v_mfma_f32_32x32x16_bf16 v[16:31], v[148:151], v[96:99], v[16:31]
    ds_read_b64_tr_b16 v[96:97], v4 offset:28672
    ds_read_b64_tr_b16 v[98:99], v4 offset:29696
    v_mfma_f32_32x32x16_bf16 v[32:47], v[148:151], v[100:103], v[32:47]
    ds_read_b64_tr_b16 v[100:101], v5 offset:28672
    ds_read_b64_tr_b16 v[102:103], v5 offset:29696
    v_mfma_f32_32x32x16_bf16 v[48:63], v[148:151], v[104:107], v[48:63]
    ds_read_b64_tr_b16 v[104:105], v6 offset:28672
    ds_read_b64_tr_b16 v[106:107], v6 offset:29696
    v_mfma_f32_32x32x16_bf16 v[64:79], v[148:151], v[108:111], v[64:79]
    ds_read_b64_tr_b16 v[108:109], v7 offset:28672
    ds_read_b64_tr_b16 v[110:111], v7 offset:29696
    buffer_load_dwordx4 v[184:187], v9, s[20:23], s57 offen offset:2048 sc1
    s_waitcnt vmcnt(8) lgkmcnt(8)
    v_mfma_f32_32x32x16_bf16 v[16:31], v[152:155], v[80:83], v[16:31]
    ds_read_b64_tr_b16 v[80:81], v4 offset:32768
    ds_read_b64_tr_b16 v[82:83], v4 offset:33792
    v_mfma_f32_32x32x16_bf16 v[32:47], v[152:155], v[84:87], v[32:47]
    ds_read_b64_tr_b16 v[84:85], v5 offset:32768
    ds_read_b64_tr_b16 v[86:87], v5 offset:33792
    buffer_load_dwordx4 v[188:191], v9, s[20:23], s57 offen offset:3072 sc1
    v_mfma_f32_32x32x16_bf16 v[48:63], v[152:155], v[88:91], v[48:63]
    ds_read_b64_tr_b16 v[88:89], v6 offset:32768
    ds_read_b64_tr_b16 v[90:91], v6 offset:33792
    v_mfma_f32_32x32x16_bf16 v[64:79], v[152:155], v[92:95], v[64:79]
    ds_read_b64_tr_b16 v[92:93], v7 offset:32768
    ds_read_b64_tr_b16 v[94:95], v7 offset:33792
    s_add_u32 s57, s57, 12288
    buffer_load_dwordx4 v[192:195], v9, s[20:23], s57 offen offset:0 sc1
    s_waitcnt vmcnt(9) lgkmcnt(8)
    v_mfma_f32_32x32x16_bf16 v[16:31], v[156:159], v[96:99], v[16:31]
    ds_read_b64_tr_b16 v[96:97], v4 offset:36864
    ds_read_b64_tr_b16 v[98:99], v4 offset:37888
    v_mfma_f32_32x32x16_bf16 v[32:47], v[156:159], v[100:103], v[32:47]
    ds_read_b64_tr_b16 v[100:101], v5 offset:36864
    ds_read_b64_tr_b16 v[102:103], v5 offset:37888
    v_mfma_f32_32x32x16_bf16 v[48:63], v[156:159], v[104:107], v[48:63]
    ds_read_b64_tr_b16 v[104:105], v6 offset:36864
    ds_read_b64_tr_b16 v[106:107], v6 offset:37888
    v_mfma_f32_32x32x16_bf16 v[64:79], v[156:159], v[108:111], v[64:79]
    ds_read_b64_tr_b16 v[108:109], v7 offset:36864
    ds_read_b64_tr_b16 v[110:111], v7 offset:37888
    buffer_load_dwordx4 v[196:199], v9, s[20:23], s57 offen offset:1024 sc1
    s_waitcnt vmcnt(9) lgkmcnt(8)
    v_mfma_f32_32x32x16_bf16 v[16:31], v[160:163], v[80:83], v[16:31]
    ds_read_b64_tr_b16 v[80:81], v4 offset:40960
    ds_read_b64_tr_b16 v[82:83], v4 offset:41984
    v_mfma_f32_32x32x16_bf16 v[32:47], v[160:163], v[84:87], v[32:47]
    ds_read_b64_tr_b16 v[84:85], v5 offset:40960
    ds_read_b64_tr_b16 v[86:87], v5 offset:41984
    buffer_load_dwordx4 v[200:203], v9, s[20:23], s57 offen offset:2048 sc1
    v_mfma_f32_32x32x16_bf16 v[48:63], v[160:163], v[88:91], v[48:63]
    ds_read_b64_tr_b16 v[88:89], v6 offset:40960
    ds_read_b64_tr_b16 v[90:91], v6 offset:41984
    v_mfma_f32_32x32x16_bf16 v[64:79], v[160:163], v[92:95], v[64:79]
    ds_read_b64_tr_b16 v[92:93], v7 offset:40960
    ds_read_b64_tr_b16 v[94:95], v7 offset:41984
    buffer_load_dwordx4 v[204:207], v9, s[20:23], s57 offen offset:3072 sc1
    s_waitcnt vmcnt(10) lgkmcnt(8)
    v_mfma_f32_32x32x16_bf16 v[16:31], v[164:167], v[96:99], v[16:31]
    ds_read_b64_tr_b16 v[96:97], v4 offset:45056
    ds_read_b64_tr_b16 v[98:99], v4 offset:46080
    v_mfma_f32_32x32x16_bf16 v[32:47], v[164:167], v[100:103], v[32:47]
    ds_read_b64_tr_b16 v[100:101], v5 offset:45056
    ds_read_b64_tr_b16 v[102:103], v5 offset:46080
    v_mfma_f32_32x32x16_bf16 v[48:63], v[164:167], v[104:107], v[48:63]
    ds_read_b64_tr_b16 v[104:105], v6 offset:45056
    ds_read_b64_tr_b16 v[106:107], v6 offset:46080
    v_mfma_f32_32x32x16_bf16 v[64:79], v[164:167], v[108:111], v[64:79]
    ds_read_b64_tr_b16 v[108:109], v7 offset:45056
    ds_read_b64_tr_b16 v[110:111], v7 offset:46080
    s_add_u32 s57, s57, 4096
    buffer_load_dwordx4 v[208:211], v9, s[20:23], s57 offen offset:0 sc1
    s_waitcnt vmcnt(10) lgkmcnt(8)
    v_mfma_f32_32x32x16_bf16 v[16:31], v[168:171], v[80:83], v[16:31]
    ds_read_b64_tr_b16 v[80:81], v4 offset:49152
    ds_read_b64_tr_b16 v[82:83], v4 offset:50176
    v_mfma_f32_32x32x16_bf16 v[32:47], v[168:171], v[84:87], v[32:47]
    ds_read_b64_tr_b16 v[84:85], v5 offset:49152
    ds_read_b64_tr_b16 v[86:87], v5 offset:50176
    buffer_load_dwordx4 v[212:215], v9, s[20:23], s57 offen offset:1024 sc1
    v_mfma_f32_32x32x16_bf16 v[48:63], v[168:171], v[88:91], v[48:63]
    ds_read_b64_tr_b16 v[88:89], v6 offset:49152
    ds_read_b64_tr_b16 v[90:91], v6 offset:50176
    v_mfma_f32_32x32x16_bf16 v[64:79], v[168:171], v[92:95], v[64:79]
    ds_read_b64_tr_b16 v[92:93], v7 offset:49152
    ds_read_b64_tr_b16 v[94:95], v7 offset:50176
    buffer_load_dwordx4 v[128:131], v9, s[20:23], s57 offen offset:2048 sc1
    s_waitcnt vmcnt(11) lgkmcnt(8)
    v_mfma_f32_32x32x16_bf16 v[16:31], v[172:175], v[96:99], v[16:31]
    ds_read_b64_tr_b16 v[96:97], v4 offset:53248
    ds_read_b64_tr_b16 v[98:99], v4 offset:54272
    v_mfma_f32_32x32x16_bf16 v[32:47], v[172:175], v[100:103], v[32:47]
    ds_read_b64_tr_b16 v[100:101], v5 offset:53248
    ds_read_b64_tr_b16 v[102:103], v5 offset:54272
    v_mfma_f32_32x32x16_bf16 v[48:63], v[172:175], v[104:107], v[48:63]
    ds_read_b64_tr_b16 v[104:105], v6 offset:53248
    ds_read_b64_tr_b16 v[106:107], v6 offset:54272
    v_mfma_f32_32x32x16_bf16 v[64:79], v[172:175], v[108:111], v[64:79]
    ds_read_b64_tr_b16 v[108:109], v7 offset:53248
    ds_read_b64_tr_b16 v[110:111], v7 offset:54272
    buffer_load_dwordx4 v[132:135], v9, s[20:23], s57 offen offset:3072 sc1
    s_waitcnt vmcnt(11) lgkmcnt(8)
    v_mfma_f32_32x32x16_bf16 v[16:31], v[176:179], v[80:83], v[16:31]
    ds_read_b64_tr_b16 v[80:81], v4 offset:57344
    ds_read_b64_tr_b16 v[82:83], v4 offset:58368
    v_mfma_f32_32x32x16_bf16 v[32:47], v[176:179], v[84:87], v[32:47]
    ds_read_b64_tr_b16 v[84:85], v5 offset:57344
    ds_read_b64_tr_b16 v[86:87], v5 offset:58368
    s_add_u32 s57, s57, 12288
    buffer_load_dwordx4 v[136:139], v9, s[20:23], s57 offen offset:0 sc1
    v_mfma_f32_32x32x16_bf16 v[48:63], v[176:179], v[88:91], v[48:63]
    ds_read_b64_tr_b16 v[88:89], v6 offset:57344
    ds_read_b64_tr_b16 v[90:91], v6 offset:58368
    v_mfma_f32_32x32x16_bf16 v[64:79], v[176:179], v[92:95], v[64:79]
    ds_read_b64_tr_b16 v[92:93], v7 offset:57344
    ds_read_b64_tr_b16 v[94:95], v7 offset:58368
    buffer_load_dwordx4 v[140:143], v9, s[20:23], s57 offen offset:1024 sc1
    s_waitcnt vmcnt(12) lgkmcnt(8)
    v_mfma_f32_32x32x16_bf16 v[16:31], v[180:183], v[96:99], v[16:31]
    ds_read_b64_tr_b16 v[96:97], v4 offset:61440
    ds_read_b64_tr_b16 v[98:99], v4 offset:62464
    v_mfma_f32_32x32x16_bf16 v[32:47], v[180:183], v[100:103], v[32:47]
    ds_read_b64_tr_b16 v[100:101], v5 offset:61440
    ds_read_b64_tr_b16 v[102:103], v5 offset:62464
    v_mfma_f32_32x32x16_bf16 v[48:63], v[180:183], v[104:107], v[48:63]
    ds_read_b64_tr_b16 v[104:105], v6 offset:61440
    ds_read_b64_tr_b16 v[106:107], v6 offset:62464
    v_mfma_f32_32x32x16_bf16 v[64:79], v[180:183], v[108:111], v[64:79]
    ds_read_b64_tr_b16 v[108:109], v7 offset:61440
    ds_read_b64_tr_b16 v[110:111], v7 offset:62464
    buffer_load_dwordx4 v[144:147], v9, s[20:23], s57 offen offset:2048 sc1
    s_waitcnt vmcnt(12) lgkmcnt(8)
    v_mfma_f32_32x32x16_bf16 v[16:31], v[184:187], v[80:83], v[16:31]
    v_add_u32 v4, 65536, v4
    ds_read_b64_tr_b16 v[80:81], v4 offset:0
    ds_read_b64_tr_b16 v[82:83], v4 offset:1024
    v_mfma_f32_32x32x16_bf16 v[32:47], v[184:187], v[84:87], v[32:47]
    v_add_u32 v5, 65536, v5
    ds_read_b64_tr_b16 v[84:85], v5 offset:0
    ds_read_b64_tr_b16 v[86:87], v5 offset:1024
    buffer_load_dwordx4 v[148:151], v9, s[20:23], s57 offen offset:3072 sc1
    v_mfma_f32_32x32x16_bf16 v[48:63], v[184:187], v[88:91], v[48:63]
    v_add_u32 v6, 65536, v6
    ds_read_b64_tr_b16 v[88:89], v6 offset:0
    ds_read_b64_tr_b16 v[90:91], v6 offset:1024
    v_mfma_f32_32x32x16_bf16 v[64:79], v[184:187], v[92:95], v[64:79]
    v_add_u32 v7, 65536, v7
    ds_read_b64_tr_b16 v[92:93], v7 offset:0
    ds_read_b64_tr_b16 v[94:95], v7 offset:1024
    s_add_u32 s57, s57, 4096
    buffer_load_dwordx4 v[152:155], v9, s[20:23], s57 offen offset:0 sc1
    s_waitcnt vmcnt(13) lgkmcnt(8)
    v_mfma_f32_32x32x16_bf16 v[16:31], v[188:191], v[96:99], v[16:31]
    ds_read_b64_tr_b16 v[96:97], v4 offset:4096
    ds_read_b64_tr_b16 v[98:99], v4 offset:5120
    v_mfma_f32_32x32x16_bf16 v[32:47], v[188:191], v[100:103], v[32:47]
    ds_read_b64_tr_b16 v[100:101], v5 offset:4096
    ds_read_b64_tr_b16 v[102:103], v5 offset:5120
    v_mfma_f32_32x32x16_bf16 v[48:63], v[188:191], v[104:107], v[48:63]
    ds_read_b64_tr_b16 v[104:105], v6 offset:4096
    ds_read_b64_tr_b16 v[106:107], v6 offset:5120
    v_mfma_f32_32x32x16_bf16 v[64:79], v[188:191], v[108:111], v[64:79]
    ds_read_b64_tr_b16 v[108:109], v7 offset:4096
    ds_read_b64_tr_b16 v[110:111], v7 offset:5120
    buffer_load_dwordx4 v[156:159], v9, s[20:23], s57 offen offset:1024 sc1
    s_waitcnt vmcnt(13) lgkmcnt(8)
    v_mfma_f32_32x32x16_bf16 v[16:31], v[192:195], v[80:83], v[16:31]
    ds_read_b64_tr_b16 v[80:81], v4 offset:8192
    ds_read_b64_tr_b16 v[82:83], v4 offset:9216
    v_mfma_f32_32x32x16_bf16 v[32:47], v[192:195], v[84:87], v[32:47]
    ds_read_b64_tr_b16 v[84:85], v5 offset:8192
    ds_read_b64_tr_b16 v[86:87], v5 offset:9216
    buffer_load_dwordx4 v[160:163], v9, s[20:23], s57 offen offset:2048 sc1
    v_mfma_f32_32x32x16_bf16 v[48:63], v[192:195], v[88:91], v[48:63]
    ds_read_b64_tr_b16 v[88:89], v6 offset:8192
    ds_read_b64_tr_b16 v[90:91], v6 offset:9216
    v_mfma_f32_32x32x16_bf16 v[64:79], v[192:195], v[92:95], v[64:79]
    ds_read_b64_tr_b16 v[92:93], v7 offset:8192
    ds_read_b64_tr_b16 v[94:95], v7 offset:9216
    buffer_load_dwordx4 v[164:167], v9, s[20:23], s57 offen offset:3072 sc1
    s_waitcnt vmcnt(14) lgkmcnt(8)
    v_mfma_f32_32x32x16_bf16 v[16:31], v[196:199], v[96:99], v[16:31]
    ds_read_b64_tr_b16 v[96:97], v4 offset:12288
    ds_read_b64_tr_b16 v[98:99], v4 offset:13312
    v_mfma_f32_32x32x16_bf16 v[32:47], v[196:199], v[100:103], v[32:47]
    ds_read_b64_tr_b16 v[100:101], v5 offset:12288
    ds_read_b64_tr_b16 v[102:103], v5 offset:13312
    v_mfma_f32_32x32x16_bf16 v[48:63], v[196:199], v[104:107], v[48:63]
    ds_read_b64_tr_b16 v[104:105], v6 offset:12288
    ds_read_b64_tr_b16 v[106:107], v6 offset:13312
    v_mfma_f32_32x32x16_bf16 v[64:79], v[196:199], v[108:111], v[64:79]
    ds_read_b64_tr_b16 v[108:109], v7 offset:12288
    ds_read_b64_tr_b16 v[110:111], v7 offset:13312
    s_add_u32 s57, s57, 12288
    buffer_load_dwordx4 v[168:171], v9, s[20:23], s57 offen offset:0 sc1
    s_waitcnt vmcnt(14) lgkmcnt(8)
    s_barrier
    v_mfma_f32_32x32x16_bf16 v[16:31], v[200:203], v[80:83], v[16:31]
    ds_read_b64_tr_b16 v[80:81], v4 offset:16384
    ds_read_b64_tr_b16 v[82:83], v4 offset:17408
    v_mfma_f32_32x32x16_bf16 v[32:47], v[200:203], v[84:87], v[32:47]
    ds_read_b64_tr_b16 v[84:85], v5 offset:16384
    ds_read_b64_tr_b16 v[86:87], v5 offset:17408
    buffer_load_dwordx4 v[172:175], v9, s[20:23], s57 offen offset:1024 sc1
    v_mfma_f32_32x32x16_bf16 v[48:63], v[200:203], v[88:91], v[48:63]
    ds_read_b64_tr_b16 v[88:89], v6 offset:16384
    ds_read_b64_tr_b16 v[90:91], v6 offset:17408
    v_mfma_f32_32x32x16_bf16 v[64:79], v[200:203], v[92:95], v[64:79]
    ds_read_b64_tr_b16 v[92:93], v7 offset:16384
    ds_read_b64_tr_b16 v[94:95], v7 offset:17408
    buffer_load_dwordx4 v[176:179], v9, s[20:23], s57 offen offset:2048 sc1
    s_waitcnt vmcnt(15) lgkmcnt(8)
    v_mfma_f32_32x32x16_bf16 v[16:31], v[204:207], v[96:99], v[16:31]
    ds_read_b64_tr_b16 v[96:97], v4 offset:20480
    ds_read_b64_tr_b16 v[98:99], v4 offset:21504
    v_mfma_f32_32x32x16_bf16 v[32:47], v[204:207], v[100:103], v[32:47]
    ds_read_b64_tr_b16 v[100:101], v5 offset:20480
    ds_read_b64_tr_b16 v[102:103], v5 offset:21504
    v_mfma_f32_32x32x16_bf16 v[48:63], v[204:207], v[104:107], v[48:63]
    ds_read_b64_tr_b16 v[104:105], v6 offset:20480
    ds_read_b64_tr_b16 v[106:107], v6 offset:21504
    v_mfma_f32_32x32x16_bf16 v[64:79], v[204:207], v[108:111], v[64:79]
    ds_read_b64_tr_b16 v[108:109], v7 offset:20480
    ds_read_b64_tr_b16 v[110:111], v7 offset:21504
    buffer_load_dwordx4 v[180:183], v9, s[20:23], s57 offen offset:3072 sc1
    s_waitcnt vmcnt(15) lgkmcnt(8)
    v_mfma_f32_32x32x16_bf16 v[16:31], v[208:211], v[80:83], v[16:31]
    ds_read_b64_tr_b16 v[80:81], v4 offset:24576
    ds_read_b64_tr_b16 v[82:83], v4 offset:25600
    v_mfma_f32_32x32x16_bf16 v[32:47], v[208:211], v[84:87], v[32:47]
    ds_read_b64_tr_b16 v[84:85], v5 offset:24576
    ds_read_b64_tr_b16 v[86:87], v5 offset:25600
    s_add_u32 s57, s57, 4096
    buffer_load_dwordx4 v[184:187], v9, s[20:23], s57 offen offset:0 sc1
    v_mfma_f32_32x32x16_bf16 v[48:63], v[208:211], v[88:91], v[48:63]
    ds_read_b64_tr_b16 v[88:89], v6 offset:24576
    ds_read_b64_tr_b16 v[90:91], v6 offset:25600
    v_mfma_f32_32x32x16_bf16 v[64:79], v[208:211], v[92:95], v[64:79]
    ds_read_b64_tr_b16 v[92:93], v7 offset:24576
    ds_read_b64_tr_b16 v[94:95], v7 offset:25600
    buffer_load_dwordx4 v[188:191], v9, s[20:23], s57 offen offset:1024 sc1
    s_waitcnt vmcnt(16) lgkmcnt(8)
    v_mfma_f32_32x32x16_bf16 v[16:31], v[212:215], v[96:99], v[16:31]
    ds_read_b64_tr_b16 v[96:97], v4 offset:28672
    ds_read_b64_tr_b16 v[98:99], v4 offset:29696
    v_mfma_f32_32x32x16_bf16 v[32:47], v[212:215], v[100:103], v[32:47]
    ds_read_b64_tr_b16 v[100:101], v5 offset:28672
    ds_read_b64_tr_b16 v[102:103], v5 offset:29696
    v_mfma_f32_32x32x16_bf16 v[48:63], v[212:215], v[104:107], v[48:63]
    ds_read_b64_tr_b16 v[104:105], v6 offset:28672
    ds_read_b64_tr_b16 v[106:107], v6 offset:29696
    v_mfma_f32_32x32x16_bf16 v[64:79], v[212:215], v[108:111], v[64:79]
    ds_read_b64_tr_b16 v[108:109], v7 offset:28672
    ds_read_b64_tr_b16 v[110:111], v7 offset:29696
    buffer_load_dwordx4 v[192:195], v9, s[20:23], s57 offen offset:2048 sc1
    s_waitcnt vmcnt(16) lgkmcnt(8)
    v_mfma_f32_32x32x16_bf16 v[16:31], v[128:131], v[80:83], v[16:31]
    ds_read_b64_tr_b16 v[80:81], v4 offset:32768
    ds_read_b64_tr_b16 v[82:83], v4 offset:33792
    v_mfma_f32_32x32x16_bf16 v[32:47], v[128:131], v[84:87], v[32:47]
    ds_read_b64_tr_b16 v[84:85], v4 offset:36864
    ds_read_b64_tr_b16 v[86:87], v4 offset:37888
    buffer_load_dwordx4 v[196:199], v9, s[20:23], s57 offen offset:3072 sc1
    v_mfma_f32_32x32x16_bf16 v[48:63], v[128:131], v[88:91], v[48:63]
    ds_read_b64_tr_b16 v[88:89], v4 offset:40960
    ds_read_b64_tr_b16 v[90:91], v4 offset:41984
    v_mfma_f32_32x32x16_bf16 v[64:79], v[128:131], v[92:95], v[64:79]
    ds_read_b64_tr_b16 v[92:93], v4 offset:45056
    ds_read_b64_tr_b16 v[94:95], v4 offset:46080
    s_waitcnt vmcnt(16) lgkmcnt(8)
    v_mfma_f32_32x32x16_bf16 v[16:31], v[132:135], v[96:99], v[16:31]
    ds_read_b64_tr_b16 v[96:97], v4 offset:49152
    ds_read_b64_tr_b16 v[98:99], v4 offset:50176
    v_mfma_f32_32x32x16_bf16 v[32:47], v[132:135], v[100:103], v[32:47]
    ds_read_b64_tr_b16 v[100:101], v4 offset:53248
    ds_read_b64_tr_b16 v[102:103], v4 offset:54272
    v_mfma_f32_32x32x16_bf16 v[48:63], v[132:135], v[104:107], v[48:63]
    ds_read_b64_tr_b16 v[104:105], v4 offset:57344
    ds_read_b64_tr_b16 v[106:107], v4 offset:58368
    v_mfma_f32_32x32x16_bf16 v[64:79], v[132:135], v[108:111], v[64:79]
    ds_read_b64_tr_b16 v[108:109], v4 offset:61440
    ds_read_b64_tr_b16 v[110:111], v4 offset:62464
    s_waitcnt vmcnt(12) lgkmcnt(8)
    v_mfma_f32_32x32x16_bf16 v[16:31], v[136:139], v[80:83], v[16:31]
    ds_read_b64_tr_b16 v[80:81], v5 offset:32768
    ds_read_b64_tr_b16 v[82:83], v5 offset:33792
    v_mfma_f32_32x32x16_bf16 v[16:31], v[140:143], v[84:87], v[16:31]
    ds_read_b64_tr_b16 v[84:85], v5 offset:36864
    ds_read_b64_tr_b16 v[86:87], v5 offset:37888
    v_mfma_f32_32x32x16_bf16 v[16:31], v[144:147], v[88:91], v[16:31]
    ds_read_b64_tr_b16 v[88:89], v5 offset:40960
    ds_read_b64_tr_b16 v[90:91], v5 offset:41984
    v_mfma_f32_32x32x16_bf16 v[16:31], v[148:151], v[92:95], v[16:31]
    ds_read_b64_tr_b16 v[92:93], v5 offset:45056
    ds_read_b64_tr_b16 v[94:95], v5 offset:46080
    s_waitcnt vmcnt(8) lgkmcnt(8)
    v_mfma_f32_32x32x16_bf16 v[16:31], v[152:155], v[96:99], v[16:31]
    ds_read_b64_tr_b16 v[96:97], v5 offset:49152
    ds_read_b64_tr_b16 v[98:99], v5 offset:50176
    v_mfma_f32_32x32x16_bf16 v[16:31], v[156:159], v[100:103], v[16:31]
    ds_read_b64_tr_b16 v[100:101], v5 offset:53248
    ds_read_b64_tr_b16 v[102:103], v5 offset:54272
    v_mfma_f32_32x32x16_bf16 v[16:31], v[160:163], v[104:107], v[16:31]
    ds_read_b64_tr_b16 v[104:105], v5 offset:57344
    ds_read_b64_tr_b16 v[106:107], v5 offset:58368
    v_mfma_f32_32x32x16_bf16 v[16:31], v[164:167], v[108:111], v[16:31]
    ds_read_b64_tr_b16 v[108:109], v5 offset:61440
    ds_read_b64_tr_b16 v[110:111], v5 offset:62464
    s_waitcnt lgkmcnt(8)
    s_barrier
    v_mfma_f32_32x32x16_bf16 v[32:47], v[136:139], v[80:83], v[32:47]
    v_add_u32 v4, 65536, v4
    ds_read_b64_tr_b16 v[80:81], v4 offset:0
    ds_read_b64_tr_b16 v[82:83], v4 offset:1024
    v_mfma_f32_32x32x16_bf16 v[32:47], v[140:143], v[84:87], v[32:47]
    ds_read_b64_tr_b16 v[84:85], v4 offset:4096
    ds_read_b64_tr_b16 v[86:87], v4 offset:5120
    v_mfma_f32_32x32x16_bf16 v[32:47], v[144:147], v[88:91], v[32:47]
    ds_read_b64_tr_b16 v[88:89], v4 offset:8192
    ds_read_b64_tr_b16 v[90:91], v4 offset:9216
    v_mfma_f32_32x32x16_bf16 v[32:47], v[148:151], v[92:95], v[32:47]
    ds_read_b64_tr_b16 v[92:93], v4 offset:12288
    ds_read_b64_tr_b16 v[94:95], v4 offset:13312
    s_waitcnt lgkmcnt(8)
    v_mfma_f32_32x32x16_bf16 v[32:47], v[152:155], v[96:99], v[32:47]
    v_subrev_u32 v4, 131072, v4
    ds_read_b64_tr_b16 v[96:97], v4 offset:0
    ds_read_b64_tr_b16 v[98:99], v4 offset:1024
    v_mfma_f32_32x32x16_bf16 v[32:47], v[156:159], v[100:103], v[32:47]
    ds_read_b64_tr_b16 v[100:101], v4 offset:4096
    ds_read_b64_tr_b16 v[102:103], v4 offset:5120
    v_mfma_f32_32x32x16_bf16 v[32:47], v[160:163], v[104:107], v[32:47]
    ds_read_b64_tr_b16 v[104:105], v4 offset:8192
    ds_read_b64_tr_b16 v[106:107], v4 offset:9216
    v_mfma_f32_32x32x16_bf16 v[32:47], v[164:167], v[108:111], v[32:47]
    ds_read_b64_tr_b16 v[108:109], v4 offset:12288
    ds_read_b64_tr_b16 v[110:111], v4 offset:13312
    s_waitcnt vmcnt(4) lgkmcnt(8)
    v_mfma_f32_32x32x16_bf16 v[16:31], v[168:171], v[80:83], v[16:31]
    v_add_u32 v5, 65536, v5
    ds_read_b64_tr_b16 v[80:81], v5 offset:0
    ds_read_b64_tr_b16 v[82:83], v5 offset:1024
    v_mfma_f32_32x32x16_bf16 v[16:31], v[172:175], v[84:87], v[16:31]
    ds_read_b64_tr_b16 v[84:85], v5 offset:4096
    ds_read_b64_tr_b16 v[86:87], v5 offset:5120
    v_mfma_f32_32x32x16_bf16 v[16:31], v[176:179], v[88:91], v[16:31]
    ds_read_b64_tr_b16 v[88:89], v5 offset:8192
    ds_read_b64_tr_b16 v[90:91], v5 offset:9216
    v_mfma_f32_32x32x16_bf16 v[16:31], v[180:183], v[92:95], v[16:31]
    ds_read_b64_tr_b16 v[92:93], v5 offset:12288
    ds_read_b64_tr_b16 v[94:95], v5 offset:13312
    s_waitcnt vmcnt(0) lgkmcnt(8)
    v_mfma_f32_32x32x16_bf16 v[16:31], v[184:187], v[96:99], v[16:31]
    v_subrev_u32 v5, 131072, v5
    ds_read_b64_tr_b16 v[96:97], v5 offset:0
    ds_read_b64_tr_b16 v[98:99], v5 offset:1024
    v_mfma_f32_32x32x16_bf16 v[16:31], v[188:191], v[100:103], v[16:31]
    ds_read_b64_tr_b16 v[100:101], v5 offset:4096
    ds_read_b64_tr_b16 v[102:103], v5 offset:5120
    v_mfma_f32_32x32x16_bf16 v[16:31], v[192:195], v[104:107], v[16:31]
    ds_read_b64_tr_b16 v[104:105], v5 offset:8192
    ds_read_b64_tr_b16 v[106:107], v5 offset:9216
    v_mfma_f32_32x32x16_bf16 v[16:31], v[196:199], v[108:111], v[16:31]
    ds_read_b64_tr_b16 v[108:109], v5 offset:12288
    ds_read_b64_tr_b16 v[110:111], v5 offset:13312
    s_waitcnt lgkmcnt(8)
    v_mfma_f32_32x32x16_bf16 v[32:47], v[168:171], v[80:83], v[32:47]
    ds_read_b64_tr_b16 v[80:81], v6 offset:32768
    ds_read_b64_tr_b16 v[82:83], v6 offset:33792
    v_mfma_f32_32x32x16_bf16 v[32:47], v[172:175], v[84:87], v[32:47]
    ds_read_b64_tr_b16 v[84:85], v6 offset:36864
    ds_read_b64_tr_b16 v[86:87], v6 offset:37888
    v_mfma_f32_32x32x16_bf16 v[32:47], v[176:179], v[88:91], v[32:47]
    ds_read_b64_tr_b16 v[88:89], v6 offset:40960
    ds_read_b64_tr_b16 v[90:91], v6 offset:41984
    v_mfma_f32_32x32x16_bf16 v[32:47], v[180:183], v[92:95], v[32:47]
    ds_read_b64_tr_b16 v[92:93], v6 offset:45056
    ds_read_b64_tr_b16 v[94:95], v6 offset:46080
    v_cvt_pk_bf16_f32 v112, v16, v17
    v_cvt_pk_bf16_f32 v113, v18, v19
    s_waitcnt lgkmcnt(8)
    v_mfma_f32_32x32x16_bf16 v[32:47], v[184:187], v[96:99], v[32:47]
    ds_read_b64_tr_b16 v[96:97], v6 offset:49152
    ds_read_b64_tr_b16 v[98:99], v6 offset:50176
    v_cvt_pk_bf16_f32 v114, v20, v21
    v_cvt_pk_bf16_f32 v115, v22, v23
    v_mfma_f32_32x32x16_bf16 v[32:47], v[188:191], v[100:103], v[32:47]
    ds_read_b64_tr_b16 v[100:101], v6 offset:53248
    ds_read_b64_tr_b16 v[102:103], v6 offset:54272
    v_cvt_pk_bf16_f32 v116, v24, v25
    v_cvt_pk_bf16_f32 v117, v26, v27
    v_mfma_f32_32x32x16_bf16 v[32:47], v[192:195], v[104:107], v[32:47]
    ds_read_b64_tr_b16 v[104:105], v6 offset:57344
    ds_read_b64_tr_b16 v[106:107], v6 offset:58368
    v_cvt_pk_bf16_f32 v118, v28, v29
    v_cvt_pk_bf16_f32 v119, v30, v31
    v_mfma_f32_32x32x16_bf16 v[32:47], v[196:199], v[108:111], v[32:47]
    ds_read_b64_tr_b16 v[108:109], v6 offset:61440
    ds_read_b64_tr_b16 v[110:111], v6 offset:62464
    s_nop 0
    v_permlane32_swap_b32 v112, v114
    s_waitcnt lgkmcnt(8)
    v_mfma_f32_32x32x16_bf16 v[48:63], v[136:139], v[80:83], v[48:63]
    v_add_u32 v6, 65536, v6
    ds_read_b64_tr_b16 v[80:81], v6 offset:0
    ds_read_b64_tr_b16 v[82:83], v6 offset:1024
    v_permlane32_swap_b32 v113, v115
    v_permlane32_swap_b32 v116, v118
    v_mfma_f32_32x32x16_bf16 v[48:63], v[140:143], v[84:87], v[48:63]
    ds_read_b64_tr_b16 v[84:85], v6 offset:4096
    ds_read_b64_tr_b16 v[86:87], v6 offset:5120
    v_permlane32_swap_b32 v117, v119
    buffer_store_dwordx4 v[112:115], v2, s[20:23], s55 offen offset:0 sc0 sc1
    v_mfma_f32_32x32x16_bf16 v[48:63], v[144:147], v[88:91], v[48:63]
    ds_read_b64_tr_b16 v[88:89], v6 offset:8192
    ds_read_b64_tr_b16 v[90:91], v6 offset:9216
    buffer_store_dwordx4 v[116:119], v2, s[20:23], s56 offen offset:0 sc0 sc1
    v_mfma_f32_32x32x16_bf16 v[48:63], v[148:151], v[92:95], v[48:63]
    ds_read_b64_tr_b16 v[92:93], v6 offset:12288
    ds_read_b64_tr_b16 v[94:95], v6 offset:13312
    v_cvt_pk_bf16_f32 v120, v32, v33
    v_cvt_pk_bf16_f32 v121, v34, v35
    s_waitcnt lgkmcnt(8)
    v_mfma_f32_32x32x16_bf16 v[48:63], v[152:155], v[96:99], v[48:63]
    v_subrev_u32 v6, 131072, v6
    ds_read_b64_tr_b16 v[96:97], v6 offset:0
    ds_read_b64_tr_b16 v[98:99], v6 offset:1024
    v_cvt_pk_bf16_f32 v122, v36, v37
    v_cvt_pk_bf16_f32 v123, v38, v39
    v_mfma_f32_32x32x16_bf16 v[48:63], v[156:159], v[100:103], v[48:63]
    ds_read_b64_tr_b16 v[100:101], v6 offset:4096
    ds_read_b64_tr_b16 v[102:103], v6 offset:5120
    v_cvt_pk_bf16_f32 v124, v40, v41
    v_cvt_pk_bf16_f32 v125, v42, v43
    v_mfma_f32_32x32x16_bf16 v[48:63], v[160:163], v[104:107], v[48:63]
    ds_read_b64_tr_b16 v[104:105], v6 offset:8192
    ds_read_b64_tr_b16 v[106:107], v6 offset:9216
    v_cvt_pk_bf16_f32 v126, v44, v45
    v_cvt_pk_bf16_f32 v127, v46, v47
    v_mfma_f32_32x32x16_bf16 v[48:63], v[164:167], v[108:111], v[48:63]
    ds_read_b64_tr_b16 v[108:109], v6 offset:12288
    ds_read_b64_tr_b16 v[110:111], v6 offset:13312
    s_nop 0
    v_permlane32_swap_b32 v120, v122
    s_waitcnt lgkmcnt(8)
    v_mfma_f32_32x32x16_bf16 v[48:63], v[168:171], v[80:83], v[48:63]
    ds_read_b64_tr_b16 v[80:81], v7 offset:32768
    ds_read_b64_tr_b16 v[82:83], v7 offset:33792
    v_permlane32_swap_b32 v121, v123
    v_permlane32_swap_b32 v124, v126
    v_mfma_f32_32x32x16_bf16 v[48:63], v[172:175], v[84:87], v[48:63]
    ds_read_b64_tr_b16 v[84:85], v7 offset:36864
    ds_read_b64_tr_b16 v[86:87], v7 offset:37888
    v_permlane32_swap_b32 v125, v127
    buffer_store_dwordx4 v[120:123], v2, s[20:23], s55 offen offset:512 sc0 sc1
    v_mfma_f32_32x32x16_bf16 v[48:63], v[176:179], v[88:91], v[48:63]
    ds_read_b64_tr_b16 v[88:89], v7 offset:40960
    ds_read_b64_tr_b16 v[90:91], v7 offset:41984
    buffer_store_dwordx4 v[124:127], v2, s[20:23], s56 offen offset:512 sc0 sc1
    v_mfma_f32_32x32x16_bf16 v[48:63], v[180:183], v[92:95], v[48:63]
    ds_read_b64_tr_b16 v[92:93], v7 offset:45056
    ds_read_b64_tr_b16 v[94:95], v7 offset:46080
    s_waitcnt lgkmcnt(8)
    v_mfma_f32_32x32x16_bf16 v[48:63], v[184:187], v[96:99], v[48:63]
    ds_read_b64_tr_b16 v[96:97], v7 offset:49152
    ds_read_b64_tr_b16 v[98:99], v7 offset:50176
    v_mfma_f32_32x32x16_bf16 v[48:63], v[188:191], v[100:103], v[48:63]
    ds_read_b64_tr_b16 v[100:101], v7 offset:53248
    ds_read_b64_tr_b16 v[102:103], v7 offset:54272
    v_mfma_f32_32x32x16_bf16 v[48:63], v[192:195], v[104:107], v[48:63]
    ds_read_b64_tr_b16 v[104:105], v7 offset:57344
    ds_read_b64_tr_b16 v[106:107], v7 offset:58368
    v_mfma_f32_32x32x16_bf16 v[48:63], v[196:199], v[108:111], v[48:63]
    ds_read_b64_tr_b16 v[108:109], v7 offset:61440
    ds_read_b64_tr_b16 v[110:111], v7 offset:62464
    s_waitcnt lgkmcnt(8)
    v_mfma_f32_32x32x16_bf16 v[64:79], v[136:139], v[80:83], v[64:79]
    v_add_u32 v7, 65536, v7
    ds_read_b64_tr_b16 v[80:81], v7 offset:0
    ds_read_b64_tr_b16 v[82:83], v7 offset:1024
    v_mfma_f32_32x32x16_bf16 v[64:79], v[140:143], v[84:87], v[64:79]
    ds_read_b64_tr_b16 v[84:85], v7 offset:4096
    ds_read_b64_tr_b16 v[86:87], v7 offset:5120
    v_mfma_f32_32x32x16_bf16 v[64:79], v[144:147], v[88:91], v[64:79]
    ds_read_b64_tr_b16 v[88:89], v7 offset:8192
    ds_read_b64_tr_b16 v[90:91], v7 offset:9216
    v_mfma_f32_32x32x16_bf16 v[64:79], v[148:151], v[92:95], v[64:79]
    ds_read_b64_tr_b16 v[92:93], v7 offset:12288
    ds_read_b64_tr_b16 v[94:95], v7 offset:13312
    v_cvt_pk_bf16_f32 v112, v48, v49
    v_cvt_pk_bf16_f32 v113, v50, v51
    s_waitcnt lgkmcnt(8)
    v_mfma_f32_32x32x16_bf16 v[64:79], v[152:155], v[96:99], v[64:79]
    v_subrev_u32 v7, 131072, v7
    ds_read_b64_tr_b16 v[96:97], v7 offset:0
    ds_read_b64_tr_b16 v[98:99], v7 offset:1024
    v_cvt_pk_bf16_f32 v114, v52, v53
    v_cvt_pk_bf16_f32 v115, v54, v55
    v_mfma_f32_32x32x16_bf16 v[64:79], v[156:159], v[100:103], v[64:79]
    ds_read_b64_tr_b16 v[100:101], v7 offset:4096
    ds_read_b64_tr_b16 v[102:103], v7 offset:5120
    v_cvt_pk_bf16_f32 v116, v56, v57
    v_cvt_pk_bf16_f32 v117, v58, v59
    v_mfma_f32_32x32x16_bf16 v[64:79], v[160:163], v[104:107], v[64:79]
    ds_read_b64_tr_b16 v[104:105], v7 offset:8192
    ds_read_b64_tr_b16 v[106:107], v7 offset:9216
    v_cvt_pk_bf16_f32 v118, v60, v61
    v_cvt_pk_bf16_f32 v119, v62, v63
    v_mfma_f32_32x32x16_bf16 v[64:79], v[164:167], v[108:111], v[64:79]
    ds_read_b64_tr_b16 v[108:109], v7 offset:12288
    ds_read_b64_tr_b16 v[110:111], v7 offset:13312
    s_nop 0
    v_permlane32_swap_b32 v112, v114
    s_waitcnt lgkmcnt(8)
    v_mfma_f32_32x32x16_bf16 v[64:79], v[168:171], v[80:83], v[64:79]
    v_permlane32_swap_b32 v113, v115
    v_permlane32_swap_b32 v116, v118
    v_mfma_f32_32x32x16_bf16 v[64:79], v[172:175], v[84:87], v[64:79]
    v_permlane32_swap_b32 v117, v119
    buffer_store_dwordx4 v[112:115], v2, s[20:23], s55 offen offset:1024 sc0 sc1
    v_mfma_f32_32x32x16_bf16 v[64:79], v[176:179], v[88:91], v[64:79]
    buffer_store_dwordx4 v[116:119], v2, s[20:23], s56 offen offset:1024 sc0 sc1
    v_mfma_f32_32x32x16_bf16 v[64:79], v[180:183], v[92:95], v[64:79]
    s_waitcnt lgkmcnt(0)
    v_mfma_f32_32x32x16_bf16 v[64:79], v[184:187], v[96:99], v[64:79]
    v_mfma_f32_32x32x16_bf16 v[64:79], v[188:191], v[100:103], v[64:79]
    v_mfma_f32_32x32x16_bf16 v[64:79], v[192:195], v[104:107], v[64:79]
    v_mfma_f32_32x32x16_bf16 v[64:79], v[196:199], v[108:111], v[64:79]
    s_nop 11
    v_cvt_pk_bf16_f32 v120, v64, v65
    v_cvt_pk_bf16_f32 v121, v66, v67
    v_cvt_pk_bf16_f32 v122, v68, v69
    v_cvt_pk_bf16_f32 v123, v70, v71
    v_cvt_pk_bf16_f32 v124, v72, v73
    v_cvt_pk_bf16_f32 v125, v74, v75
    v_cvt_pk_bf16_f32 v126, v76, v77
    v_cvt_pk_bf16_f32 v127, v78, v79
    s_nop 0
    v_permlane32_swap_b32 v120, v122
    v_permlane32_swap_b32 v121, v123
    v_permlane32_swap_b32 v124, v126
    v_permlane32_swap_b32 v125, v127
    buffer_store_dwordx4 v[120:123], v2, s[20:23], s55 offen offset:1536 sc0 sc1
    buffer_store_dwordx4 v[124:127], v2, s[20:23], s56 offen offset:1536 sc0 sc1
    s_branch L_q_done
L_q_side:
    s_barrier
    s_branch L_q_done
L_q_done:
    s_waitcnt vmcnt(0)
    s_barrier
L_q_setup:
    s_lshl_b32 s52, s41, 4
    s_add_u32 s52, s52, s42
    s_lshr_b32 s58, s52, 4
    s_and_b32 s60, s58, 3
    s_lshl_b32 s60, s60, 11
    s_and_b32 s59, s58, 4
    s_lshl_b32 s59, s59, 12
    s_add_u32 s60, s60, s59
    s_and_b32 s59, s58, 8
    s_lshl_b32 s59, s59, 10
    s_add_u32 s60, s60, s59
    s_xor_b32 s60, s60, s99
    s_add_u32 s60, s60, 29491200
    s_and_b32 s59, s52, 15
    s_lshl_b32 s59, s59, 7
    s_add_u32 s60, s60, s59
    v_lshl_add_u32 v249, v1, 2, s60
    s_cmp_eq_u32 s40, 0
    s_cbranch_scc0 L_a_nopw
    s_bfe_u32 s41, s2, 0x20001
    s_lshl_b32 s41, s41, 2
    s_bfe_u32 s42, s2, 0x20003
    s_add_u32 s41, s41, s42
    s_lshl_b32 s41, s41, 1
    s_bfe_u32 s42, s2, 0x10005
    s_add_u32 s41, s41, s42
    s_lshr_b32 s42, s2, 6
    s_and_b32 s60, s2, 1
    s_lshl_b32 s60, s60, 2
    s_add_u32 s42, s42, s60
    s_lshl_b32 s52, s41, 3
    s_add_u32 s52, s52, s42
    s_lshr_b32 s58, s52, 4
    s_and_b32 s60, s58, 3
    s_lshl_b32 s60, s60, 11
    s_and_b32 s59, s58, 4
    s_lshl_b32 s59, s59, 12
    s_add_u32 s60, s60, s59
    s_and_b32 s59, s58, 8
    s_lshl_b32 s59, s59, 10
    s_add_u32 s60, s60, s59
    s_xor_b32 s60, s60, s99
    s_add_u32 s60, s60, 29425664
    s_and_b32 s59, s52, 15
    s_lshl_b32 s59, s59, 7
    s_add_u32 s60, s60, s59
    v_lshl_add_u32 v249, v1, 2, s60
    v_not_b32 v251, v248
    s_mov_b32 exec_hi, 0
    buffer_store_dword v251, v249, s[20:23], 0 offen sc0 sc1
    s_mov_b32 exec_hi, -1
    s_cmp_lt_u32 s2, 224
    s_cbranch_scc0 L_a_nopw
    s_bfe_u32 s41, s2, 0x20001
    s_lshl_b32 s41, s41, 2
    s_bfe_u32 s44, s2, 0x20003
    s_add_u32 s41, s41, s44
    s_and_b32 s42, s2, 1
    s_mul_i32 s42, s42, 7
    s_lshr_b32 s44, s2, 5
    s_and_b32 s43, s41, 7
    s_min_u32 s43, s43, 6
    s_cmp_eq_u32 s44, 7
    s_cselect_b32 s44, s43, s44
    s_add_u32 s42, s42, s44
    s_mov_b32 s43, 3456
    s_lshl_b32 s46, s42, 8
    s_mov_b32 s8, s32
    s_mov_b32 s9, s33
    s_mov_b32 s10, 2211840
    s_mov_b32 s11, 0x20000
    s_lshl_b32 s52, s41, 4
    s_add_u32 s52, s52, s42
    s_lshr_b32 s58, s52, 4
    s_and_b32 s60, s58, 3
    s_lshl_b32 s60, s60, 11
    s_and_b32 s59, s58, 4
    s_lshl_b32 s59, s59, 12
    s_add_u32 s60, s60, s59
    s_and_b32 s59, s58, 8
    s_lshl_b32 s59, s59, 10
    s_add_u32 s60, s60, s59
    s_xor_b32 s60, s60, s99
    s_add_u32 s60, s60, 29458432
    s_and_b32 s59, s52, 15
    s_lshl_b32 s59, s59, 7
    s_add_u32 s60, s60, s59
    v_lshl_add_u32 v249, v1, 2, s60
    v_not_b32 v251, v248
    s_mov_b32 exec_hi, 0
    buffer_store_dword v251, v249, s[20:23], 0 offen sc0 sc1
    s_mov_b32 exec_hi, -1
L_a_nopw:
    s_and_b32 s41, s2, 4
    s_lshl_b32 s41, s41, 1
    s_bfe_u32 s42, s2, 0x30003
    s_add_u32 s41, s41, s42
    s_and_b32 s42, s2, 3
    s_lshl_b32 s42, s42, 2
    s_lshr_b32 s43, s2, 6
    s_add_u32 s42, s42, s43
    s_cmp_eq_u32 s40, 0
    s_cbranch_scc0 L_a_nopw2
    s_lshl_b32 s52, s41, 4
    s_add_u32 s52, s52, s42
    s_lshr_b32 s58, s52, 4
    s_and_b32 s60, s58, 3
    s_lshl_b32 s60, s60, 11
    s_and_b32 s59, s58, 4
    s_lshl_b32 s59, s59, 12
    s_add_u32 s60, s60, s59
    s_and_b32 s59, s58, 8
    s_lshl_b32 s59, s59, 10
    s_add_u32 s60, s60, s59
    s_xor_b32 s60, s60, s99
    s_add_u32 s60, s60, 29392896
    s_and_b32 s59, s52, 15
    s_lshl_b32 s59, s59, 7
    s_add_u32 s60, s60, s59
    v_lshl_add_u32 v249, v1, 2, s60
    v_not_b32 v251, v248
    s_mov_b32 exec_hi, 0
    buffer_store_dword v251, v249, s[20:23], 0 offen sc0 sc1
    s_mov_b32 exec_hi, -1
L_a_nopw2:
    s_lshr_b32 s43, s40, 2
    s_xor_b32 s43, s43, 1
    s_and_b32 s44, s40, 3
    s_mul_i32 s45, s42, 2560
    s_mul_i32 s46, s43, 1536
    s_add_u32 s46, s46, s45
    v_lshlrev_b32 v4, 4, v1
    v_add_u32 v4, s46, v4
    v_and_b32 v10, 31, v1
    v_lshrrev_b32 v11, 5, v1
    v_lshlrev_b32 v5, 4, v10
    v_lshl_add_u32 v5, v11, 3, v5
    s_add_u32 s45, s45, 1024
    v_add_u32 v5, s45, v5
    v_and_b32 v13, 0xffffe000, v4
    v_add_u32 v4, v13, v4
    v_and_b32 v13, 0xffffe000, v5
    v_add_u32 v5, v13, v5
    s_lshl_b32 s47, s43, 2
    v_add_u32 v12, s47, v10
    v_subrev_u32 v13, 20, v12
    v_cmp_gt_u32 vcc, 20, v12
    s_mul_i32 s47, s42, 40
    s_mul_i32 s48, s43, 20
    v_cndmask_b32 v12, v13, v12, vcc
    s_add_u32 s48, s47, s48
    v_add_u32 v12, s48, v12
    v_lshrrev_b32 v13, 7, v12
    v_and_b32 v12, 127, v12
    v_lshlrev_b32 v12, 4, v12
    v_lshl_add_u32 v12, v13, 14, v12
    v_lshl_add_u32 v12, v11, 11, v12
    v_add_u32 v6, 81920, v12
    v_add_u32 v7, 86016, v12
    s_and_b32 s47, s47, 0xffffff80
    s_add_u32 s47, s47, 163840
    v_mov_b32 v13, s47
    v_mov_b32 v14, 0x40000000
    v_cmp_eq_u32 vcc, 20, v10
    v_mov_b32 v8, 0xdddddddd
    v_cmp_eq_u32 s[50:51], s43, v11
    v_cndmask_b32 v13, v14, v13, vcc
    v_cmp_gt_u32 vcc, 20, v10
    s_and_b32 s53, s41, 8
    s_lshl_b32 s53, s53, 2
    v_cndmask_b32 v6, v13, v6, vcc
    v_cndmask_b32 v7, v13, v7, vcc
    s_lshl_b32 s52, s44, 3
    s_add_u32 s53, s53, s52
    s_and_b32 s49, s53, 7
    s_mul_i32 s49, s49, 262144
    s_bfe_u32 s60, s53, 131075
    s_lshl_b32 s60, s60, 21
    s_add_u32 s49, s49, s60
    s_lshl_b32 s60, s53, 2
    s_xor_b32 s60, s60, s53
    s_and_b32 s60, s60, 32
    s_lshl_b32 s60, s60, 8
    s_xor_b32 s60, s60, s99
    s_add_u32 s49, s49, s60
    s_add_u32 s49, s49, 4194304
    s_add_u32 s49, s49, 81920
    s_xor_b32 s48, s49, 8192
    s_lshl_b32 s53, s41, 2
    s_add_u32 s52, s53, s44
    s_and_b32 s47, s52, 15
    s_mul_i32 s47, s47, 81920
    s_bfe_u32 s60, s52, 65540
    s_lshl_b32 s60, s60, 21
    s_add_u32 s47, s47, s60
    s_lshl_b32 s60, s52, 1
    s_xor_b32 s60, s60, s52
    s_and_b32 s60, s60, 32
    s_lshl_b32 s60, s60, 8
    s_xor_b32 s60, s60, s99
    s_add_u32 s47, s47, s60
    s_add_u32 s47, s47, 41943040
    s_and_b32 s46, s53, 7
    s_mul_i32 s46, s46, 262144
    s_bfe_u32 s60, s53, 131075
    s_lshl_b32 s60, s60, 21
    s_add_u32 s46, s46, s60
    s_lshl_b32 s60, s53, 2
    s_xor_b32 s60, s60, s53
    s_and_b32 s60, s60, 32
    s_lshl_b32 s60, s60, 8
    s_xor_b32 s60, s60, s99
    s_add_u32 s46, s46, s60
    s_add_u32 s46, s46, 4194304
    s_add_u32 s52, s44, 1
    s_and_b32 s52, s52, 3
    s_lshl_b32 s52, s52, 18
    s_add_u32 s54, s52, s46
    s_add_u32 s52, s44, 2
    s_and_b32 s52, s52, 3
    s_lshl_b32 s52, s52, 18
    s_add_u32 s55, s52, s46
    s_add_u32 s52, s44, 3
    s_and_b32 s52, s52, 3
    s_lshl_b32 s52, s52, 18
    s_add_u32 s56, s52, s46
    s_add_u32 s52, s44, 4
    s_and_b32 s52, s52, 3
    s_lshl_b32 s52, s52, 18
    s_add_u32 s57, s52, s46
    s_bfe_u32 s6, s2, 0x20001
    s_lshl_b32 s6, s6, 2
    s_bfe_u32 s52, s2, 0x20003
    s_add_u32 s6, s6, s52
    s_lshl_b32 s6, s6, 1
    s_bfe_u32 s52, s2, 0x10005
    s_add_u32 s6, s6, s52
    s_lshr_b32 s52, s2, 6
    s_and_b32 s60, s2, 1
    s_lshl_b32 s60, s60, 2
    s_add_u32 s52, s52, s60
    v_lshlrev_b32 v3, 4, v1
    v_add_u32 v2, 83968, v3
    s_lshl_b32 s61, s44, 11
    s_mul_i32 s53, s52, 102400
    s_add_u32 s53, s53, s61
    s_add_u32 s53, s53, 23265280
    v_add_u32 v3, s53, v3
    s_lshr_b32 s53, s2, 3
    v_lshlrev_b32 v236, 5, v1
    v_min_u32 v236, 1760, v236
    s_mul_i32 s53, s53, 20
    s_mul_i32 s60, s40, 5
    s_lshr_b32 s60, s60, 1
    s_add_u32 s53, s53, s60
    s_mul_i32 s53, s53, 3456
    s_and_b32 s60, s2, 1
    s_mul_i32 s60, s60, 1792
    s_add_u32 s53, s53, s60
    v_add_u32 v236, s53, v236
    s_mov_b32 s8, s32
    s_mov_b32 s9, s33
    s_mov_b32 s10, 2211840
    s_mov_b32 s11, 0x20000
    v_and_b32 v10, 31, v1
    v_mul_u32_u24 v237, 1280, v10
    v_lshrrev_b32 v10, 5, v1
    v_lshl_add_u32 v237, v10, 4, v237
    s_lshl_b32 s53, s6, 1
    s_and_b32 s60, s40, 1
    s_add_u32 s53, s53, s60
    s_mul_i32 s53, s53, 40960
    s_mul_i32 s52, s52, 160
    s_add_u32 s53, s53, s52
    s_bfe_u32 s60, s40, 0x10001
    s_mul_i32 s60, s60, 96
    s_add_u32 s53, s53, s60
    v_add_u32 v237, s53, v237
    s_and_b32 s63, s41, 8
    s_lshl_b32 s63, s63, 10
    s_xor_b32 s63, s63, s99
    s_add_u32 s63, s63, 29491200
    v_bfe_u32 v10, v1, 3, 1
    v_mul_u32_u24 v10, 39, v10
    s_mul_i32 s52, s42, 40
    v_add_u32 v10, s52, v10
    v_lshrrev_b32 v10, 7, v10
    v_lshrrev_b32 v12, 4, v1
    v_mad_u32_u24 v12, v12, 5, 5
    v_cmp_gt_u32 vcc, 32, v1
    v_mov_b32 v11, s41
    s_nop 0
    v_cndmask_b32 v12, 0, v12, vcc
    v_cndmask_b32 v11, v11, v1, vcc
    v_bfe_u32 v13, v1, 4, 1
    v_mad_u32_u24 v13, v13, 5, v10
    v_and_b32 v14, 1, v1
    v_lshl_add_u32 v13, v14, 4, v13
    s_and_b32 s52, s44, 1
    s_lshl_b32 s52, s52, 12
    s_and_b32 s53, s44, 2
    s_lshl_b32 s53, s53, 13
    s_add_u32 s52, s52, s53
    s_xor_b32 s53, s63, 8192
    s_add_u32 s52, s52, s53
    s_add_u32 s52, s52, 640
    v_lshl_add_u32 v9, v13, 7, s52
    v_add_u32 v10, v10, v12
    v_and_b32 v12, 3, v11
    v_lshl_add_u32 v10, v12, 4, v10
    v_and_b32 v12, 4, v11
    v_lshl_add_u32 v10, v12, 5, v10
    v_lshl_add_u32 v250, v10, 7, s63
    v_mov_b32 v10, 158784
    v_mov_b32 v11, 0
    ds_write_b32 v10, v11
    s_waitcnt lgkmcnt(0)
    v_mov_b32 v11, 1
    s_setprio 2
    s_cmp_eq_u32 s43, 0
    s_cbranch_scc0 L_ho_qkv_done
    s_setprio 3
    s_waitcnt vmcnt(0)
    s_barrier
    s_cmp_eq_u32 s40, 4
    s_cbranch_scc0 L_ho_qkv_a
    s_mov_b32 exec_hi, 0
    buffer_store_dword v248, v249, s[20:23], 0 offen sc0 sc1
    s_mov_b64 exec, -1
L_ho_qkv_a:
    s_cmp_eq_u32 s40, 4
    s_cbranch_scc0 L_ho_qkv_done
    s_mov_b32 s62, 0
    s_waitcnt vmcnt(0)
L_ho_qkv:
    buffer_load_dword v251, v250, s[20:23], 0 offen sc0 sc1
    s_add_u32 s62, s62, 1
    s_waitcnt vmcnt(0)
L_ho_qkv_chk:
    v_cmp_ne_u32 vcc, s3, v251
    s_cmp_gt_u32 s62, 400000
    s_cbranch_scc1 L_ho_qkv_done
    s_cbranch_vccz L_ho_qkv_done
    s_branch L_ho_qkv
L_ho_qkv_done:
    s_lshl_b32 s60, s2, 2
    s_add_u32 s60, s60, 83968
    v_mov_b32 v249, s60
    s_barrier
    s_cmp_eq_u32 s43, 0
    s_cbranch_scc0 L_att_b
    buffer_load_dwordx2 v[160:161], v5, s[20:23], s54 offen sc1
    buffer_load_dwordx4 v[144:147], v4, s[20:23], s54 offen sc1
    buffer_load_dwordx2 v[172:173], v5, s[20:23], s49 offen sc1
    buffer_load_dwordx4 v[168:171], v4, s[20:23], s49 offen sc1
    v_mov_b32 v16, 0
    v_mov_b32 v17, 0
    v_mov_b32 v18, 0
    v_mov_b32 v19, 0
    v_mov_b32 v20, 0
    v_mov_b32 v21, 0
    v_mov_b32 v22, 0
    v_mov_b32 v23, 0
    v_mov_b32 v24, 0
    v_mov_b32 v25, 0
    v_mov_b32 v26, 0
    v_mov_b32 v27, 0
    v_mov_b32 v28, 0
    v_mov_b32 v29, 0
    v_mov_b32 v30, 0
    v_mov_b32 v31, 0
    v_mov_b32 v32, 0
    v_mov_b32 v33, 0
    v_mov_b32 v34, 0
    v_mov_b32 v35, 0
    v_mov_b32 v36, 0
    v_mov_b32 v37, 0
    v_mov_b32 v38, 0
    v_mov_b32 v39, 0
    v_mov_b32 v40, 0
    v_mov_b32 v41, 0
    v_mov_b32 v42, 0
    v_mov_b32 v43, 0
    v_mov_b32 v44, 0
    v_mov_b32 v45, 0
    v_mov_b32 v46, 0
    v_mov_b32 v47, 0
    v_mov_b32 v48, 0
    v_mov_b32 v49, 0
    v_mov_b32 v50, 0
    v_mov_b32 v51, 0
    v_mov_b32 v52, 0
    v_mov_b32 v53, 0
    v_mov_b32 v54, 0
    v_mov_b32 v55, 0
    buffer_load_dwordx2 v[162:163], v5, s[20:23], s55 offen sc1
    buffer_load_dwordx4 v[148:151], v4, s[20:23], s55 offen sc1
    buffer_load_dwordx4 v[174:177], v6, s[20:23], s49 offen sc1
    v_mov_b32 v56, 0
    v_mov_b32 v57, 0
    v_mov_b32 v58, 0
    v_mov_b32 v59, 0
    v_mov_b32 v60, 0
    v_mov_b32 v61, 0
    v_mov_b32 v62, 0
    v_mov_b32 v63, 0
    v_mov_b32 v64, 0
    v_mov_b32 v65, 0
    v_mov_b32 v66, 0
    v_mov_b32 v67, 0
    v_mov_b32 v68, 0
    v_mov_b32 v69, 0
    v_mov_b32 v70, 0
    v_mov_b32 v71, 0
    v_mov_b32 v72, 0
    v_mov_b32 v73, 0
    v_mov_b32 v74, 0
    v_mov_b32 v75, 0
    v_mov_b32 v76, 0
    v_mov_b32 v77, 0
    v_mov_b32 v78, 0
    v_mov_b32 v79, 0
    buffer_load_dwordx2 v[164:165], v5, s[20:23], s56 offen sc1
    buffer_load_dwordx4 v[152:155], v4, s[20:23], s56 offen sc1
    buffer_load_dwordx4 v[178:181], v7, s[20:23], s49 offen sc1
    buffer_load_dwordx2 v[166:167], v5, s[20:23], s57 offen sc1
    buffer_load_dwordx4 v[156:159], v4, s[20:23], s57 offen sc1
    s_add_u32 s49, s49, 262144
    buffer_load_dwordx4 v[182:185], v4, s[20:23], s49 offen sc1
    buffer_load_dwordx2 v[186:187], v5, s[20:23], s49 offen sc1
    buffer_load_dwordx4 v[188:191], v6, s[20:23], s49 offen sc1
    buffer_load_dwordx4 v[192:195], v7, s[20:23], s49 offen sc1
    s_waitcnt vmcnt(12)
    v_cndmask_b32 v160, 0, v160, s[50:51]
    v_cndmask_b32 v161, 0, v161, s[50:51]
    s_nop 1
    v_mfma_f32_32x32x8_bf16 v[80:95], v[172:173], v[160:161], 0
    v_mfma_f32_32x32x16_bf16 v[80:95], v[168:171], v[144:147], v[80:95]
    s_waitcnt vmcnt(10)
    v_cndmask_b32 v162, 0, v162, s[50:51]
    v_cndmask_b32 v163, 0, v163, s[50:51]
    s_nop 8
    v_exp_f32 v80, v80
    v_exp_f32 v81, v81
    v_mfma_f32_32x32x8_bf16 v[96:111], v[172:173], v[162:163], 0
    s_add_u32 s49, s49, 262144
    buffer_load_dwordx4 v[196:199], v4, s[20:23], s49 offen sc1
    v_exp_f32 v82, v82
    v_exp_f32 v83, v83
    v_exp_f32 v84, v84
    v_exp_f32 v85, v85
    v_mfma_f32_32x32x16_bf16 v[96:111], v[168:171], v[148:151], v[96:111]
    v_exp_f32 v86, v86
    v_exp_f32 v87, v87
    v_exp_f32 v88, v88
    v_exp_f32 v89, v89
    s_nop 0
    buffer_load_dwordx2 v[200:201], v5, s[20:23], s49 offen sc1
    v_exp_f32 v90, v90
    v_exp_f32 v91, v91
    v_exp_f32 v92, v92
    v_exp_f32 v93, v93
    s_waitcnt vmcnt(8)
    v_cndmask_b32 v164, 0, v164, s[50:51]
    v_cndmask_b32 v165, 0, v165, s[50:51]
    v_smfmac_f32_32x32x32_bf16 v[16:31], v[174:177], v[80:87], v8
    v_exp_f32 v94, v94
    v_exp_f32 v95, v95
    v_exp_f32 v96, v96
    v_exp_f32 v97, v97
    v_mfma_f32_32x32x8_bf16 v[112:127], v[172:173], v[164:165], 0
    buffer_load_dwordx4 v[202:205], v6, s[20:23], s49 offen sc1
    v_exp_f32 v98, v98
    v_exp_f32 v99, v99
    v_exp_f32 v100, v100
    v_exp_f32 v101, v101
    v_mfma_f32_32x32x16_bf16 v[112:127], v[168:171], v[152:155], v[112:127]
    v_exp_f32 v102, v102
    v_exp_f32 v103, v103
    v_exp_f32 v104, v104
    v_exp_f32 v105, v105
    v_smfmac_f32_32x32x32_bf16 v[16:31], v[178:181], v[88:95], v8
    buffer_load_dwordx4 v[206:209], v7, s[20:23], s49 offen sc1
    v_exp_f32 v106, v106
    v_exp_f32 v107, v107
    v_exp_f32 v108, v108
    v_exp_f32 v109, v109
    s_waitcnt vmcnt(8)
    v_cndmask_b32 v166, 0, v166, s[50:51]
    v_cndmask_b32 v167, 0, v167, s[50:51]
    v_smfmac_f32_32x32x32_bf16 v[32:47], v[174:177], v[96:103], v8
    v_exp_f32 v110, v110
    v_exp_f32 v111, v111
    v_exp_f32 v112, v112
    v_exp_f32 v113, v113
    v_mfma_f32_32x32x8_bf16 v[128:143], v[172:173], v[166:167], 0
    s_add_u32 s49, s49, 262144
    buffer_load_dwordx4 v[210:213], v4, s[20:23], s49 offen sc1
    v_exp_f32 v114, v114
    v_exp_f32 v115, v115
    v_exp_f32 v116, v116
    v_exp_f32 v117, v117
    v_mfma_f32_32x32x16_bf16 v[128:143], v[168:171], v[156:159], v[128:143]
    v_exp_f32 v118, v118
    v_exp_f32 v119, v119
    v_exp_f32 v120, v120
    v_exp_f32 v121, v121
    v_smfmac_f32_32x32x32_bf16 v[32:47], v[178:181], v[104:111], v8
    buffer_load_dwordx2 v[214:215], v5, s[20:23], s49 offen sc1
    v_exp_f32 v122, v122
    v_exp_f32 v123, v123
    v_exp_f32 v124, v124
    v_exp_f32 v125, v125
    v_smfmac_f32_32x32x32_bf16 v[48:63], v[174:177], v[112:119], v8
    v_exp_f32 v126, v126
    v_exp_f32 v127, v127
    v_exp_f32 v128, v128
    v_exp_f32 v129, v129
    s_waitcnt vmcnt(6)
    v_mfma_f32_32x32x8_bf16 v[80:95], v[186:187], v[160:161], 0
    buffer_load_dwordx4 v[216:219], v6, s[20:23], s49 offen sc1
    v_exp_f32 v130, v130
    v_exp_f32 v131, v131
    v_exp_f32 v132, v132
    v_exp_f32 v133, v133
    v_mfma_f32_32x32x16_bf16 v[80:95], v[182:185], v[144:147], v[80:95]
    v_exp_f32 v134, v134
    v_exp_f32 v135, v135
    v_exp_f32 v136, v136
    v_exp_f32 v137, v137
    v_smfmac_f32_32x32x32_bf16 v[48:63], v[178:181], v[120:127], v8
    buffer_load_dwordx4 v[220:223], v7, s[20:23], s49 offen sc1
    v_exp_f32 v138, v138
    v_exp_f32 v139, v139
    v_exp_f32 v140, v140
    v_exp_f32 v141, v141
    v_smfmac_f32_32x32x32_bf16 v[64:79], v[174:177], v[128:135], v8
    v_exp_f32 v142, v142
    v_exp_f32 v143, v143
    v_exp_f32 v80, v80
    v_exp_f32 v81, v81
    v_mfma_f32_32x32x8_bf16 v[96:111], v[186:187], v[162:163], 0
    v_exp_f32 v82, v82
    v_exp_f32 v83, v83
    v_exp_f32 v84, v84
    v_exp_f32 v85, v85
    v_mfma_f32_32x32x16_bf16 v[96:111], v[182:185], v[148:151], v[96:111]
    v_exp_f32 v86, v86
    v_exp_f32 v87, v87
    v_exp_f32 v88, v88
    v_exp_f32 v89, v89
    v_smfmac_f32_32x32x32_bf16 v[64:79], v[178:181], v[136:143], v8
    v_exp_f32 v90, v90
    v_exp_f32 v91, v91
    v_exp_f32 v92, v92
    v_exp_f32 v93, v93
    v_smfmac_f32_32x32x32_bf16 v[16:31], v[188:191], v[80:87], v8
    v_exp_f32 v94, v94
    v_exp_f32 v95, v95
    v_exp_f32 v96, v96
    v_exp_f32 v97, v97
    v_mfma_f32_32x32x8_bf16 v[112:127], v[186:187], v[164:165], 0
    s_add_u32 s49, s49, 262144
    buffer_load_dwordx4 v[168:171], v4, s[20:23], s49 offen sc1
    v_exp_f32 v98, v98
    v_exp_f32 v99, v99
    v_exp_f32 v100, v100
    v_exp_f32 v101, v101
    v_mfma_f32_32x32x16_bf16 v[112:127], v[182:185], v[152:155], v[112:127]
    v_exp_f32 v102, v102
    v_exp_f32 v103, v103
    v_exp_f32 v104, v104
    v_exp_f32 v105, v105
    v_smfmac_f32_32x32x32_bf16 v[16:31], v[192:195], v[88:95], v8
    v_exp_f32 v106, v106
    v_exp_f32 v107, v107
    v_exp_f32 v108, v108
    v_exp_f32 v109, v109
    v_smfmac_f32_32x32x32_bf16 v[32:47], v[188:191], v[96:103], v8
    v_exp_f32 v110, v110
    v_exp_f32 v111, v111
    v_exp_f32 v112, v112
    v_exp_f32 v113, v113
    v_mfma_f32_32x32x8_bf16 v[128:143], v[186:187], v[166:167], 0
    buffer_load_dwordx2 v[172:173], v5, s[20:23], s49 offen sc1
    v_exp_f32 v114, v114
    v_exp_f32 v115, v115
    v_exp_f32 v116, v116
    v_exp_f32 v117, v117
    v_mfma_f32_32x32x16_bf16 v[128:143], v[182:185], v[156:159], v[128:143]
    v_exp_f32 v118, v118
    v_exp_f32 v119, v119
    v_exp_f32 v120, v120
    v_exp_f32 v121, v121
    v_smfmac_f32_32x32x32_bf16 v[32:47], v[192:195], v[104:111], v8
    buffer_load_dwordx4 v[224:227], v239, s[12:15], 0 offen
    v_exp_f32 v122, v122
    v_exp_f32 v123, v123
    v_exp_f32 v124, v124
    v_exp_f32 v125, v125
    v_smfmac_f32_32x32x32_bf16 v[48:63], v[188:191], v[112:119], v8
    v_exp_f32 v126, v126
    v_exp_f32 v127, v127
    v_exp_f32 v128, v128
    v_exp_f32 v129, v129
    s_waitcnt vmcnt(7)
    v_mfma_f32_32x32x8_bf16 v[80:95], v[200:201], v[160:161], 0
    buffer_load_dwordx4 v[174:177], v6, s[20:23], s49 offen sc1
    v_exp_f32 v130, v130
    v_exp_f32 v131, v131
    v_exp_f32 v132, v132
    v_exp_f32 v133, v133
    v_mfma_f32_32x32x16_bf16 v[80:95], v[196:199], v[144:147], v[80:95]
    v_exp_f32 v134, v134
    v_exp_f32 v135, v135
    v_exp_f32 v136, v136
    v_exp_f32 v137, v137
    v_smfmac_f32_32x32x32_bf16 v[48:63], v[192:195], v[120:127], v8
    v_exp_f32 v138, v138
    v_exp_f32 v139, v139
    v_exp_f32 v140, v140
    v_exp_f32 v141, v141
    v_smfmac_f32_32x32x32_bf16 v[64:79], v[188:191], v[128:135], v8
    v_exp_f32 v142, v142
    v_exp_f32 v143, v143
    v_exp_f32 v80, v80
    v_exp_f32 v81, v81
    v_mfma_f32_32x32x8_bf16 v[96:111], v[200:201], v[162:163], 0
    buffer_load_dwordx4 v[178:181], v7, s[20:23], s49 offen sc1
    v_exp_f32 v82, v82
    v_exp_f32 v83, v83
    v_exp_f32 v84, v84
    v_exp_f32 v85, v85
    v_mfma_f32_32x32x16_bf16 v[96:111], v[196:199], v[148:151], v[96:111]
    v_exp_f32 v86, v86
    v_exp_f32 v87, v87
    v_exp_f32 v88, v88
    v_exp_f32 v89, v89
    v_smfmac_f32_32x32x32_bf16 v[64:79], v[192:195], v[136:143], v8
    v_exp_f32 v90, v90
    v_exp_f32 v91, v91
    v_exp_f32 v92, v92
    v_exp_f32 v93, v93
    v_smfmac_f32_32x32x32_bf16 v[16:31], v[202:205], v[80:87], v8
    v_exp_f32 v94, v94
    v_exp_f32 v95, v95
    v_exp_f32 v96, v96
    v_exp_f32 v97, v97
    v_mfma_f32_32x32x8_bf16 v[112:127], v[200:201], v[164:165], 0
    s_add_u32 s49, s49, 262144
    buffer_load_dwordx4 v[182:185], v4, s[20:23], s49 offen sc1
    v_exp_f32 v98, v98
    v_exp_f32 v99, v99
    v_exp_f32 v100, v100
    v_exp_f32 v101, v101
    v_mfma_f32_32x32x16_bf16 v[112:127], v[196:199], v[152:155], v[112:127]
    v_exp_f32 v102, v102
    v_exp_f32 v103, v103
    v_exp_f32 v104, v104
    v_exp_f32 v105, v105
    v_smfmac_f32_32x32x32_bf16 v[16:31], v[206:209], v[88:95], v8
    v_exp_f32 v106, v106
    v_exp_f32 v107, v107
    v_exp_f32 v108, v108
    v_exp_f32 v109, v109
    v_smfmac_f32_32x32x32_bf16 v[32:47], v[202:205], v[96:103], v8
    v_exp_f32 v110, v110
    v_exp_f32 v111, v111
    v_exp_f32 v112, v112
    v_exp_f32 v113, v113
    v_mfma_f32_32x32x8_bf16 v[128:143], v[200:201], v[166:167], 0
    buffer_load_dwordx2 v[186:187], v5, s[20:23], s49 offen sc1
    v_exp_f32 v114, v114
    v_exp_f32 v115, v115
    v_exp_f32 v116, v116
    v_exp_f32 v117, v117
    v_mfma_f32_32x32x16_bf16 v[128:143], v[196:199], v[156:159], v[128:143]
    v_exp_f32 v118, v118
    v_exp_f32 v119, v119
    v_exp_f32 v120, v120
    v_exp_f32 v121, v121
    v_smfmac_f32_32x32x32_bf16 v[32:47], v[206:209], v[104:111], v8
    v_exp_f32 v122, v122
    v_exp_f32 v123, v123
    v_exp_f32 v124, v124
    v_exp_f32 v125, v125
    v_smfmac_f32_32x32x32_bf16 v[48:63], v[202:205], v[112:119], v8
    v_exp_f32 v126, v126
    v_exp_f32 v127, v127
    v_exp_f32 v128, v128
    v_exp_f32 v129, v129
    s_waitcnt vmcnt(7)
    v_mfma_f32_32x32x8_bf16 v[80:95], v[214:215], v[160:161], 0
    buffer_load_dwordx4 v[188:191], v6, s[20:23], s49 offen sc1
    v_exp_f32 v130, v130
    v_exp_f32 v131, v131
    v_exp_f32 v132, v132
    v_exp_f32 v133, v133
    v_mfma_f32_32x32x16_bf16 v[80:95], v[210:213], v[144:147], v[80:95]
    v_exp_f32 v134, v134
    v_exp_f32 v135, v135
    v_exp_f32 v136, v136
    v_exp_f32 v137, v137
    v_smfmac_f32_32x32x32_bf16 v[48:63], v[206:209], v[120:127], v8
    v_exp_f32 v138, v138
    v_exp_f32 v139, v139
    v_exp_f32 v140, v140
    v_exp_f32 v141, v141
    v_smfmac_f32_32x32x32_bf16 v[64:79], v[202:205], v[128:135], v8
    v_exp_f32 v142, v142
    v_exp_f32 v143, v143
    v_exp_f32 v80, v80
    v_exp_f32 v81, v81
    v_mfma_f32_32x32x8_bf16 v[96:111], v[214:215], v[162:163], 0
    buffer_load_dwordx4 v[192:195], v7, s[20:23], s49 offen sc1
    v_exp_f32 v82, v82
    v_exp_f32 v83, v83
    v_exp_f32 v84, v84
    v_exp_f32 v85, v85
    v_mfma_f32_32x32x16_bf16 v[96:111], v[210:213], v[148:151], v[96:111]
    v_exp_f32 v86, v86
    v_exp_f32 v87, v87
    v_exp_f32 v88, v88
    v_exp_f32 v89, v89
    v_smfmac_f32_32x32x32_bf16 v[64:79], v[206:209], v[136:143], v8
    v_exp_f32 v90, v90
    v_exp_f32 v91, v91
    v_exp_f32 v92, v92
    v_exp_f32 v93, v93
    v_smfmac_f32_32x32x32_bf16 v[16:31], v[216:219], v[80:87], v8
    v_exp_f32 v94, v94
    v_exp_f32 v95, v95
    v_exp_f32 v96, v96
    v_exp_f32 v97, v97
    v_mfma_f32_32x32x8_bf16 v[112:127], v[214:215], v[164:165], 0
    s_add_u32 s49, s49, 262144
    buffer_load_dwordx4 v[196:199], v4, s[20:23], s49 offen sc1
    v_exp_f32 v98, v98
    v_exp_f32 v99, v99
    v_exp_f32 v100, v100
    v_exp_f32 v101, v101
    v_mfma_f32_32x32x16_bf16 v[112:127], v[210:213], v[152:155], v[112:127]
    v_exp_f32 v102, v102
    v_exp_f32 v103, v103
    v_exp_f32 v104, v104
    v_exp_f32 v105, v105
    v_smfmac_f32_32x32x32_bf16 v[16:31], v[220:223], v[88:95], v8
    buffer_load_dword v12, v9, s[20:23], 0 offen sc0 sc1
    v_exp_f32 v106, v106
    v_exp_f32 v107, v107
    v_exp_f32 v108, v108
    v_exp_f32 v109, v109
    v_smfmac_f32_32x32x32_bf16 v[32:47], v[216:219], v[96:103], v8
    v_exp_f32 v110, v110
    v_exp_f32 v111, v111
    v_exp_f32 v112, v112
    v_exp_f32 v113, v113
    v_mfma_f32_32x32x8_bf16 v[128:143], v[214:215], v[166:167], 0
    buffer_load_dwordx2 v[200:201], v5, s[20:23], s49 offen sc1
    v_exp_f32 v114, v114
    v_exp_f32 v115, v115
    v_exp_f32 v116, v116
    v_exp_f32 v117, v117
    v_mfma_f32_32x32x16_bf16 v[128:143], v[210:213], v[156:159], v[128:143]
    v_exp_f32 v118, v118
    v_exp_f32 v119, v119
    v_exp_f32 v120, v120
    v_exp_f32 v121, v121
    v_smfmac_f32_32x32x32_bf16 v[32:47], v[220:223], v[104:111], v8
    buffer_load_dwordx4 v[228:231], v240, s[12:15], 0 offen
    v_exp_f32 v122, v122
    v_exp_f32 v123, v123
    v_exp_f32 v124, v124
    v_exp_f32 v125, v125
    v_smfmac_f32_32x32x32_bf16 v[48:63], v[216:219], v[112:119], v8
    v_exp_f32 v126, v126
    v_exp_f32 v127, v127
    v_exp_f32 v128, v128
    v_exp_f32 v129, v129
    s_waitcnt vmcnt(8)
    v_mfma_f32_32x32x8_bf16 v[80:95], v[172:173], v[160:161], 0
    buffer_load_dwordx4 v[202:205], v6, s[20:23], s49 offen sc1
    v_exp_f32 v130, v130
    v_exp_f32 v131, v131
    v_exp_f32 v132, v132
    v_exp_f32 v133, v133
    v_mfma_f32_32x32x16_bf16 v[80:95], v[168:171], v[144:147], v[80:95]
    v_exp_f32 v134, v134
    v_exp_f32 v135, v135
    v_exp_f32 v136, v136
    v_exp_f32 v137, v137
    v_smfmac_f32_32x32x32_bf16 v[48:63], v[220:223], v[120:127], v8
    s_waitcnt vmcnt(11)
    ds_write_b128 v245, v[224:227] offset:0
    ds_read_b64_tr_b16 v[224:225], v246 offset:0
    ds_read_b64_tr_b16 v[226:227], v246 offset:768
    v_exp_f32 v138, v138
    v_exp_f32 v139, v139
    v_exp_f32 v140, v140
    v_exp_f32 v141, v141
    v_smfmac_f32_32x32x32_bf16 v[64:79], v[216:219], v[128:135], v8
    v_exp_f32 v142, v142
    v_exp_f32 v143, v143
    v_exp_f32 v80, v80
    v_exp_f32 v81, v81
    v_mfma_f32_32x32x8_bf16 v[96:111], v[172:173], v[162:163], 0
    buffer_load_dwordx4 v[206:209], v7, s[20:23], s49 offen sc1
    v_exp_f32 v82, v82
    v_exp_f32 v83, v83
    v_exp_f32 v84, v84
    v_exp_f32 v85, v85
    v_mfma_f32_32x32x16_bf16 v[96:111], v[168:171], v[148:151], v[96:111]
    v_exp_f32 v86, v86
    v_exp_f32 v87, v87
    v_exp_f32 v88, v88
    v_exp_f32 v89, v89
    v_smfmac_f32_32x32x32_bf16 v[64:79], v[220:223], v[136:143], v8
    s_waitcnt lgkmcnt(0)
    buffer_store_dwordx4 v[224:227], v242, s[20:23], 0 offen sc0 sc1
    v_exp_f32 v90, v90
    v_exp_f32 v91, v91
    v_exp_f32 v92, v92
    v_exp_f32 v93, v93
    v_smfmac_f32_32x32x32_bf16 v[16:31], v[174:177], v[80:87], v8
    v_exp_f32 v94, v94
    v_exp_f32 v95, v95
    v_exp_f32 v96, v96
    v_exp_f32 v97, v97
    v_mfma_f32_32x32x8_bf16 v[112:127], v[172:173], v[164:165], 0
    s_add_u32 s49, s49, 262144
    buffer_load_dwordx4 v[210:213], v4, s[20:23], s49 offen sc1
    v_exp_f32 v98, v98
    v_exp_f32 v99, v99
    v_exp_f32 v100, v100
    v_exp_f32 v101, v101
    v_mfma_f32_32x32x16_bf16 v[112:127], v[168:171], v[152:155], v[112:127]
    v_exp_f32 v102, v102
    v_exp_f32 v103, v103
    v_exp_f32 v104, v104
    v_exp_f32 v105, v105
    v_smfmac_f32_32x32x32_bf16 v[16:31], v[178:181], v[88:95], v8
    v_exp_f32 v106, v106
    v_exp_f32 v107, v107
    v_exp_f32 v108, v108
    v_exp_f32 v109, v109
    v_smfmac_f32_32x32x32_bf16 v[32:47], v[174:177], v[96:103], v8
    v_exp_f32 v110, v110
    v_exp_f32 v111, v111
    v_exp_f32 v112, v112
    v_exp_f32 v113, v113
    v_mfma_f32_32x32x8_bf16 v[128:143], v[172:173], v[166:167], 0
    buffer_load_dwordx2 v[214:215], v5, s[20:23], s49 offen sc1
    v_exp_f32 v114, v114
    v_exp_f32 v115, v115
    v_exp_f32 v116, v116
    v_exp_f32 v117, v117
    v_mfma_f32_32x32x16_bf16 v[128:143], v[168:171], v[156:159], v[128:143]
    v_exp_f32 v118, v118
    v_exp_f32 v119, v119
    v_exp_f32 v120, v120
    v_exp_f32 v121, v121
    v_smfmac_f32_32x32x32_bf16 v[32:47], v[178:181], v[104:111], v8
    v_exp_f32 v122, v122
    v_exp_f32 v123, v123
    v_exp_f32 v124, v124
    v_exp_f32 v125, v125
    v_smfmac_f32_32x32x32_bf16 v[48:63], v[174:177], v[112:119], v8
    v_exp_f32 v126, v126
    v_exp_f32 v127, v127
    v_exp_f32 v128, v128
    v_exp_f32 v129, v129
    s_waitcnt vmcnt(9)
    v_mfma_f32_32x32x8_bf16 v[80:95], v[186:187], v[160:161], 0
    buffer_load_dwordx4 v[216:219], v6, s[20:23], s49 offen sc1
    v_exp_f32 v130, v130
    v_exp_f32 v131, v131
    v_exp_f32 v132, v132
    v_exp_f32 v133, v133
    v_mfma_f32_32x32x16_bf16 v[80:95], v[182:185], v[144:147], v[80:95]
    v_exp_f32 v134, v134
    v_exp_f32 v135, v135
    v_exp_f32 v136, v136
    v_exp_f32 v137, v137
    v_smfmac_f32_32x32x32_bf16 v[48:63], v[178:181], v[120:127], v8
    s_waitcnt vmcnt(8)
    v_cmp_ne_u32 vcc, s3, v12
    s_nop 0
    s_cbranch_vccz L_poll0_far_done
    s_mov_b32 s62, 0
    s_waitcnt vmcnt(0)
L_poll0_far:
    buffer_load_dword v12, v9, s[20:23], 0 offen offset:0 sc0 sc1
    s_add_u32 s62, s62, 1
    s_waitcnt vmcnt(0)
    v_cmp_ne_u32 vcc, s3, v12
    s_cmp_gt_u32 s62, 400000
    s_cbranch_scc1 L_poll0_far_done
    s_cbranch_vccz L_poll0_far_done
    s_sleep 4
    s_branch L_poll0_far
L_poll0_far_done:
    v_exp_f32 v138, v138
    v_exp_f32 v139, v139
    v_exp_f32 v140, v140
    v_exp_f32 v141, v141
    v_smfmac_f32_32x32x32_bf16 v[64:79], v[174:177], v[128:135], v8
    v_exp_f32 v142, v142
    v_exp_f32 v143, v143
    v_exp_f32 v80, v80
    v_exp_f32 v81, v81
    v_mfma_f32_32x32x8_bf16 v[96:111], v[186:187], v[162:163], 0
    buffer_load_dwordx4 v[220:223], v7, s[20:23], s49 offen sc1
    v_exp_f32 v82, v82
    v_exp_f32 v83, v83
    v_exp_f32 v84, v84
    v_exp_f32 v85, v85
    v_mfma_f32_32x32x16_bf16 v[96:111], v[182:185], v[148:151], v[96:111]
    v_exp_f32 v86, v86
    v_exp_f32 v87, v87
    v_exp_f32 v88, v88
    v_exp_f32 v89, v89
    v_smfmac_f32_32x32x32_bf16 v[64:79], v[178:181], v[136:143], v8
    v_exp_f32 v90, v90
    v_exp_f32 v91, v91
    v_exp_f32 v92, v92
    v_exp_f32 v93, v93
    v_smfmac_f32_32x32x32_bf16 v[16:31], v[188:191], v[80:87], v8
    v_exp_f32 v94, v94
    v_exp_f32 v95, v95
    v_exp_f32 v96, v96
    v_exp_f32 v97, v97
    v_mfma_f32_32x32x8_bf16 v[112:127], v[186:187], v[164:165], 0
    s_mov_b32 s49, s48
    buffer_load_dwordx4 v[168:171], v4, s[20:23], s49 offen sc1
    v_exp_f32 v98, v98
    v_exp_f32 v99, v99
    v_exp_f32 v100, v100
    v_exp_f32 v101, v101
    v_mfma_f32_32x32x16_bf16 v[112:127], v[182:185], v[152:155], v[112:127]
    v_exp_f32 v102, v102
    v_exp_f32 v103, v103
    v_exp_f32 v104, v104
    v_exp_f32 v105, v105
    v_smfmac_f32_32x32x32_bf16 v[16:31], v[192:195], v[88:95], v8
    v_exp_f32 v106, v106
    v_exp_f32 v107, v107
    v_exp_f32 v108, v108
    v_exp_f32 v109, v109
    v_smfmac_f32_32x32x32_bf16 v[32:47], v[188:191], v[96:103], v8
    v_exp_f32 v110, v110
    v_exp_f32 v111, v111
    v_exp_f32 v112, v112
    v_exp_f32 v113, v113
    v_mfma_f32_32x32x8_bf16 v[128:143], v[186:187], v[166:167], 0
    buffer_load_dwordx2 v[172:173], v5, s[20:23], s49 offen sc1
    v_exp_f32 v114, v114
    v_exp_f32 v115, v115
    v_exp_f32 v116, v116
    v_exp_f32 v117, v117
    v_mfma_f32_32x32x16_bf16 v[128:143], v[182:185], v[156:159], v[128:143]
    v_exp_f32 v118, v118
    v_exp_f32 v119, v119
    v_exp_f32 v120, v120
    v_exp_f32 v121, v121
    v_smfmac_f32_32x32x32_bf16 v[32:47], v[192:195], v[104:111], v8
    buffer_load_dwordx4 v[232:235], v241, s[16:19], 0 offen
    v_exp_f32 v122, v122
    v_exp_f32 v123, v123
    v_exp_f32 v124, v124
    v_exp_f32 v125, v125
    v_smfmac_f32_32x32x32_bf16 v[48:63], v[188:191], v[112:119], v8
    v_exp_f32 v126, v126
    v_exp_f32 v127, v127
    v_exp_f32 v128, v128
    v_exp_f32 v129, v129
    s_waitcnt vmcnt(8)
    v_mfma_f32_32x32x8_bf16 v[80:95], v[200:201], v[160:161], 0
    buffer_load_dwordx4 v[174:177], v6, s[20:23], s49 offen sc1
    v_exp_f32 v130, v130
    v_exp_f32 v131, v131
    v_exp_f32 v132, v132
    v_exp_f32 v133, v133
    v_mfma_f32_32x32x16_bf16 v[80:95], v[196:199], v[144:147], v[80:95]
    v_exp_f32 v134, v134
    v_exp_f32 v135, v135
    v_exp_f32 v136, v136
    v_exp_f32 v137, v137
    v_smfmac_f32_32x32x32_bf16 v[48:63], v[192:195], v[120:127], v8
    s_waitcnt vmcnt(11)
    ds_write_b128 v245, v[228:231] offset:1536
    ds_read_b64_tr_b16 v[228:229], v246 offset:1536
    ds_read_b64_tr_b16 v[230:231], v246 offset:2304
    v_exp_f32 v138, v138
    v_exp_f32 v139, v139
    v_exp_f32 v140, v140
    v_exp_f32 v141, v141
    v_smfmac_f32_32x32x32_bf16 v[64:79], v[188:191], v[128:135], v8
    v_exp_f32 v142, v142
    v_exp_f32 v143, v143
    v_exp_f32 v80, v80
    v_exp_f32 v81, v81
    v_mfma_f32_32x32x8_bf16 v[96:111], v[200:201], v[162:163], 0
    buffer_load_dwordx4 v[178:181], v7, s[20:23], s49 offen sc1
    v_exp_f32 v82, v82
    v_exp_f32 v83, v83
    v_exp_f32 v84, v84
    v_exp_f32 v85, v85
    v_mfma_f32_32x32x16_bf16 v[96:111], v[196:199], v[148:151], v[96:111]
    v_exp_f32 v86, v86
    v_exp_f32 v87, v87
    v_exp_f32 v88, v88
    v_exp_f32 v89, v89
    v_smfmac_f32_32x32x32_bf16 v[64:79], v[192:195], v[136:143], v8
    s_waitcnt lgkmcnt(0)
    buffer_store_dwordx4 v[228:231], v243, s[20:23], 0 offen sc0 sc1
    v_exp_f32 v90, v90
    v_exp_f32 v91, v91
    v_exp_f32 v92, v92
    v_exp_f32 v93, v93
    v_smfmac_f32_32x32x32_bf16 v[16:31], v[202:205], v[80:87], v8
    v_exp_f32 v94, v94
    v_exp_f32 v95, v95
    v_exp_f32 v96, v96
    v_exp_f32 v97, v97
    v_mfma_f32_32x32x8_bf16 v[112:127], v[200:201], v[164:165], 0
    s_add_u32 s49, s49, 262144
    buffer_load_dwordx4 v[182:185], v4, s[20:23], s49 offen sc1
    v_exp_f32 v98, v98
    v_exp_f32 v99, v99
    v_exp_f32 v100, v100
    v_exp_f32 v101, v101
    v_mfma_f32_32x32x16_bf16 v[112:127], v[196:199], v[152:155], v[112:127]
    v_exp_f32 v102, v102
    v_exp_f32 v103, v103
    v_exp_f32 v104, v104
    v_exp_f32 v105, v105
    v_smfmac_f32_32x32x32_bf16 v[16:31], v[206:209], v[88:95], v8
    v_exp_f32 v106, v106
    v_exp_f32 v107, v107
    v_exp_f32 v108, v108
    v_exp_f32 v109, v109
    v_smfmac_f32_32x32x32_bf16 v[32:47], v[202:205], v[96:103], v8
    v_exp_f32 v110, v110
    v_exp_f32 v111, v111
    v_exp_f32 v112, v112
    v_exp_f32 v113, v113
    v_mfma_f32_32x32x8_bf16 v[128:143], v[200:201], v[166:167], 0
    buffer_load_dwordx2 v[186:187], v5, s[20:23], s49 offen sc1
    v_exp_f32 v114, v114
    v_exp_f32 v115, v115
    v_exp_f32 v116, v116
    v_exp_f32 v117, v117
    v_mfma_f32_32x32x16_bf16 v[128:143], v[196:199], v[156:159], v[128:143]
    v_exp_f32 v118, v118
    v_exp_f32 v119, v119
    v_exp_f32 v120, v120
    v_exp_f32 v121, v121
    v_smfmac_f32_32x32x32_bf16 v[32:47], v[206:209], v[104:111], v8
    v_exp_f32 v122, v122
    v_exp_f32 v123, v123
    v_exp_f32 v124, v124
    v_exp_f32 v125, v125
    v_smfmac_f32_32x32x32_bf16 v[48:63], v[202:205], v[112:119], v8
    v_exp_f32 v126, v126
    v_exp_f32 v127, v127
    v_exp_f32 v128, v128
    v_exp_f32 v129, v129
    s_waitcnt vmcnt(8)
    v_mfma_f32_32x32x8_bf16 v[80:95], v[214:215], v[160:161], 0
    buffer_load_dwordx4 v[188:191], v6, s[20:23], s49 offen sc1
    v_exp_f32 v130, v130
    v_exp_f32 v131, v131
    v_exp_f32 v132, v132
    v_exp_f32 v133, v133
    v_mfma_f32_32x32x16_bf16 v[80:95], v[210:213], v[144:147], v[80:95]
    v_exp_f32 v134, v134
    v_exp_f32 v135, v135
    v_exp_f32 v136, v136
    v_exp_f32 v137, v137
    v_smfmac_f32_32x32x32_bf16 v[48:63], v[206:209], v[120:127], v8
    v_exp_f32 v138, v138
    v_exp_f32 v139, v139
    v_exp_f32 v140, v140
    v_exp_f32 v141, v141
    v_smfmac_f32_32x32x32_bf16 v[64:79], v[202:205], v[128:135], v8
    v_exp_f32 v142, v142
    v_exp_f32 v143, v143
    v_exp_f32 v80, v80
    v_exp_f32 v81, v81
    v_mfma_f32_32x32x8_bf16 v[96:111], v[214:215], v[162:163], 0
    buffer_load_dwordx4 v[192:195], v7, s[20:23], s49 offen sc1
    v_exp_f32 v82, v82
    v_exp_f32 v83, v83
    v_exp_f32 v84, v84
    v_exp_f32 v85, v85
    v_mfma_f32_32x32x16_bf16 v[96:111], v[210:213], v[148:151], v[96:111]
    v_exp_f32 v86, v86
    v_exp_f32 v87, v87
    v_exp_f32 v88, v88
    v_exp_f32 v89, v89
    v_smfmac_f32_32x32x32_bf16 v[64:79], v[206:209], v[136:143], v8
    v_exp_f32 v90, v90
    v_exp_f32 v91, v91
    v_exp_f32 v92, v92
    v_exp_f32 v93, v93
    v_smfmac_f32_32x32x32_bf16 v[16:31], v[216:219], v[80:87], v8
    v_exp_f32 v94, v94
    v_exp_f32 v95, v95
    v_exp_f32 v96, v96
    v_exp_f32 v97, v97
    v_mfma_f32_32x32x8_bf16 v[112:127], v[214:215], v[164:165], 0
    s_add_u32 s49, s49, 262144
    buffer_load_dwordx4 v[196:199], v4, s[20:23], s49 offen sc1
    v_exp_f32 v98, v98
    v_exp_f32 v99, v99
    v_exp_f32 v100, v100
    v_exp_f32 v101, v101
    v_mfma_f32_32x32x16_bf16 v[112:127], v[210:213], v[152:155], v[112:127]
    v_exp_f32 v102, v102
    v_exp_f32 v103, v103
    v_exp_f32 v104, v104
    v_exp_f32 v105, v105
    v_smfmac_f32_32x32x32_bf16 v[16:31], v[220:223], v[88:95], v8
    v_exp_f32 v106, v106
    v_exp_f32 v107, v107
    v_exp_f32 v108, v108
    v_exp_f32 v109, v109
    v_smfmac_f32_32x32x32_bf16 v[32:47], v[216:219], v[96:103], v8
    v_exp_f32 v110, v110
    v_exp_f32 v111, v111
    v_exp_f32 v112, v112
    v_exp_f32 v113, v113
    v_mfma_f32_32x32x8_bf16 v[128:143], v[214:215], v[166:167], 0
    buffer_load_dwordx2 v[200:201], v5, s[20:23], s49 offen sc1
    v_exp_f32 v114, v114
    v_exp_f32 v115, v115
    v_exp_f32 v116, v116
    v_exp_f32 v117, v117
    v_mfma_f32_32x32x16_bf16 v[128:143], v[210:213], v[156:159], v[128:143]
    v_exp_f32 v118, v118
    v_exp_f32 v119, v119
    v_exp_f32 v120, v120
    v_exp_f32 v121, v121
    v_smfmac_f32_32x32x32_bf16 v[32:47], v[220:223], v[104:111], v8
    v_exp_f32 v122, v122
    v_exp_f32 v123, v123
    v_exp_f32 v124, v124
    v_exp_f32 v125, v125
    v_smfmac_f32_32x32x32_bf16 v[48:63], v[216:219], v[112:119], v8
    v_exp_f32 v126, v126
    v_exp_f32 v127, v127
    v_exp_f32 v128, v128
    v_exp_f32 v129, v129
    s_waitcnt vmcnt(7)
    v_mfma_f32_32x32x8_bf16 v[80:95], v[172:173], v[160:161], 0
    buffer_load_dwordx4 v[202:205], v6, s[20:23], s49 offen sc1
    v_exp_f32 v130, v130
    v_exp_f32 v131, v131
    v_exp_f32 v132, v132
    v_exp_f32 v133, v133
    v_mfma_f32_32x32x16_bf16 v[80:95], v[168:171], v[144:147], v[80:95]
    v_exp_f32 v134, v134
    v_exp_f32 v135, v135
    v_exp_f32 v136, v136
    v_exp_f32 v137, v137
    v_smfmac_f32_32x32x32_bf16 v[48:63], v[220:223], v[120:127], v8
    s_waitcnt vmcnt(10)
    ds_write_b128 v245, v[232:235] offset:3072
    ds_read_b64_tr_b16 v[232:233], v246 offset:3072
    ds_read_b64_tr_b16 v[234:235], v246 offset:3840
    v_exp_f32 v138, v138
    v_exp_f32 v139, v139
    v_exp_f32 v140, v140
    v_exp_f32 v141, v141
    v_smfmac_f32_32x32x32_bf16 v[64:79], v[216:219], v[128:135], v8
    v_exp_f32 v142, v142
    v_exp_f32 v143, v143
    v_exp_f32 v80, v80
    v_exp_f32 v81, v81
    v_mfma_f32_32x32x8_bf16 v[96:111], v[172:173], v[162:163], 0
    buffer_load_dwordx4 v[206:209], v7, s[20:23], s49 offen sc1
    v_exp_f32 v82, v82
    v_exp_f32 v83, v83
    v_exp_f32 v84, v84
    v_exp_f32 v85, v85
    v_mfma_f32_32x32x16_bf16 v[96:111], v[168:171], v[148:151], v[96:111]
    v_exp_f32 v86, v86
    v_exp_f32 v87, v87
    v_exp_f32 v88, v88
    v_exp_f32 v89, v89
    v_smfmac_f32_32x32x32_bf16 v[64:79], v[220:223], v[136:143], v8
    s_waitcnt lgkmcnt(0)
    buffer_store_dwordx4 v[232:235], v244, s[20:23], 0 offen sc0 sc1
    v_exp_f32 v90, v90
    v_exp_f32 v91, v91
    v_exp_f32 v92, v92
    v_exp_f32 v93, v93
    v_smfmac_f32_32x32x32_bf16 v[16:31], v[174:177], v[80:87], v8
    v_exp_f32 v94, v94
    v_exp_f32 v95, v95
    v_exp_f32 v96, v96
    v_exp_f32 v97, v97
    v_mfma_f32_32x32x8_bf16 v[112:127], v[172:173], v[164:165], 0
    s_add_u32 s49, s49, 262144
    buffer_load_dwordx4 v[210:213], v4, s[20:23], s49 offen sc1
    v_exp_f32 v98, v98
    v_exp_f32 v99, v99
    v_exp_f32 v100, v100
    v_exp_f32 v101, v101
    v_mfma_f32_32x32x16_bf16 v[112:127], v[168:171], v[152:155], v[112:127]
    v_exp_f32 v102, v102
    v_exp_f32 v103, v103
    v_exp_f32 v104, v104
    v_exp_f32 v105, v105
    v_smfmac_f32_32x32x32_bf16 v[16:31], v[178:181], v[88:95], v8
    v_exp_f32 v106, v106
    v_exp_f32 v107, v107
    v_exp_f32 v108, v108
    v_exp_f32 v109, v109
    v_smfmac_f32_32x32x32_bf16 v[32:47], v[174:177], v[96:103], v8
    v_exp_f32 v110, v110
    v_exp_f32 v111, v111
    v_exp_f32 v112, v112
    v_exp_f32 v113, v113
    v_mfma_f32_32x32x8_bf16 v[128:143], v[172:173], v[166:167], 0
    buffer_load_dwordx2 v[214:215], v5, s[20:23], s49 offen sc1
    v_exp_f32 v114, v114
    v_exp_f32 v115, v115
    v_exp_f32 v116, v116
    v_exp_f32 v117, v117
    v_mfma_f32_32x32x16_bf16 v[128:143], v[168:171], v[156:159], v[128:143]
    v_exp_f32 v118, v118
    v_exp_f32 v119, v119
    v_exp_f32 v120, v120
    v_exp_f32 v121, v121
    v_smfmac_f32_32x32x32_bf16 v[32:47], v[178:181], v[104:111], v8
    v_exp_f32 v122, v122
    v_exp_f32 v123, v123
    v_exp_f32 v124, v124
    v_exp_f32 v125, v125
    v_smfmac_f32_32x32x32_bf16 v[48:63], v[174:177], v[112:119], v8
    v_exp_f32 v126, v126
    v_exp_f32 v127, v127
    v_exp_f32 v128, v128
    v_exp_f32 v129, v129
    s_waitcnt vmcnt(7)
    v_mfma_f32_32x32x8_bf16 v[80:95], v[186:187], v[160:161], 0
    buffer_load_dwordx4 v[216:219], v6, s[20:23], s49 offen sc1
    v_exp_f32 v130, v130
    v_exp_f32 v131, v131
    v_exp_f32 v132, v132
    v_exp_f32 v133, v133
    v_mfma_f32_32x32x16_bf16 v[80:95], v[182:185], v[144:147], v[80:95]
    v_exp_f32 v134, v134
    v_exp_f32 v135, v135
    v_exp_f32 v136, v136
    v_exp_f32 v137, v137
    v_smfmac_f32_32x32x32_bf16 v[48:63], v[178:181], v[120:127], v8
    v_exp_f32 v138, v138
    v_exp_f32 v139, v139
    v_exp_f32 v140, v140
    v_exp_f32 v141, v141
    v_smfmac_f32_32x32x32_bf16 v[64:79], v[174:177], v[128:135], v8
    v_exp_f32 v142, v142
    v_exp_f32 v143, v143
    v_exp_f32 v80, v80
    v_exp_f32 v81, v81
    v_mfma_f32_32x32x8_bf16 v[96:111], v[186:187], v[162:163], 0
    buffer_load_dwordx4 v[220:223], v7, s[20:23], s49 offen sc1
    v_exp_f32 v82, v82
    v_exp_f32 v83, v83
    v_exp_f32 v84, v84
    v_exp_f32 v85, v85
    v_mfma_f32_32x32x16_bf16 v[96:111], v[182:185], v[148:151], v[96:111]
    v_exp_f32 v86, v86
    v_exp_f32 v87, v87
    v_exp_f32 v88, v88
    v_exp_f32 v89, v89
    v_smfmac_f32_32x32x32_bf16 v[64:79], v[178:181], v[136:143], v8
    s_mov_b32 s60, 0
    buffer_load_dword v238, v236, s[8:11], s60 offen
    v_exp_f32 v90, v90
    v_exp_f32 v91, v91
    v_exp_f32 v92, v92
    v_exp_f32 v93, v93
    v_smfmac_f32_32x32x32_bf16 v[16:31], v[188:191], v[80:87], v8
    v_exp_f32 v94, v94
    v_exp_f32 v95, v95
    v_exp_f32 v96, v96
    v_exp_f32 v97, v97
    v_mfma_f32_32x32x8_bf16 v[112:127], v[186:187], v[164:165], 0
    s_add_u32 s49, s49, 262144
    buffer_load_dwordx4 v[168:171], v4, s[20:23], s49 offen sc1
    v_exp_f32 v98, v98
    v_exp_f32 v99, v99
    v_exp_f32 v100, v100
    v_exp_f32 v101, v101
    v_mfma_f32_32x32x16_bf16 v[112:127], v[182:185], v[152:155], v[112:127]
    v_exp_f32 v102, v102
    v_exp_f32 v103, v103
    v_exp_f32 v104, v104
    v_exp_f32 v105, v105
    v_smfmac_f32_32x32x32_bf16 v[16:31], v[192:195], v[88:95], v8
    v_exp_f32 v106, v106
    v_exp_f32 v107, v107
    v_exp_f32 v108, v108
    v_exp_f32 v109, v109
    v_smfmac_f32_32x32x32_bf16 v[32:47], v[188:191], v[96:103], v8
    v_exp_f32 v110, v110
    v_exp_f32 v111, v111
    v_exp_f32 v112, v112
    v_exp_f32 v113, v113
    v_mfma_f32_32x32x8_bf16 v[128:143], v[186:187], v[166:167], 0
    buffer_load_dwordx2 v[172:173], v5, s[20:23], s49 offen sc1
    v_exp_f32 v114, v114
    v_exp_f32 v115, v115
    v_exp_f32 v116, v116
    v_exp_f32 v117, v117
    v_mfma_f32_32x32x16_bf16 v[128:143], v[182:185], v[156:159], v[128:143]
    v_exp_f32 v118, v118
    v_exp_f32 v119, v119
    v_exp_f32 v120, v120
    v_exp_f32 v121, v121
    v_smfmac_f32_32x32x32_bf16 v[32:47], v[192:195], v[104:111], v8
    v_exp_f32 v122, v122
    v_exp_f32 v123, v123
    v_exp_f32 v124, v124
    v_exp_f32 v125, v125
    v_smfmac_f32_32x32x32_bf16 v[48:63], v[188:191], v[112:119], v8
    v_exp_f32 v126, v126
    v_exp_f32 v127, v127
    v_exp_f32 v128, v128
    v_exp_f32 v129, v129
    s_waitcnt vmcnt(8)
    v_mfma_f32_32x32x8_bf16 v[80:95], v[200:201], v[160:161], 0
    buffer_load_dwordx4 v[174:177], v6, s[20:23], s49 offen sc1
    v_exp_f32 v130, v130
    v_exp_f32 v131, v131
    v_exp_f32 v132, v132
    v_exp_f32 v133, v133
    v_mfma_f32_32x32x16_bf16 v[80:95], v[196:199], v[144:147], v[80:95]
    v_exp_f32 v134, v134
    v_exp_f32 v135, v135
    v_exp_f32 v136, v136
    v_exp_f32 v137, v137
    v_smfmac_f32_32x32x32_bf16 v[48:63], v[192:195], v[120:127], v8
    v_exp_f32 v138, v138
    v_exp_f32 v139, v139
    v_exp_f32 v140, v140
    v_exp_f32 v141, v141
    v_smfmac_f32_32x32x32_bf16 v[64:79], v[188:191], v[128:135], v8
    v_exp_f32 v142, v142
    v_exp_f32 v143, v143
    v_exp_f32 v80, v80
    v_exp_f32 v81, v81
    v_mfma_f32_32x32x8_bf16 v[96:111], v[200:201], v[162:163], 0
    buffer_load_dwordx4 v[178:181], v7, s[20:23], s49 offen sc1
    v_exp_f32 v82, v82
    v_exp_f32 v83, v83
    v_exp_f32 v84, v84
    v_exp_f32 v85, v85
    v_mfma_f32_32x32x16_bf16 v[96:111], v[196:199], v[148:151], v[96:111]
    v_exp_f32 v86, v86
    v_exp_f32 v87, v87
    v_exp_f32 v88, v88
    v_exp_f32 v89, v89
    v_smfmac_f32_32x32x32_bf16 v[64:79], v[192:195], v[136:143], v8
    v_exp_f32 v90, v90
    v_exp_f32 v91, v91
    v_exp_f32 v92, v92
    v_exp_f32 v93, v93
    v_smfmac_f32_32x32x32_bf16 v[16:31], v[202:205], v[80:87], v8
    v_exp_f32 v94, v94
    v_exp_f32 v95, v95
    v_exp_f32 v96, v96
    v_exp_f32 v97, v97
    v_mfma_f32_32x32x8_bf16 v[112:127], v[200:201], v[164:165], 0
    s_add_u32 s49, s49, 262144
    buffer_load_dwordx4 v[182:185], v4, s[20:23], s49 offen sc1
    v_exp_f32 v98, v98
    v_exp_f32 v99, v99
    v_exp_f32 v100, v100
    v_exp_f32 v101, v101
    v_mfma_f32_32x32x16_bf16 v[112:127], v[196:199], v[152:155], v[112:127]
    v_exp_f32 v102, v102
    v_exp_f32 v103, v103
    v_exp_f32 v104, v104
    v_exp_f32 v105, v105
    v_smfmac_f32_32x32x32_bf16 v[16:31], v[206:209], v[88:95], v8
    s_waitcnt vmcnt(10)
    s_mov_b64 exec, 1
    ds_add_rtn_u32 v13, v10, v11
    s_mov_b64 exec, -1
    v_exp_f32 v106, v106
    v_exp_f32 v107, v107
    v_exp_f32 v108, v108
    v_exp_f32 v109, v109
    v_smfmac_f32_32x32x32_bf16 v[32:47], v[202:205], v[96:103], v8
    v_exp_f32 v110, v110
    v_exp_f32 v111, v111
    v_exp_f32 v112, v112
    v_exp_f32 v113, v113
    v_mfma_f32_32x32x8_bf16 v[128:143], v[200:201], v[166:167], 0
    buffer_load_dwordx2 v[186:187], v5, s[20:23], s49 offen sc1
    v_exp_f32 v114, v114
    v_exp_f32 v115, v115
    v_exp_f32 v116, v116
    v_exp_f32 v117, v117
    v_mfma_f32_32x32x16_bf16 v[128:143], v[196:199], v[156:159], v[128:143]
    v_exp_f32 v118, v118
    v_exp_f32 v119, v119
    v_exp_f32 v120, v120
    v_exp_f32 v121, v121
    v_smfmac_f32_32x32x32_bf16 v[32:47], v[206:209], v[104:111], v8
    s_waitcnt lgkmcnt(0)
    v_cmp_eq_u32 vcc, 3, v13
    s_mov_b64 exec, 1
    v_mov_b32 v13, 0x40000000
    v_cndmask_b32 v13, v13, v249, vcc
    buffer_store_dword v248, v13, s[20:23], 0 offen sc0 sc1
    s_mov_b64 exec, -1
    s_mov_b32 s60, 3456
    buffer_load_dword v238, v236, s[8:11], s60 offen
    v_exp_f32 v122, v122
    v_exp_f32 v123, v123
    v_exp_f32 v124, v124
    v_exp_f32 v125, v125
    v_smfmac_f32_32x32x32_bf16 v[48:63], v[202:205], v[112:119], v8
    v_exp_f32 v126, v126
    v_exp_f32 v127, v127
    v_exp_f32 v128, v128
    v_exp_f32 v129, v129
    s_waitcnt vmcnt(9)
    v_mfma_f32_32x32x8_bf16 v[80:95], v[214:215], v[160:161], 0
    buffer_load_dwordx4 v[188:191], v6, s[20:23], s49 offen sc1
    v_exp_f32 v130, v130
    v_exp_f32 v131, v131
    v_exp_f32 v132, v132
    v_exp_f32 v133, v133
    v_mfma_f32_32x32x16_bf16 v[80:95], v[210:213], v[144:147], v[80:95]
    v_exp_f32 v134, v134
    v_exp_f32 v135, v135
    v_exp_f32 v136, v136
    v_exp_f32 v137, v137
    v_smfmac_f32_32x32x32_bf16 v[48:63], v[206:209], v[120:127], v8
    v_exp_f32 v138, v138
    v_exp_f32 v139, v139
    v_exp_f32 v140, v140
    v_exp_f32 v141, v141
    v_smfmac_f32_32x32x32_bf16 v[64:79], v[202:205], v[128:135], v8
    v_exp_f32 v142, v142
    v_exp_f32 v143, v143
    v_exp_f32 v80, v80
    v_exp_f32 v81, v81
    v_mfma_f32_32x32x8_bf16 v[96:111], v[214:215], v[162:163], 0
    buffer_load_dwordx4 v[192:195], v7, s[20:23], s49 offen sc1
    v_exp_f32 v82, v82
    v_exp_f32 v83, v83
    v_exp_f32 v84, v84
    v_exp_f32 v85, v85
    v_mfma_f32_32x32x16_bf16 v[96:111], v[210:213], v[148:151], v[96:111]
    v_exp_f32 v86, v86
    v_exp_f32 v87, v87
    v_exp_f32 v88, v88
    v_exp_f32 v89, v89
    v_smfmac_f32_32x32x32_bf16 v[64:79], v[206:209], v[136:143], v8
    v_exp_f32 v90, v90
    v_exp_f32 v91, v91
    v_exp_f32 v92, v92
    v_exp_f32 v93, v93
    v_smfmac_f32_32x32x32_bf16 v[16:31], v[216:219], v[80:87], v8
    v_exp_f32 v94, v94
    v_exp_f32 v95, v95
    v_exp_f32 v96, v96
    v_exp_f32 v97, v97
    v_mfma_f32_32x32x8_bf16 v[112:127], v[214:215], v[164:165], 0
    s_add_u32 s49, s49, 262144
    buffer_load_dwordx4 v[196:199], v4, s[20:23], s49 offen sc1
    v_exp_f32 v98, v98
    v_exp_f32 v99, v99
    v_exp_f32 v100, v100
    v_exp_f32 v101, v101
    v_mfma_f32_32x32x16_bf16 v[112:127], v[210:213], v[152:155], v[112:127]
    v_exp_f32 v102, v102
    v_exp_f32 v103, v103
    v_exp_f32 v104, v104
    v_exp_f32 v105, v105
    v_smfmac_f32_32x32x32_bf16 v[16:31], v[220:223], v[88:95], v8
    v_exp_f32 v106, v106
    v_exp_f32 v107, v107
    v_exp_f32 v108, v108
    v_exp_f32 v109, v109
    v_smfmac_f32_32x32x32_bf16 v[32:47], v[216:219], v[96:103], v8
    v_exp_f32 v110, v110
    v_exp_f32 v111, v111
    v_exp_f32 v112, v112
    v_exp_f32 v113, v113
    v_mfma_f32_32x32x8_bf16 v[128:143], v[214:215], v[166:167], 0
    buffer_load_dwordx2 v[200:201], v5, s[20:23], s49 offen sc1
    v_exp_f32 v114, v114
    v_exp_f32 v115, v115
    v_exp_f32 v116, v116
    v_exp_f32 v117, v117
    v_mfma_f32_32x32x16_bf16 v[128:143], v[210:213], v[156:159], v[128:143]
    v_exp_f32 v118, v118
    v_exp_f32 v119, v119
    v_exp_f32 v120, v120
    v_exp_f32 v121, v121
    v_smfmac_f32_32x32x32_bf16 v[32:47], v[220:223], v[104:111], v8
    v_exp_f32 v122, v122
    v_exp_f32 v123, v123
    v_exp_f32 v124, v124
    v_exp_f32 v125, v125
    v_smfmac_f32_32x32x32_bf16 v[48:63], v[216:219], v[112:119], v8
    v_exp_f32 v126, v126
    v_exp_f32 v127, v127
    v_exp_f32 v128, v128
    v_exp_f32 v129, v129
    s_waitcnt vmcnt(8)
    v_mfma_f32_32x32x8_bf16 v[80:95], v[172:173], v[160:161], 0
    buffer_load_dwordx4 v[202:205], v6, s[20:23], s49 offen sc1
    v_exp_f32 v130, v130
    v_exp_f32 v131, v131
    v_exp_f32 v132, v132
    v_exp_f32 v133, v133
    v_mfma_f32_32x32x16_bf16 v[80:95], v[168:171], v[144:147], v[80:95]
    v_exp_f32 v134, v134
    v_exp_f32 v135, v135
    v_exp_f32 v136, v136
    v_exp_f32 v137, v137
    v_smfmac_f32_32x32x32_bf16 v[48:63], v[220:223], v[120:127], v8
    v_lshlrev_b32 v10, 4, v1
    s_add_u32 s53, s44, 1
    s_and_b32 s53, s53, 3
    s_mul_i32 s53, s53, 9216
    s_add_u32 s53, s53, 90112
    v_add_u32 v11, s53, v10
    s_add_u32 s53, s44, 2
    s_and_b32 s53, s53, 3
    s_mul_i32 s53, s53, 9216
    s_add_u32 s53, s53, 90112
    v_add_u32 v12, s53, v10
    s_add_u32 s53, s44, 3
    s_and_b32 s53, s53, 3
    s_mul_i32 s53, s53, 9216
    s_add_u32 s53, s53, 90112
    v_add_u32 v13, s53, v10
    s_add_u32 s53, s44, 4
    s_and_b32 s53, s53, 3
    s_mul_i32 s53, s53, 9216
    s_add_u32 s53, s53, 90112
    v_add_u32 v10, s53, v10
    v_exp_f32 v138, v138
    v_exp_f32 v139, v139
    v_exp_f32 v140, v140
    v_exp_f32 v141, v141
    v_smfmac_f32_32x32x32_bf16 v[64:79], v[216:219], v[128:135], v8
    v_exp_f32 v142, v142
    v_exp_f32 v143, v143
    v_exp_f32 v80, v80
    v_exp_f32 v81, v81
    v_mfma_f32_32x32x8_bf16 v[96:111], v[172:173], v[162:163], 0
    buffer_load_dwordx4 v[206:209], v7, s[20:23], s49 offen sc1
    v_exp_f32 v82, v82
    v_exp_f32 v83, v83
    v_exp_f32 v84, v84
    v_exp_f32 v85, v85
    v_mfma_f32_32x32x16_bf16 v[96:111], v[168:171], v[148:151], v[96:111]
    v_exp_f32 v86, v86
    v_exp_f32 v87, v87
    v_exp_f32 v88, v88
    v_exp_f32 v89, v89
    v_smfmac_f32_32x32x32_bf16 v[64:79], v[220:223], v[136:143], v8
    s_mov_b32 s60, 6912
    buffer_load_dword v238, v236, s[8:11], s60 offen
    v_exp_f32 v90, v90
    v_exp_f32 v91, v91
    v_exp_f32 v92, v92
    v_exp_f32 v93, v93
    v_smfmac_f32_32x32x32_bf16 v[16:31], v[174:177], v[80:87], v8
    v_exp_f32 v94, v94
    v_exp_f32 v95, v95
    v_exp_f32 v96, v96
    v_exp_f32 v97, v97
    v_mfma_f32_32x32x8_bf16 v[112:127], v[172:173], v[164:165], 0
    s_add_u32 s49, s49, 262144
    buffer_load_dwordx4 v[210:213], v4, s[20:23], s49 offen sc1
    v_exp_f32 v98, v98
    v_exp_f32 v99, v99
    v_exp_f32 v100, v100
    v_exp_f32 v101, v101
    v_mfma_f32_32x32x16_bf16 v[112:127], v[168:171], v[152:155], v[112:127]
    v_exp_f32 v102, v102
    v_exp_f32 v103, v103
    v_exp_f32 v104, v104
    v_exp_f32 v105, v105
    v_smfmac_f32_32x32x32_bf16 v[16:31], v[178:181], v[88:95], v8
    v_exp_f32 v106, v106
    v_exp_f32 v107, v107
    v_exp_f32 v108, v108
    v_exp_f32 v109, v109
    v_smfmac_f32_32x32x32_bf16 v[32:47], v[174:177], v[96:103], v8
    v_exp_f32 v110, v110
    v_exp_f32 v111, v111
    v_exp_f32 v112, v112
    v_exp_f32 v113, v113
    s_setprio 1
    v_mfma_f32_32x32x8_bf16 v[128:143], v[172:173], v[166:167], 0
    buffer_load_dwordx2 v[214:215], v5, s[20:23], s49 offen sc1
    v_exp_f32 v114, v114
    v_exp_f32 v115, v115
    v_exp_f32 v116, v116
    v_exp_f32 v117, v117
    v_mfma_f32_32x32x16_bf16 v[128:143], v[168:171], v[156:159], v[128:143]
    v_exp_f32 v118, v118
    v_exp_f32 v119, v119
    v_exp_f32 v120, v120
    v_exp_f32 v121, v121
    v_smfmac_f32_32x32x32_bf16 v[32:47], v[178:181], v[104:111], v8
    s_and_b32 s60, s2, 0xf8
    s_add_u32 s60, s60, s40
    s_mul_i32 s60, s60, 128
    s_min_u32 s60, s60, L_tail_end-L_att_tail-128
    s_add_u32 s60, s60, L_att_tail-L_pc
    s_load_dword s62, s[100:101], s60 offset:0
    s_load_dword s62, s[100:101], s60 offset:64
    v_exp_f32 v122, v122
    v_exp_f32 v123, v123
    v_exp_f32 v124, v124
    v_exp_f32 v125, v125
    v_smfmac_f32_32x32x32_bf16 v[48:63], v[174:177], v[112:119], v8
    v_exp_f32 v126, v126
    v_exp_f32 v127, v127
    v_exp_f32 v128, v128
    v_exp_f32 v129, v129
    s_waitcnt vmcnt(7)
    v_mfma_f32_32x32x8_bf16 v[80:95], v[186:187], v[160:161], 0
    buffer_load_dwordx4 v[216:219], v6, s[20:23], s49 offen sc1
    v_exp_f32 v130, v130
    v_exp_f32 v131, v131
    v_exp_f32 v132, v132
    v_exp_f32 v133, v133
    v_mfma_f32_32x32x16_bf16 v[80:95], v[182:185], v[144:147], v[80:95]
    v_exp_f32 v134, v134
    v_exp_f32 v135, v135
    v_exp_f32 v136, v136
    v_exp_f32 v137, v137
    v_smfmac_f32_32x32x32_bf16 v[48:63], v[178:181], v[120:127], v8
    v_exp_f32 v138, v138
    v_exp_f32 v139, v139
    v_exp_f32 v140, v140
    v_exp_f32 v141, v141
    v_smfmac_f32_32x32x32_bf16 v[64:79], v[174:177], v[128:135], v8
    v_exp_f32 v142, v142
    v_exp_f32 v143, v143
    v_exp_f32 v80, v80
    v_exp_f32 v81, v81
    v_mfma_f32_32x32x8_bf16 v[96:111], v[186:187], v[162:163], 0
    buffer_load_dwordx4 v[220:223], v7, s[20:23], s49 offen sc1
    v_exp_f32 v82, v82
    v_exp_f32 v83, v83
    v_exp_f32 v84, v84
    v_exp_f32 v85, v85
    v_mfma_f32_32x32x16_bf16 v[96:111], v[182:185], v[148:151], v[96:111]
    v_exp_f32 v86, v86
    v_exp_f32 v87, v87
    v_exp_f32 v88, v88
    v_exp_f32 v89, v89
    v_smfmac_f32_32x32x32_bf16 v[64:79], v[178:181], v[136:143], v8
    v_exp_f32 v90, v90
    v_exp_f32 v91, v91
    v_exp_f32 v92, v92
    v_exp_f32 v93, v93
    v_smfmac_f32_32x32x32_bf16 v[16:31], v[188:191], v[80:87], v8
    v_exp_f32 v94, v94
    v_exp_f32 v95, v95
    v_exp_f32 v96, v96
    v_exp_f32 v97, v97
    v_mfma_f32_32x32x8_bf16 v[112:127], v[186:187], v[164:165], 0
    v_exp_f32 v98, v98
    v_exp_f32 v99, v99
    v_exp_f32 v100, v100
    v_exp_f32 v101, v101
    v_mfma_f32_32x32x16_bf16 v[112:127], v[182:185], v[152:155], v[112:127]
    v_exp_f32 v102, v102
    v_exp_f32 v103, v103
    v_exp_f32 v104, v104
    v_exp_f32 v105, v105
    v_smfmac_f32_32x32x32_bf16 v[16:31], v[192:195], v[88:95], v8
    v_exp_f32 v106, v106
    v_exp_f32 v107, v107
    v_exp_f32 v108, v108
    v_exp_f32 v109, v109
    v_smfmac_f32_32x32x32_bf16 v[32:47], v[188:191], v[96:103], v8
    v_exp_f32 v110, v110
    v_exp_f32 v111, v111
    v_exp_f32 v112, v112
    v_exp_f32 v113, v113
    v_mfma_f32_32x32x8_bf16 v[128:143], v[186:187], v[166:167], 0
    v_exp_f32 v114, v114
    v_exp_f32 v115, v115
    v_exp_f32 v116, v116
    v_exp_f32 v117, v117
    v_mfma_f32_32x32x16_bf16 v[128:143], v[182:185], v[156:159], v[128:143]
    v_exp_f32 v118, v118
    v_exp_f32 v119, v119
    v_exp_f32 v120, v120
    v_exp_f32 v121, v121
    v_smfmac_f32_32x32x32_bf16 v[32:47], v[192:195], v[104:111], v8
    v_exp_f32 v122, v122
    v_exp_f32 v123, v123
    v_exp_f32 v124, v124
    v_exp_f32 v125, v125
    v_smfmac_f32_32x32x32_bf16 v[48:63], v[188:191], v[112:119], v8
    v_exp_f32 v126, v126
    v_exp_f32 v127, v127
    v_exp_f32 v128, v128
    v_exp_f32 v129, v129
    s_waitcnt vmcnt(5)
    v_mfma_f32_32x32x8_bf16 v[80:95], v[200:201], v[160:161], 0
    v_exp_f32 v130, v130
    v_exp_f32 v131, v131
    v_exp_f32 v132, v132
    v_exp_f32 v133, v133
    v_mfma_f32_32x32x16_bf16 v[80:95], v[196:199], v[144:147], v[80:95]
    v_exp_f32 v134, v134
    v_exp_f32 v135, v135
    v_exp_f32 v136, v136
    v_exp_f32 v137, v137
    v_smfmac_f32_32x32x32_bf16 v[48:63], v[192:195], v[120:127], v8
    v_exp_f32 v138, v138
    v_exp_f32 v139, v139
    v_exp_f32 v140, v140
    v_exp_f32 v141, v141
    v_smfmac_f32_32x32x32_bf16 v[64:79], v[188:191], v[128:135], v8
    v_exp_f32 v142, v142
    v_exp_f32 v143, v143
    v_exp_f32 v80, v80
    v_exp_f32 v81, v81
    v_mfma_f32_32x32x8_bf16 v[96:111], v[200:201], v[162:163], 0
    v_exp_f32 v82, v82
    v_exp_f32 v83, v83
    v_exp_f32 v84, v84
    v_exp_f32 v85, v85
    v_mfma_f32_32x32x16_bf16 v[96:111], v[196:199], v[148:151], v[96:111]
    v_exp_f32 v86, v86
    v_exp_f32 v87, v87
    v_exp_f32 v88, v88
    v_exp_f32 v89, v89
    v_smfmac_f32_32x32x32_bf16 v[64:79], v[192:195], v[136:143], v8
    v_exp_f32 v90, v90
    v_exp_f32 v91, v91
    v_exp_f32 v92, v92
    v_exp_f32 v93, v93
    v_smfmac_f32_32x32x32_bf16 v[16:31], v[202:205], v[80:87], v8
    v_exp_f32 v94, v94
    v_exp_f32 v95, v95
    v_exp_f32 v96, v96
    v_exp_f32 v97, v97
    v_mfma_f32_32x32x8_bf16 v[112:127], v[200:201], v[164:165], 0
    v_exp_f32 v98, v98
    v_exp_f32 v99, v99
    v_exp_f32 v100, v100
    v_exp_f32 v101, v101
    v_mfma_f32_32x32x16_bf16 v[112:127], v[196:199], v[152:155], v[112:127]
    v_exp_f32 v102, v102
    v_exp_f32 v103, v103
    v_exp_f32 v104, v104
    v_exp_f32 v105, v105
    v_smfmac_f32_32x32x32_bf16 v[16:31], v[206:209], v[88:95], v8
    v_exp_f32 v106, v106
    v_exp_f32 v107, v107
    v_exp_f32 v108, v108
    v_exp_f32 v109, v109
    v_smfmac_f32_32x32x32_bf16 v[32:47], v[202:205], v[96:103], v8
    v_exp_f32 v110, v110
    v_exp_f32 v111, v111
    v_exp_f32 v112, v112
    v_exp_f32 v113, v113
    v_mfma_f32_32x32x8_bf16 v[128:143], v[200:201], v[166:167], 0
    v_exp_f32 v114, v114
    v_exp_f32 v115, v115
    v_exp_f32 v116, v116
    v_exp_f32 v117, v117
    v_mfma_f32_32x32x16_bf16 v[128:143], v[196:199], v[156:159], v[128:143]
    v_exp_f32 v118, v118
    v_exp_f32 v119, v119
    v_exp_f32 v120, v120
    v_exp_f32 v121, v121
    v_smfmac_f32_32x32x32_bf16 v[32:47], v[206:209], v[104:111], v8
    v_exp_f32 v122, v122
    v_exp_f32 v123, v123
    v_exp_f32 v124, v124
    v_exp_f32 v125, v125
    v_smfmac_f32_32x32x32_bf16 v[48:63], v[202:205], v[112:119], v8
    v_exp_f32 v126, v126
    v_exp_f32 v127, v127
    v_exp_f32 v128, v128
    v_exp_f32 v129, v129
    s_waitcnt vmcnt(0)
    v_mfma_f32_32x32x8_bf16 v[80:95], v[214:215], v[160:161], 0
    v_exp_f32 v130, v130
    v_exp_f32 v131, v131
    v_exp_f32 v132, v132
    v_exp_f32 v133, v133
    v_mfma_f32_32x32x16_bf16 v[80:95], v[210:213], v[144:147], v[80:95]
    v_exp_f32 v134, v134
    v_exp_f32 v135, v135
    v_exp_f32 v136, v136
    v_exp_f32 v137, v137
    v_smfmac_f32_32x32x32_bf16 v[48:63], v[206:209], v[120:127], v8
    v_exp_f32 v138, v138
    v_exp_f32 v139, v139
    v_exp_f32 v140, v140
    v_exp_f32 v141, v141
    v_smfmac_f32_32x32x32_bf16 v[64:79], v[202:205], v[128:135], v8
    v_exp_f32 v142, v142
    v_exp_f32 v143, v143
    v_exp_f32 v80, v80
    v_exp_f32 v81, v81
    v_mfma_f32_32x32x8_bf16 v[96:111], v[214:215], v[162:163], 0
    v_exp_f32 v82, v82
    v_exp_f32 v83, v83
    v_exp_f32 v84, v84
    v_exp_f32 v85, v85
    v_mfma_f32_32x32x16_bf16 v[96:111], v[210:213], v[148:151], v[96:111]
    v_exp_f32 v86, v86
    v_exp_f32 v87, v87
    v_exp_f32 v88, v88
    v_exp_f32 v89, v89
    v_smfmac_f32_32x32x32_bf16 v[64:79], v[206:209], v[136:143], v8
    v_exp_f32 v90, v90
    v_exp_f32 v91, v91
    v_exp_f32 v92, v92
    v_exp_f32 v93, v93
    v_smfmac_f32_32x32x32_bf16 v[16:31], v[216:219], v[80:87], v8
    v_exp_f32 v94, v94
    v_exp_f32 v95, v95
    v_exp_f32 v96, v96
    v_exp_f32 v97, v97
    v_mfma_f32_32x32x8_bf16 v[112:127], v[214:215], v[164:165], 0
    v_exp_f32 v98, v98
    v_exp_f32 v99, v99
    v_exp_f32 v100, v100
    v_exp_f32 v101, v101
    v_mfma_f32_32x32x16_bf16 v[112:127], v[210:213], v[152:155], v[112:127]
    v_exp_f32 v102, v102
    v_exp_f32 v103, v103
    v_exp_f32 v104, v104
    v_exp_f32 v105, v105
    v_smfmac_f32_32x32x32_bf16 v[16:31], v[220:223], v[88:95], v8
    v_exp_f32 v106, v106
    v_exp_f32 v107, v107
    v_exp_f32 v108, v108
    v_exp_f32 v109, v109
    v_smfmac_f32_32x32x32_bf16 v[32:47], v[216:219], v[96:103], v8
    v_exp_f32 v110, v110
    v_exp_f32 v111, v111
    v_exp_f32 v112, v112
    v_exp_f32 v113, v113
    v_mfma_f32_32x32x8_bf16 v[128:143], v[214:215], v[166:167], 0
    v_exp_f32 v114, v114
    v_exp_f32 v115, v115
    v_exp_f32 v116, v116
    v_exp_f32 v117, v117
    v_mfma_f32_32x32x16_bf16 v[128:143], v[210:213], v[156:159], v[128:143]
    v_exp_f32 v118, v118
    v_exp_f32 v119, v119
    ds_write_b128 v11, v[16:19] offset:0
    v_exp_f32 v120, v120
    v_exp_f32 v121, v121
    v_smfmac_f32_32x32x32_bf16 v[32:47], v[220:223], v[104:111], v8
    v_exp_f32 v122, v122
    v_exp_f32 v123, v123
    ds_write_b128 v11, v[20:23] offset:1024
    v_exp_f32 v124, v124
    v_exp_f32 v125, v125
    v_smfmac_f32_32x32x32_bf16 v[48:63], v[216:219], v[112:119], v8
    v_exp_f32 v126, v126
    ds_write_b128 v11, v[24:27] offset:2048
    v_exp_f32 v127, v127
    v_exp_f32 v128, v128
    v_exp_f32 v129, v129
    v_exp_f32 v130, v130
    v_exp_f32 v131, v131
    v_exp_f32 v132, v132
    v_exp_f32 v133, v133
    v_exp_f32 v134, v134
    v_exp_f32 v135, v135
    ds_write_b128 v12, v[32:35] offset:3072
    v_exp_f32 v136, v136
    v_exp_f32 v137, v137
    v_smfmac_f32_32x32x32_bf16 v[48:63], v[220:223], v[120:127], v8
    v_exp_f32 v138, v138
    v_exp_f32 v139, v139
    ds_write_b128 v12, v[36:39] offset:4096
    v_exp_f32 v140, v140
    v_exp_f32 v141, v141
    v_smfmac_f32_32x32x32_bf16 v[64:79], v[216:219], v[128:135], v8
    v_exp_f32 v142, v142
    ds_write_b128 v12, v[40:43] offset:5120
    v_exp_f32 v143, v143
    s_mul_i32 s53, s44, 9216
    s_add_u32 s53, s53, 90112
    v_smfmac_f32_32x32x32_bf16 v[64:79], v[220:223], v[136:143], v8
    s_setprio 3
    s_nop 0
    ds_write_b128 v13, v[48:51] offset:6144
    ds_write_b128 v13, v[52:55] offset:7168
    ds_write_b128 v13, v[56:59] offset:8192
    v_and_b32 v12, 31, v1
    v_lshl_add_u32 v12, v12, 3, s53
    s_mov_b32 s52, 0x71800000
    s_mov_b32 s53, 0x2b800000
    s_waitcnt lgkmcnt(0)
    s_barrier
    ds_read_b128 v[80:83], v10 offset:0
    ds_read_b128 v[84:87], v10 offset:1024
    ds_read_b128 v[88:91], v10 offset:2048
    ds_read_b128 v[92:95], v10 offset:3072
    ds_read_b128 v[96:99], v10 offset:4096
    ds_read_b128 v[100:103], v10 offset:5120
    ds_read_b128 v[104:107], v10 offset:6144
    ds_read_b128 v[108:111], v10 offset:7168
    ds_read_b128 v[112:115], v10 offset:8192
    s_waitcnt lgkmcnt(6)
    v_add_f32 v64, v64, v80
    v_add_f32 v65, v65, v81
    v_add_f32 v66, v66, v82
    v_add_f32 v67, v67, v83
    v_add_f32 v68, v68, v84
    v_add_f32 v69, v69, v85
    v_add_f32 v70, v70, v86
    v_add_f32 v71, v71, v87
    v_add_f32 v72, v72, v88
    v_add_f32 v73, v73, v89
    v_add_f32 v74, v74, v90
    v_add_f32 v75, v75, v91
    s_waitcnt lgkmcnt(3)
    v_add_f32 v64, v64, v92
    v_add_f32 v65, v65, v93
    v_add_f32 v66, v66, v94
    v_add_f32 v67, v67, v95
    v_add_f32 v68, v68, v96
    v_add_f32 v69, v69, v97
    v_add_f32 v70, v70, v98
    v_add_f32 v71, v71, v99
    v_add_f32 v72, v72, v100
    v_add_f32 v73, v73, v101
    v_add_f32 v74, v74, v102
    v_add_f32 v75, v75, v103
    s_waitcnt lgkmcnt(0)
    v_add_f32 v64, v64, v104
    v_add_f32 v65, v65, v105
    v_add_f32 v66, v66, v106
    v_add_f32 v67, v67, v107
    v_add_f32 v68, v68, v108
    v_add_f32 v69, v69, v109
    v_add_f32 v70, v70, v110
    v_add_f32 v71, v71, v111
    v_add_f32 v72, v72, v112
    v_add_f32 v73, v73, v113
    v_add_f32 v74, v74, v114
    v_add_f32 v75, v75, v115
    v_mov_b32 v13, v72
    v_mov_b32 v14, v72
    v_maximum3_f32 v15, |v64|, |v65|, |v66|
    v_maximum3_f32 v15, v15, |v67|, |v68|
    v_permlane32_swap_b32 v13, v14
    v_maximum3_f32 v15, v15, |v69|, |v70|
    v_maximum3_f32 v15, v15, |v71|, |v72|
    v_maximum3_f32 v15, v15, |v73|, |v74|
    v_maximum3_f32 v15, v15, |v75|, |v75|
    v_cmp_nle_f32 s[58:59], s53, v14
    v_cmp_nge_f32 vcc, s52, v15
    s_nop 0
    s_or_b64 vcc, vcc, s[58:59]
    s_cbranch_vccnz L_att_fallback
L_att_norm0:
    v_rcp_f32 v14, v14
    s_nop 0
    v_mul_f32 v64, v14, v64
    v_mul_f32 v65, v14, v65
    v_mul_f32 v66, v14, v66
    v_mul_f32 v67, v14, v67
    v_mul_f32 v68, v14, v68
    v_mul_f32 v69, v14, v69
    v_mul_f32 v70, v14, v70
    v_mul_f32 v71, v14, v71
    v_mul_f32 v72, v14, v72
    v_mul_f32 v73, v14, v73
    v_mul_f32 v74, v14, v74
    v_mul_f32 v75, v14, v75
    v_cvt_pk_bf16_f32 v116, v64, v65
    v_cvt_pk_bf16_f32 v117, v66, v67
    v_cvt_pk_bf16_f32 v118, v68, v69
    v_cvt_pk_bf16_f32 v119, v70, v71
    v_cvt_pk_bf16_f32 v122, v72, v73
    v_cvt_pk_bf16_f32 v123, v74, v75
    v_permlane32_swap_b32 v116, v118
    v_permlane32_swap_b32 v117, v119
    buffer_store_dwordx4 v[116:119], v4, s[20:23], s47 offen sc0 sc1
    s_waitcnt lgkmcnt(0)
    s_mov_b32 exec_hi, 0
    ds_write_b64 v12, v[122:123]
    s_mov_b32 exec_hi, -1
    s_waitcnt lgkmcnt(0)
    s_branch L_tail_helper
L_att_b:
    v_mov_b32 v16, 0
    v_mov_b32 v17, 0
    v_mov_b32 v18, 0
    v_mov_b32 v19, 0
    v_mov_b32 v20, 0
    v_mov_b32 v21, 0
    v_mov_b32 v22, 0
    v_mov_b32 v23, 0
    v_mov_b32 v24, 0
    v_mov_b32 v25, 0
    v_mov_b32 v26, 0
    v_mov_b32 v27, 0
    v_mov_b32 v28, 0
    v_mov_b32 v29, 0
    v_mov_b32 v30, 0
    v_mov_b32 v31, 0
    v_mov_b32 v32, 0
    v_mov_b32 v33, 0
    v_mov_b32 v34, 0
    v_mov_b32 v35, 0
    v_mov_b32 v36, 0
    v_mov_b32 v37, 0
    v_mov_b32 v38, 0
    v_mov_b32 v39, 0
    v_mov_b32 v40, 0
    v_mov_b32 v41, 0
    v_mov_b32 v42, 0
    v_mov_b32 v43, 0
    v_mov_b32 v44, 0
    v_mov_b32 v45, 0
    v_mov_b32 v46, 0
    v_mov_b32 v47, 0
    v_mov_b32 v48, 0
    v_mov_b32 v49, 0
    v_mov_b32 v50, 0
    v_mov_b32 v51, 0
    v_mov_b32 v52, 0
    v_mov_b32 v53, 0
    v_mov_b32 v54, 0
    v_mov_b32 v55, 0
    v_mov_b32 v56, 0
    v_mov_b32 v57, 0
    v_mov_b32 v58, 0
    v_mov_b32 v59, 0
    v_mov_b32 v60, 0
    v_mov_b32 v61, 0
    v_mov_b32 v62, 0
    v_mov_b32 v63, 0
    v_mov_b32 v64, 0
    v_mov_b32 v65, 0
    v_mov_b32 v66, 0
    v_mov_b32 v67, 0
    v_mov_b32 v68, 0
    v_mov_b32 v69, 0
    v_mov_b32 v70, 0
    v_mov_b32 v71, 0
    v_mov_b32 v72, 0
    v_mov_b32 v73, 0
    v_mov_b32 v74, 0
    v_mov_b32 v75, 0
    v_mov_b32 v76, 0
    v_mov_b32 v77, 0
    v_mov_b32 v78, 0
    v_mov_b32 v79, 0
    buffer_load_dwordx2 v[160:161], v5, s[20:23], s54 offen sc1
    buffer_load_dwordx4 v[144:147], v4, s[20:23], s54 offen sc1
    buffer_load_dwordx2 v[172:173], v5, s[20:23], s49 offen sc1
    buffer_load_dwordx4 v[168:171], v4, s[20:23], s49 offen sc1
    buffer_load_dwordx2 v[162:163], v5, s[20:23], s55 offen sc1
    buffer_load_dwordx4 v[148:151], v4, s[20:23], s55 offen sc1
    buffer_load_dwordx4 v[174:177], v6, s[20:23], s49 offen sc1
    buffer_load_dwordx2 v[164:165], v5, s[20:23], s56 offen sc1
    buffer_load_dwordx4 v[152:155], v4, s[20:23], s56 offen sc1
    buffer_load_dwordx4 v[178:181], v7, s[20:23], s49 offen sc1
    buffer_load_dwordx2 v[166:167], v5, s[20:23], s57 offen sc1
    buffer_load_dwordx4 v[156:159], v4, s[20:23], s57 offen sc1
    s_add_u32 s49, s49, 262144
    buffer_load_dwordx4 v[182:185], v4, s[20:23], s49 offen sc1
    buffer_load_dwordx2 v[186:187], v5, s[20:23], s49 offen sc1
    buffer_load_dwordx4 v[188:191], v6, s[20:23], s49 offen sc1
    buffer_load_dwordx4 v[192:195], v7, s[20:23], s49 offen sc1
    s_waitcnt vmcnt(12)
    v_cndmask_b32 v160, 0, v160, s[50:51]
    v_cndmask_b32 v161, 0, v161, s[50:51]
    s_nop 1
    v_mfma_f32_32x32x8_bf16 v[80:95], v[172:173], v[160:161], 0
    v_mfma_f32_32x32x16_bf16 v[80:95], v[168:171], v[144:147], v[80:95]
    s_waitcnt vmcnt(10)
    v_cndmask_b32 v162, 0, v162, s[50:51]
    v_cndmask_b32 v163, 0, v163, s[50:51]
    s_nop 8
    v_exp_f32 v80, v80
    v_exp_f32 v81, v81
    v_mfma_f32_32x32x8_bf16 v[96:111], v[172:173], v[162:163], 0
    s_add_u32 s49, s49, 262144
    buffer_load_dwordx4 v[196:199], v4, s[20:23], s49 offen sc1
    v_exp_f32 v82, v82
    v_exp_f32 v83, v83
    v_exp_f32 v84, v84
    v_exp_f32 v85, v85
    v_mfma_f32_32x32x16_bf16 v[96:111], v[168:171], v[148:151], v[96:111]
    v_exp_f32 v86, v86
    v_exp_f32 v87, v87
    v_exp_f32 v88, v88
    v_exp_f32 v89, v89
    s_nop 0
    buffer_load_dwordx2 v[200:201], v5, s[20:23], s49 offen sc1
    v_exp_f32 v90, v90
    v_exp_f32 v91, v91
    v_exp_f32 v92, v92
    v_exp_f32 v93, v93
    s_waitcnt vmcnt(8)
    v_cndmask_b32 v164, 0, v164, s[50:51]
    v_cndmask_b32 v165, 0, v165, s[50:51]
    v_smfmac_f32_32x32x32_bf16 v[16:31], v[174:177], v[80:87], v8
    v_exp_f32 v94, v94
    v_exp_f32 v95, v95
    v_exp_f32 v96, v96
    v_exp_f32 v97, v97
    v_mfma_f32_32x32x8_bf16 v[112:127], v[172:173], v[164:165], 0
    buffer_load_dwordx4 v[202:205], v6, s[20:23], s49 offen sc1
    v_exp_f32 v98, v98
    v_exp_f32 v99, v99
    v_exp_f32 v100, v100
    v_exp_f32 v101, v101
    v_mfma_f32_32x32x16_bf16 v[112:127], v[168:171], v[152:155], v[112:127]
    v_exp_f32 v102, v102
    v_exp_f32 v103, v103
    v_exp_f32 v104, v104
    v_exp_f32 v105, v105
    v_smfmac_f32_32x32x32_bf16 v[16:31], v[178:181], v[88:95], v8
    buffer_load_dwordx4 v[206:209], v7, s[20:23], s49 offen sc1
    v_exp_f32 v106, v106
    v_exp_f32 v107, v107
    v_exp_f32 v108, v108
    v_exp_f32 v109, v109
    s_waitcnt vmcnt(8)
    v_cndmask_b32 v166, 0, v166, s[50:51]
    v_cndmask_b32 v167, 0, v167, s[50:51]
    v_smfmac_f32_32x32x32_bf16 v[32:47], v[174:177], v[96:103], v8
    v_exp_f32 v110, v110
    v_exp_f32 v111, v111
    v_exp_f32 v112, v112
    v_exp_f32 v113, v113
    v_mfma_f32_32x32x8_bf16 v[128:143], v[172:173], v[166:167], 0
    s_add_u32 s49, s49, 262144
    buffer_load_dwordx4 v[210:213], v4, s[20:23], s49 offen sc1
    v_exp_f32 v114, v114
    v_exp_f32 v115, v115
    v_exp_f32 v116, v116
    v_exp_f32 v117, v117
    v_mfma_f32_32x32x16_bf16 v[128:143], v[168:171], v[156:159], v[128:143]
    v_exp_f32 v118, v118
    v_exp_f32 v119, v119
    v_exp_f32 v120, v120
    v_exp_f32 v121, v121
    v_smfmac_f32_32x32x32_bf16 v[32:47], v[178:181], v[104:111], v8
    buffer_load_dwordx2 v[214:215], v5, s[20:23], s49 offen sc1
    v_exp_f32 v122, v122
    v_exp_f32 v123, v123
    v_exp_f32 v124, v124
    v_exp_f32 v125, v125
    v_smfmac_f32_32x32x32_bf16 v[48:63], v[174:177], v[112:119], v8
    v_exp_f32 v126, v126
    v_exp_f32 v127, v127
    v_exp_f32 v128, v128
    v_exp_f32 v129, v129
    s_waitcnt vmcnt(6)
    v_mfma_f32_32x32x8_bf16 v[80:95], v[186:187], v[160:161], 0
    buffer_load_dwordx4 v[216:219], v6, s[20:23], s49 offen sc1
    v_exp_f32 v130, v130
    v_exp_f32 v131, v131
    v_exp_f32 v132, v132
    v_exp_f32 v133, v133
    v_mfma_f32_32x32x16_bf16 v[80:95], v[182:185], v[144:147], v[80:95]
    v_exp_f32 v134, v134
    v_exp_f32 v135, v135
    v_exp_f32 v136, v136
    v_exp_f32 v137, v137
    v_smfmac_f32_32x32x32_bf16 v[48:63], v[178:181], v[120:127], v8
    buffer_load_dwordx4 v[220:223], v7, s[20:23], s49 offen sc1
    v_exp_f32 v138, v138
    v_exp_f32 v139, v139
    v_exp_f32 v140, v140
    v_exp_f32 v141, v141
    v_smfmac_f32_32x32x32_bf16 v[64:79], v[174:177], v[128:135], v8
    v_exp_f32 v142, v142
    v_exp_f32 v143, v143
    v_exp_f32 v80, v80
    v_exp_f32 v81, v81
    v_mfma_f32_32x32x8_bf16 v[96:111], v[186:187], v[162:163], 0
    v_exp_f32 v82, v82
    v_exp_f32 v83, v83
    v_exp_f32 v84, v84
    v_exp_f32 v85, v85
    v_mfma_f32_32x32x16_bf16 v[96:111], v[182:185], v[148:151], v[96:111]
    v_exp_f32 v86, v86
    v_exp_f32 v87, v87
    v_exp_f32 v88, v88
    v_exp_f32 v89, v89
    v_smfmac_f32_32x32x32_bf16 v[64:79], v[178:181], v[136:143], v8
    v_exp_f32 v90, v90
    v_exp_f32 v91, v91
    v_exp_f32 v92, v92
    v_exp_f32 v93, v93
    v_smfmac_f32_32x32x32_bf16 v[16:31], v[188:191], v[80:87], v8
    v_exp_f32 v94, v94
    v_exp_f32 v95, v95
    v_exp_f32 v96, v96
    v_exp_f32 v97, v97
    v_mfma_f32_32x32x8_bf16 v[112:127], v[186:187], v[164:165], 0
    s_add_u32 s49, s49, 262144
    buffer_load_dwordx4 v[168:171], v4, s[20:23], s49 offen sc1
    v_exp_f32 v98, v98
    v_exp_f32 v99, v99
    v_exp_f32 v100, v100
    v_exp_f32 v101, v101
    v_mfma_f32_32x32x16_bf16 v[112:127], v[182:185], v[152:155], v[112:127]
    v_exp_f32 v102, v102
    v_exp_f32 v103, v103
    v_exp_f32 v104, v104
    v_exp_f32 v105, v105
    v_smfmac_f32_32x32x32_bf16 v[16:31], v[192:195], v[88:95], v8
    v_exp_f32 v106, v106
    v_exp_f32 v107, v107
    v_exp_f32 v108, v108
    v_exp_f32 v109, v109
    v_smfmac_f32_32x32x32_bf16 v[32:47], v[188:191], v[96:103], v8
    v_exp_f32 v110, v110
    v_exp_f32 v111, v111
    v_exp_f32 v112, v112
    v_exp_f32 v113, v113
    v_mfma_f32_32x32x8_bf16 v[128:143], v[186:187], v[166:167], 0
    buffer_load_dwordx2 v[172:173], v5, s[20:23], s49 offen sc1
    v_exp_f32 v114, v114
    v_exp_f32 v115, v115
    v_exp_f32 v116, v116
    v_exp_f32 v117, v117
    v_mfma_f32_32x32x16_bf16 v[128:143], v[182:185], v[156:159], v[128:143]
    v_exp_f32 v118, v118
    v_exp_f32 v119, v119
    v_exp_f32 v120, v120
    v_exp_f32 v121, v121
    v_smfmac_f32_32x32x32_bf16 v[32:47], v[192:195], v[104:111], v8
    v_exp_f32 v122, v122
    v_exp_f32 v123, v123
    v_exp_f32 v124, v124
    v_exp_f32 v125, v125
    v_smfmac_f32_32x32x32_bf16 v[48:63], v[188:191], v[112:119], v8
    v_exp_f32 v126, v126
    v_exp_f32 v127, v127
    v_exp_f32 v128, v128
    v_exp_f32 v129, v129
    s_waitcnt vmcnt(6)
    v_mfma_f32_32x32x8_bf16 v[80:95], v[200:201], v[160:161], 0
    buffer_load_dwordx4 v[174:177], v6, s[20:23], s49 offen sc1
    v_exp_f32 v130, v130
    v_exp_f32 v131, v131
    v_exp_f32 v132, v132
    v_exp_f32 v133, v133
    v_mfma_f32_32x32x16_bf16 v[80:95], v[196:199], v[144:147], v[80:95]
    v_exp_f32 v134, v134
    v_exp_f32 v135, v135
    v_exp_f32 v136, v136
    v_exp_f32 v137, v137
    v_smfmac_f32_32x32x32_bf16 v[48:63], v[192:195], v[120:127], v8
    v_exp_f32 v138, v138
    v_exp_f32 v139, v139
    v_exp_f32 v140, v140
    v_exp_f32 v141, v141
    v_smfmac_f32_32x32x32_bf16 v[64:79], v[188:191], v[128:135], v8
    v_exp_f32 v142, v142
    v_exp_f32 v143, v143
    v_exp_f32 v80, v80
    v_exp_f32 v81, v81
    v_mfma_f32_32x32x8_bf16 v[96:111], v[200:201], v[162:163], 0
    buffer_load_dwordx4 v[178:181], v7, s[20:23], s49 offen sc1
    v_exp_f32 v82, v82
    v_exp_f32 v83, v83
    v_exp_f32 v84, v84
    v_exp_f32 v85, v85
    v_mfma_f32_32x32x16_bf16 v[96:111], v[196:199], v[148:151], v[96:111]
    v_exp_f32 v86, v86
    v_exp_f32 v87, v87
    v_exp_f32 v88, v88
    v_exp_f32 v89, v89
    v_smfmac_f32_32x32x32_bf16 v[64:79], v[192:195], v[136:143], v8
    v_exp_f32 v90, v90
    v_exp_f32 v91, v91
    v_exp_f32 v92, v92
    v_exp_f32 v93, v93
    v_smfmac_f32_32x32x32_bf16 v[16:31], v[202:205], v[80:87], v8
    v_exp_f32 v94, v94
    v_exp_f32 v95, v95
    v_exp_f32 v96, v96
    v_exp_f32 v97, v97
    v_mfma_f32_32x32x8_bf16 v[112:127], v[200:201], v[164:165], 0
    s_add_u32 s49, s49, 262144
    buffer_load_dwordx4 v[182:185], v4, s[20:23], s49 offen sc1
    v_exp_f32 v98, v98
    v_exp_f32 v99, v99
    v_exp_f32 v100, v100
    v_exp_f32 v101, v101
    v_mfma_f32_32x32x16_bf16 v[112:127], v[196:199], v[152:155], v[112:127]
    v_exp_f32 v102, v102
    v_exp_f32 v103, v103
    v_exp_f32 v104, v104
    v_exp_f32 v105, v105
    v_smfmac_f32_32x32x32_bf16 v[16:31], v[206:209], v[88:95], v8
    v_exp_f32 v106, v106
    v_exp_f32 v107, v107
    v_exp_f32 v108, v108
    v_exp_f32 v109, v109
    v_smfmac_f32_32x32x32_bf16 v[32:47], v[202:205], v[96:103], v8
    v_exp_f32 v110, v110
    v_exp_f32 v111, v111
    v_exp_f32 v112, v112
    v_exp_f32 v113, v113
    v_mfma_f32_32x32x8_bf16 v[128:143], v[200:201], v[166:167], 0
    buffer_load_dwordx2 v[186:187], v5, s[20:23], s49 offen sc1
    v_exp_f32 v114, v114
    v_exp_f32 v115, v115
    v_exp_f32 v116, v116
    v_exp_f32 v117, v117
    v_mfma_f32_32x32x16_bf16 v[128:143], v[196:199], v[156:159], v[128:143]
    v_exp_f32 v118, v118
    v_exp_f32 v119, v119
    v_exp_f32 v120, v120
    v_exp_f32 v121, v121
    v_smfmac_f32_32x32x32_bf16 v[32:47], v[206:209], v[104:111], v8
    v_exp_f32 v122, v122
    v_exp_f32 v123, v123
    v_exp_f32 v124, v124
    v_exp_f32 v125, v125
    v_smfmac_f32_32x32x32_bf16 v[48:63], v[202:205], v[112:119], v8
    v_exp_f32 v126, v126
    v_exp_f32 v127, v127
    v_exp_f32 v128, v128
    v_exp_f32 v129, v129
    s_waitcnt vmcnt(6)
    v_mfma_f32_32x32x8_bf16 v[80:95], v[214:215], v[160:161], 0
    buffer_load_dwordx4 v[188:191], v6, s[20:23], s49 offen sc1
    v_exp_f32 v130, v130
    v_exp_f32 v131, v131
    v_exp_f32 v132, v132
    v_exp_f32 v133, v133
    v_mfma_f32_32x32x16_bf16 v[80:95], v[210:213], v[144:147], v[80:95]
    v_exp_f32 v134, v134
    v_exp_f32 v135, v135
    v_exp_f32 v136, v136
    v_exp_f32 v137, v137
    v_smfmac_f32_32x32x32_bf16 v[48:63], v[206:209], v[120:127], v8
    v_exp_f32 v138, v138
    v_exp_f32 v139, v139
    v_exp_f32 v140, v140
    v_exp_f32 v141, v141
    v_smfmac_f32_32x32x32_bf16 v[64:79], v[202:205], v[128:135], v8
    v_exp_f32 v142, v142
    v_exp_f32 v143, v143
    v_exp_f32 v80, v80
    v_exp_f32 v81, v81
    v_mfma_f32_32x32x8_bf16 v[96:111], v[214:215], v[162:163], 0
    buffer_load_dwordx4 v[192:195], v7, s[20:23], s49 offen sc1
    v_exp_f32 v82, v82
    v_exp_f32 v83, v83
    v_exp_f32 v84, v84
    v_exp_f32 v85, v85
    v_mfma_f32_32x32x16_bf16 v[96:111], v[210:213], v[148:151], v[96:111]
    v_exp_f32 v86, v86
    v_exp_f32 v87, v87
    v_exp_f32 v88, v88
    v_exp_f32 v89, v89
    v_smfmac_f32_32x32x32_bf16 v[64:79], v[206:209], v[136:143], v8
    v_exp_f32 v90, v90
    v_exp_f32 v91, v91
    v_exp_f32 v92, v92
    v_exp_f32 v93, v93
    v_smfmac_f32_32x32x32_bf16 v[16:31], v[216:219], v[80:87], v8
    v_exp_f32 v94, v94
    v_exp_f32 v95, v95
    v_exp_f32 v96, v96
    v_exp_f32 v97, v97
    v_mfma_f32_32x32x8_bf16 v[112:127], v[214:215], v[164:165], 0
    s_add_u32 s49, s49, 262144
    buffer_load_dwordx4 v[196:199], v4, s[20:23], s49 offen sc1
    v_exp_f32 v98, v98
    v_exp_f32 v99, v99
    v_exp_f32 v100, v100
    v_exp_f32 v101, v101
    v_mfma_f32_32x32x16_bf16 v[112:127], v[210:213], v[152:155], v[112:127]
    v_exp_f32 v102, v102
    v_exp_f32 v103, v103
    v_exp_f32 v104, v104
    v_exp_f32 v105, v105
    v_smfmac_f32_32x32x32_bf16 v[16:31], v[220:223], v[88:95], v8
    buffer_load_dword v12, v9, s[20:23], 0 offen sc0 sc1
    v_exp_f32 v106, v106
    v_exp_f32 v107, v107
    v_exp_f32 v108, v108
    v_exp_f32 v109, v109
    v_smfmac_f32_32x32x32_bf16 v[32:47], v[216:219], v[96:103], v8
    v_exp_f32 v110, v110
    v_exp_f32 v111, v111
    v_exp_f32 v112, v112
    v_exp_f32 v113, v113
    v_mfma_f32_32x32x8_bf16 v[128:143], v[214:215], v[166:167], 0
    buffer_load_dwordx2 v[200:201], v5, s[20:23], s49 offen sc1
    v_exp_f32 v114, v114
    v_exp_f32 v115, v115
    v_exp_f32 v116, v116
    v_exp_f32 v117, v117
    v_mfma_f32_32x32x16_bf16 v[128:143], v[210:213], v[156:159], v[128:143]
    v_exp_f32 v118, v118
    v_exp_f32 v119, v119
    v_exp_f32 v120, v120
    v_exp_f32 v121, v121
    v_smfmac_f32_32x32x32_bf16 v[32:47], v[220:223], v[104:111], v8
    s_mov_b32 s60, 0
    buffer_load_dword v238, v236, s[8:11], s60 offen
    v_exp_f32 v122, v122
    v_exp_f32 v123, v123
    v_exp_f32 v124, v124
    v_exp_f32 v125, v125
    v_smfmac_f32_32x32x32_bf16 v[48:63], v[216:219], v[112:119], v8
    v_exp_f32 v126, v126
    v_exp_f32 v127, v127
    v_exp_f32 v128, v128
    v_exp_f32 v129, v129
    s_waitcnt vmcnt(8)
    v_mfma_f32_32x32x8_bf16 v[80:95], v[172:173], v[160:161], 0
    buffer_load_dwordx4 v[202:205], v6, s[20:23], s49 offen sc1
    v_exp_f32 v130, v130
    v_exp_f32 v131, v131
    v_exp_f32 v132, v132
    v_exp_f32 v133, v133
    v_mfma_f32_32x32x16_bf16 v[80:95], v[168:171], v[144:147], v[80:95]
    v_exp_f32 v134, v134
    v_exp_f32 v135, v135
    v_exp_f32 v136, v136
    v_exp_f32 v137, v137
    v_smfmac_f32_32x32x32_bf16 v[48:63], v[220:223], v[120:127], v8
    v_exp_f32 v138, v138
    v_exp_f32 v139, v139
    v_exp_f32 v140, v140
    v_exp_f32 v141, v141
    v_smfmac_f32_32x32x32_bf16 v[64:79], v[216:219], v[128:135], v8
    v_exp_f32 v142, v142
    v_exp_f32 v143, v143
    v_exp_f32 v80, v80
    v_exp_f32 v81, v81
    v_mfma_f32_32x32x8_bf16 v[96:111], v[172:173], v[162:163], 0
    buffer_load_dwordx4 v[206:209], v7, s[20:23], s49 offen sc1
    v_exp_f32 v82, v82
    v_exp_f32 v83, v83
    v_exp_f32 v84, v84
    v_exp_f32 v85, v85
    v_mfma_f32_32x32x16_bf16 v[96:111], v[168:171], v[148:151], v[96:111]
    v_exp_f32 v86, v86
    v_exp_f32 v87, v87
    v_exp_f32 v88, v88
    v_exp_f32 v89, v89
    v_smfmac_f32_32x32x32_bf16 v[64:79], v[220:223], v[136:143], v8
    v_exp_f32 v90, v90
    v_exp_f32 v91, v91
    v_exp_f32 v92, v92
    v_exp_f32 v93, v93
    v_smfmac_f32_32x32x32_bf16 v[16:31], v[174:177], v[80:87], v8
    v_exp_f32 v94, v94
    v_exp_f32 v95, v95
    v_exp_f32 v96, v96
    v_exp_f32 v97, v97
    v_mfma_f32_32x32x8_bf16 v[112:127], v[172:173], v[164:165], 0
    s_add_u32 s49, s49, 262144
    buffer_load_dwordx4 v[210:213], v4, s[20:23], s49 offen sc1
    v_exp_f32 v98, v98
    v_exp_f32 v99, v99
    v_exp_f32 v100, v100
    v_exp_f32 v101, v101
    v_mfma_f32_32x32x16_bf16 v[112:127], v[168:171], v[152:155], v[112:127]
    v_exp_f32 v102, v102
    v_exp_f32 v103, v103
    v_exp_f32 v104, v104
    v_exp_f32 v105, v105
    v_smfmac_f32_32x32x32_bf16 v[16:31], v[178:181], v[88:95], v8
    v_exp_f32 v106, v106
    v_exp_f32 v107, v107
    v_exp_f32 v108, v108
    v_exp_f32 v109, v109
    v_smfmac_f32_32x32x32_bf16 v[32:47], v[174:177], v[96:103], v8
    v_exp_f32 v110, v110
    v_exp_f32 v111, v111
    v_exp_f32 v112, v112
    v_exp_f32 v113, v113
    v_mfma_f32_32x32x8_bf16 v[128:143], v[172:173], v[166:167], 0
    buffer_load_dwordx2 v[214:215], v5, s[20:23], s49 offen sc1
    v_exp_f32 v114, v114
    v_exp_f32 v115, v115
    v_exp_f32 v116, v116
    v_exp_f32 v117, v117
    v_mfma_f32_32x32x16_bf16 v[128:143], v[168:171], v[156:159], v[128:143]
    v_exp_f32 v118, v118
    v_exp_f32 v119, v119
    v_exp_f32 v120, v120
    v_exp_f32 v121, v121
    v_smfmac_f32_32x32x32_bf16 v[32:47], v[178:181], v[104:111], v8
    v_exp_f32 v122, v122
    v_exp_f32 v123, v123
    v_exp_f32 v124, v124
    v_exp_f32 v125, v125
    v_smfmac_f32_32x32x32_bf16 v[48:63], v[174:177], v[112:119], v8
    v_exp_f32 v126, v126
    v_exp_f32 v127, v127
    v_exp_f32 v128, v128
    v_exp_f32 v129, v129
    s_waitcnt vmcnt(8)
    v_mfma_f32_32x32x8_bf16 v[80:95], v[186:187], v[160:161], 0
    buffer_load_dwordx4 v[216:219], v6, s[20:23], s49 offen sc1
    v_exp_f32 v130, v130
    v_exp_f32 v131, v131
    v_exp_f32 v132, v132
    v_exp_f32 v133, v133
    v_mfma_f32_32x32x16_bf16 v[80:95], v[182:185], v[144:147], v[80:95]
    v_exp_f32 v134, v134
    v_exp_f32 v135, v135
    v_exp_f32 v136, v136
    v_exp_f32 v137, v137
    v_smfmac_f32_32x32x32_bf16 v[48:63], v[178:181], v[120:127], v8
    s_waitcnt vmcnt(7)
    v_cmp_ne_u32 vcc, s3, v12
    s_nop 0
    s_cbranch_vccz L_poll1_far_done
    s_mov_b32 s62, 0
    s_waitcnt vmcnt(0)
L_poll1_far:
    buffer_load_dword v12, v9, s[20:23], 0 offen offset:0 sc0 sc1
    s_add_u32 s62, s62, 1
    s_waitcnt vmcnt(0)
    v_cmp_ne_u32 vcc, s3, v12
    s_cmp_gt_u32 s62, 400000
    s_cbranch_scc1 L_poll1_far_done
    s_cbranch_vccz L_poll1_far_done
    s_sleep 4
    s_branch L_poll1_far
L_poll1_far_done:
    v_exp_f32 v138, v138
    v_exp_f32 v139, v139
    v_exp_f32 v140, v140
    v_exp_f32 v141, v141
    v_smfmac_f32_32x32x32_bf16 v[64:79], v[174:177], v[128:135], v8
    v_exp_f32 v142, v142
    v_exp_f32 v143, v143
    v_exp_f32 v80, v80
    v_exp_f32 v81, v81
    v_mfma_f32_32x32x8_bf16 v[96:111], v[186:187], v[162:163], 0
    buffer_load_dwordx4 v[220:223], v7, s[20:23], s49 offen sc1
    v_exp_f32 v82, v82
    v_exp_f32 v83, v83
    v_exp_f32 v84, v84
    v_exp_f32 v85, v85
    v_mfma_f32_32x32x16_bf16 v[96:111], v[182:185], v[148:151], v[96:111]
    v_exp_f32 v86, v86
    v_exp_f32 v87, v87
    v_exp_f32 v88, v88
    v_exp_f32 v89, v89
    v_smfmac_f32_32x32x32_bf16 v[64:79], v[178:181], v[136:143], v8
    s_mov_b32 s60, 3456
    buffer_load_dword v238, v236, s[8:11], s60 offen
    v_exp_f32 v90, v90
    v_exp_f32 v91, v91
    v_exp_f32 v92, v92
    v_exp_f32 v93, v93
    v_smfmac_f32_32x32x32_bf16 v[16:31], v[188:191], v[80:87], v8
    v_exp_f32 v94, v94
    v_exp_f32 v95, v95
    v_exp_f32 v96, v96
    v_exp_f32 v97, v97
    v_mfma_f32_32x32x8_bf16 v[112:127], v[186:187], v[164:165], 0
    s_mov_b32 s49, s48
    buffer_load_dwordx4 v[168:171], v4, s[20:23], s49 offen sc1
    v_exp_f32 v98, v98
    v_exp_f32 v99, v99
    v_exp_f32 v100, v100
    v_exp_f32 v101, v101
    v_mfma_f32_32x32x16_bf16 v[112:127], v[182:185], v[152:155], v[112:127]
    v_exp_f32 v102, v102
    v_exp_f32 v103, v103
    v_exp_f32 v104, v104
    v_exp_f32 v105, v105
    v_smfmac_f32_32x32x32_bf16 v[16:31], v[192:195], v[88:95], v8
    v_exp_f32 v106, v106
    v_exp_f32 v107, v107
    v_exp_f32 v108, v108
    v_exp_f32 v109, v109
    v_smfmac_f32_32x32x32_bf16 v[32:47], v[188:191], v[96:103], v8
    v_exp_f32 v110, v110
    v_exp_f32 v111, v111
    v_exp_f32 v112, v112
    v_exp_f32 v113, v113
    v_mfma_f32_32x32x8_bf16 v[128:143], v[186:187], v[166:167], 0
    buffer_load_dwordx2 v[172:173], v5, s[20:23], s49 offen sc1
    v_exp_f32 v114, v114
    v_exp_f32 v115, v115
    v_exp_f32 v116, v116
    v_exp_f32 v117, v117
    v_mfma_f32_32x32x16_bf16 v[128:143], v[182:185], v[156:159], v[128:143]
    v_exp_f32 v118, v118
    v_exp_f32 v119, v119
    v_exp_f32 v120, v120
    v_exp_f32 v121, v121
    v_smfmac_f32_32x32x32_bf16 v[32:47], v[192:195], v[104:111], v8
    v_exp_f32 v122, v122
    v_exp_f32 v123, v123
    v_exp_f32 v124, v124
    v_exp_f32 v125, v125
    v_smfmac_f32_32x32x32_bf16 v[48:63], v[188:191], v[112:119], v8
    v_exp_f32 v126, v126
    v_exp_f32 v127, v127
    v_exp_f32 v128, v128
    v_exp_f32 v129, v129
    s_waitcnt vmcnt(7)
    v_mfma_f32_32x32x8_bf16 v[80:95], v[200:201], v[160:161], 0
    buffer_load_dwordx4 v[174:177], v6, s[20:23], s49 offen sc1
    v_exp_f32 v130, v130
    v_exp_f32 v131, v131
    v_exp_f32 v132, v132
    v_exp_f32 v133, v133
    v_mfma_f32_32x32x16_bf16 v[80:95], v[196:199], v[144:147], v[80:95]
    v_exp_f32 v134, v134
    v_exp_f32 v135, v135
    v_exp_f32 v136, v136
    v_exp_f32 v137, v137
    v_smfmac_f32_32x32x32_bf16 v[48:63], v[192:195], v[120:127], v8
    v_exp_f32 v138, v138
    v_exp_f32 v139, v139
    v_exp_f32 v140, v140
    v_exp_f32 v141, v141
    v_smfmac_f32_32x32x32_bf16 v[64:79], v[188:191], v[128:135], v8
    v_exp_f32 v142, v142
    v_exp_f32 v143, v143
    v_exp_f32 v80, v80
    v_exp_f32 v81, v81
    v_mfma_f32_32x32x8_bf16 v[96:111], v[200:201], v[162:163], 0
    buffer_load_dwordx4 v[178:181], v7, s[20:23], s49 offen sc1
    v_exp_f32 v82, v82
    v_exp_f32 v83, v83
    v_exp_f32 v84, v84
    v_exp_f32 v85, v85
    v_mfma_f32_32x32x16_bf16 v[96:111], v[196:199], v[148:151], v[96:111]
    v_exp_f32 v86, v86
    v_exp_f32 v87, v87
    v_exp_f32 v88, v88
    v_exp_f32 v89, v89
    v_smfmac_f32_32x32x32_bf16 v[64:79], v[192:195], v[136:143], v8
    buffer_load_dwordx4 v[12:15], v2, s[20:23], 0 offen sc0 sc1
    v_exp_f32 v90, v90
    v_exp_f32 v91, v91
    v_exp_f32 v92, v92
    v_exp_f32 v93, v93
    v_smfmac_f32_32x32x32_bf16 v[16:31], v[202:205], v[80:87], v8
    v_exp_f32 v94, v94
    v_exp_f32 v95, v95
    v_exp_f32 v96, v96
    v_exp_f32 v97, v97
    v_mfma_f32_32x32x8_bf16 v[112:127], v[200:201], v[164:165], 0
    s_add_u32 s49, s49, 262144
    buffer_load_dwordx4 v[182:185], v4, s[20:23], s49 offen sc1
    v_exp_f32 v98, v98
    v_exp_f32 v99, v99
    v_exp_f32 v100, v100
    v_exp_f32 v101, v101
    v_mfma_f32_32x32x16_bf16 v[112:127], v[196:199], v[152:155], v[112:127]
    v_exp_f32 v102, v102
    v_exp_f32 v103, v103
    v_exp_f32 v104, v104
    v_exp_f32 v105, v105
    v_smfmac_f32_32x32x32_bf16 v[16:31], v[206:209], v[88:95], v8
    v_exp_f32 v106, v106
    v_exp_f32 v107, v107
    v_exp_f32 v108, v108
    v_exp_f32 v109, v109
    v_smfmac_f32_32x32x32_bf16 v[32:47], v[202:205], v[96:103], v8
    v_exp_f32 v110, v110
    v_exp_f32 v111, v111
    v_exp_f32 v112, v112
    v_exp_f32 v113, v113
    v_mfma_f32_32x32x8_bf16 v[128:143], v[200:201], v[166:167], 0
    buffer_load_dwordx2 v[186:187], v5, s[20:23], s49 offen sc1
    v_exp_f32 v114, v114
    v_exp_f32 v115, v115
    v_exp_f32 v116, v116
    v_exp_f32 v117, v117
    v_mfma_f32_32x32x16_bf16 v[128:143], v[196:199], v[156:159], v[128:143]
    v_exp_f32 v118, v118
    v_exp_f32 v119, v119
    v_exp_f32 v120, v120
    v_exp_f32 v121, v121
    v_smfmac_f32_32x32x32_bf16 v[32:47], v[206:209], v[104:111], v8
    s_mov_b32 s60, 6912
    buffer_load_dword v238, v236, s[8:11], s60 offen
    v_exp_f32 v122, v122
    v_exp_f32 v123, v123
    v_exp_f32 v124, v124
    v_exp_f32 v125, v125
    v_smfmac_f32_32x32x32_bf16 v[48:63], v[202:205], v[112:119], v8
    v_exp_f32 v126, v126
    v_exp_f32 v127, v127
    v_exp_f32 v128, v128
    v_exp_f32 v129, v129
    s_waitcnt vmcnt(9)
    v_mfma_f32_32x32x8_bf16 v[80:95], v[214:215], v[160:161], 0
    buffer_load_dwordx4 v[188:191], v6, s[20:23], s49 offen sc1
    v_exp_f32 v130, v130
    v_exp_f32 v131, v131
    v_exp_f32 v132, v132
    v_exp_f32 v133, v133
    v_mfma_f32_32x32x16_bf16 v[80:95], v[210:213], v[144:147], v[80:95]
    v_exp_f32 v134, v134
    v_exp_f32 v135, v135
    v_exp_f32 v136, v136
    v_exp_f32 v137, v137
    v_smfmac_f32_32x32x32_bf16 v[48:63], v[206:209], v[120:127], v8
    v_exp_f32 v138, v138
    v_exp_f32 v139, v139
    v_exp_f32 v140, v140
    v_exp_f32 v141, v141
    v_smfmac_f32_32x32x32_bf16 v[64:79], v[202:205], v[128:135], v8
    v_exp_f32 v142, v142
    v_exp_f32 v143, v143
    v_exp_f32 v80, v80
    v_exp_f32 v81, v81
    v_mfma_f32_32x32x8_bf16 v[96:111], v[214:215], v[162:163], 0
    buffer_load_dwordx4 v[192:195], v7, s[20:23], s49 offen sc1
    v_exp_f32 v82, v82
    v_exp_f32 v83, v83
    v_exp_f32 v84, v84
    v_exp_f32 v85, v85
    v_mfma_f32_32x32x16_bf16 v[96:111], v[210:213], v[148:151], v[96:111]
    v_exp_f32 v86, v86
    v_exp_f32 v87, v87
    v_exp_f32 v88, v88
    v_exp_f32 v89, v89
    v_smfmac_f32_32x32x32_bf16 v[64:79], v[206:209], v[136:143], v8
    v_exp_f32 v90, v90
    v_exp_f32 v91, v91
    v_exp_f32 v92, v92
    v_exp_f32 v93, v93
    v_smfmac_f32_32x32x32_bf16 v[16:31], v[216:219], v[80:87], v8
    v_exp_f32 v94, v94
    v_exp_f32 v95, v95
    v_exp_f32 v96, v96
    v_exp_f32 v97, v97
    v_mfma_f32_32x32x8_bf16 v[112:127], v[214:215], v[164:165], 0
    s_add_u32 s49, s49, 262144
    buffer_load_dwordx4 v[196:199], v4, s[20:23], s49 offen sc1
    v_exp_f32 v98, v98
    v_exp_f32 v99, v99
    v_exp_f32 v100, v100
    v_exp_f32 v101, v101
    v_mfma_f32_32x32x16_bf16 v[112:127], v[210:213], v[152:155], v[112:127]
    v_exp_f32 v102, v102
    v_exp_f32 v103, v103
    v_exp_f32 v104, v104
    v_exp_f32 v105, v105
    v_smfmac_f32_32x32x32_bf16 v[16:31], v[220:223], v[88:95], v8
    v_exp_f32 v106, v106
    v_exp_f32 v107, v107
    v_exp_f32 v108, v108
    v_exp_f32 v109, v109
    v_smfmac_f32_32x32x32_bf16 v[32:47], v[216:219], v[96:103], v8
    v_exp_f32 v110, v110
    v_exp_f32 v111, v111
    v_exp_f32 v112, v112
    v_exp_f32 v113, v113
    v_mfma_f32_32x32x8_bf16 v[128:143], v[214:215], v[166:167], 0
    buffer_load_dwordx2 v[200:201], v5, s[20:23], s49 offen sc1
    v_exp_f32 v114, v114
    v_exp_f32 v115, v115
    v_exp_f32 v116, v116
    v_exp_f32 v117, v117
    v_mfma_f32_32x32x16_bf16 v[128:143], v[210:213], v[156:159], v[128:143]
    v_exp_f32 v118, v118
    v_exp_f32 v119, v119
    v_exp_f32 v120, v120
    v_exp_f32 v121, v121
    v_smfmac_f32_32x32x32_bf16 v[32:47], v[220:223], v[104:111], v8
    s_waitcnt vmcnt(7)
    v_xor_b32 v12, s3, v12
    v_xor_b32 v13, s3, v13
    v_xor_b32 v14, s3, v14
    v_xor_b32 v15, s3, v15
    v_or3_b32 v12, v12, v13, v14
    v_or_b32 v12, v12, v15
    v_cmp_ne_u32 vcc, 0, v12
    s_nop 0
    s_cbranch_vccz L_poll1_rl_done
    s_mov_b32 s62, 0
    s_waitcnt vmcnt(0)
L_poll1_rl:
    buffer_load_dwordx4 v[12:15], v2, s[20:23], 0 offen offset:0 sc0 sc1
    s_add_u32 s62, s62, 1
    s_waitcnt vmcnt(0)
    v_xor_b32 v12, s3, v12
    v_xor_b32 v13, s3, v13
    v_xor_b32 v14, s3, v14
    v_xor_b32 v15, s3, v15
    v_or3_b32 v12, v12, v13, v14
    v_or_b32 v12, v12, v15
    v_cmp_ne_u32 vcc, 0, v12
    s_cmp_gt_u32 s62, 400000
    s_cbranch_scc1 L_poll1_rl_done
    s_cbranch_vccz L_poll1_rl_done
    s_sleep 8
    s_branch L_poll1_rl
L_poll1_rl_done:
    v_exp_f32 v122, v122
    v_exp_f32 v123, v123
    v_exp_f32 v124, v124
    v_exp_f32 v125, v125
    v_smfmac_f32_32x32x32_bf16 v[48:63], v[216:219], v[112:119], v8
    v_exp_f32 v126, v126
    v_exp_f32 v127, v127
    v_exp_f32 v128, v128
    v_exp_f32 v129, v129
    s_waitcnt vmcnt(8)
    v_mfma_f32_32x32x8_bf16 v[80:95], v[172:173], v[160:161], 0
    buffer_load_dwordx4 v[202:205], v6, s[20:23], s49 offen sc1
    v_exp_f32 v130, v130
    v_exp_f32 v131, v131
    v_exp_f32 v132, v132
    v_exp_f32 v133, v133
    v_mfma_f32_32x32x16_bf16 v[80:95], v[168:171], v[144:147], v[80:95]
    v_exp_f32 v134, v134
    v_exp_f32 v135, v135
    v_exp_f32 v136, v136
    v_exp_f32 v137, v137
    v_smfmac_f32_32x32x32_bf16 v[48:63], v[220:223], v[120:127], v8
    s_add_u32 m0, s61, 0
    s_mov_b32 s60, 0
    buffer_load_dwordx4 v3, s[20:23], s60 offen offset:0 sc1 lds
    buffer_load_dwordx4 v3, s[20:23], s60 offen offset:1024 sc1 lds
    v_exp_f32 v138, v138
    v_exp_f32 v139, v139
    v_exp_f32 v140, v140
    v_exp_f32 v141, v141
    v_smfmac_f32_32x32x32_bf16 v[64:79], v[216:219], v[128:135], v8
    v_exp_f32 v142, v142
    v_exp_f32 v143, v143
    v_exp_f32 v80, v80
    v_exp_f32 v81, v81
    v_mfma_f32_32x32x8_bf16 v[96:111], v[172:173], v[162:163], 0
    buffer_load_dwordx4 v[206:209], v7, s[20:23], s49 offen sc1
    v_exp_f32 v82, v82
    v_exp_f32 v83, v83
    v_exp_f32 v84, v84
    v_exp_f32 v85, v85
    v_mfma_f32_32x32x16_bf16 v[96:111], v[168:171], v[148:151], v[96:111]
    v_exp_f32 v86, v86
    v_exp_f32 v87, v87
    v_exp_f32 v88, v88
    v_exp_f32 v89, v89
    v_smfmac_f32_32x32x32_bf16 v[64:79], v[220:223], v[136:143], v8
    buffer_load_dwordx4 v[224:227], v237, s[24:27], 0 offen offset:0
    v_exp_f32 v90, v90
    v_exp_f32 v91, v91
    v_exp_f32 v92, v92
    v_exp_f32 v93, v93
    v_smfmac_f32_32x32x32_bf16 v[16:31], v[174:177], v[80:87], v8
    v_exp_f32 v94, v94
    v_exp_f32 v95, v95
    v_exp_f32 v96, v96
    v_exp_f32 v97, v97
    v_mfma_f32_32x32x8_bf16 v[112:127], v[172:173], v[164:165], 0
    s_add_u32 s49, s49, 262144
    buffer_load_dwordx4 v[210:213], v4, s[20:23], s49 offen sc1
    v_exp_f32 v98, v98
    v_exp_f32 v99, v99
    v_exp_f32 v100, v100
    v_exp_f32 v101, v101
    v_mfma_f32_32x32x16_bf16 v[112:127], v[168:171], v[152:155], v[112:127]
    v_exp_f32 v102, v102
    v_exp_f32 v103, v103
    v_exp_f32 v104, v104
    v_exp_f32 v105, v105
    v_smfmac_f32_32x32x32_bf16 v[16:31], v[178:181], v[88:95], v8
    s_add_u32 m0, s61, 8192
    s_mov_b32 s60, 8192
    buffer_load_dwordx4 v3, s[20:23], s60 offen offset:0 sc1 lds
    buffer_load_dwordx4 v3, s[20:23], s60 offen offset:1024 sc1 lds
    v_exp_f32 v106, v106
    v_exp_f32 v107, v107
    v_exp_f32 v108, v108
    v_exp_f32 v109, v109
    v_smfmac_f32_32x32x32_bf16 v[32:47], v[174:177], v[96:103], v8
    v_exp_f32 v110, v110
    v_exp_f32 v111, v111
    v_exp_f32 v112, v112
    v_exp_f32 v113, v113
    v_mfma_f32_32x32x8_bf16 v[128:143], v[172:173], v[166:167], 0
    buffer_load_dwordx2 v[214:215], v5, s[20:23], s49 offen sc1
    v_exp_f32 v114, v114
    v_exp_f32 v115, v115
    v_exp_f32 v116, v116
    v_exp_f32 v117, v117
    v_mfma_f32_32x32x16_bf16 v[128:143], v[168:171], v[156:159], v[128:143]
    v_exp_f32 v118, v118
    v_exp_f32 v119, v119
    v_exp_f32 v120, v120
    v_exp_f32 v121, v121
    v_smfmac_f32_32x32x32_bf16 v[32:47], v[178:181], v[104:111], v8
    v_exp_f32 v122, v122
    v_exp_f32 v123, v123
    v_exp_f32 v124, v124
    v_exp_f32 v125, v125
    v_smfmac_f32_32x32x32_bf16 v[48:63], v[174:177], v[112:119], v8
    v_exp_f32 v126, v126
    v_exp_f32 v127, v127
    v_exp_f32 v128, v128
    v_exp_f32 v129, v129
    s_waitcnt vmcnt(11)
    v_mfma_f32_32x32x8_bf16 v[80:95], v[186:187], v[160:161], 0
    buffer_load_dwordx4 v[216:219], v6, s[20:23], s49 offen sc1
    v_exp_f32 v130, v130
    v_exp_f32 v131, v131
    v_exp_f32 v132, v132
    v_exp_f32 v133, v133
    v_mfma_f32_32x32x16_bf16 v[80:95], v[182:185], v[144:147], v[80:95]
    v_exp_f32 v134, v134
    v_exp_f32 v135, v135
    v_exp_f32 v136, v136
    v_exp_f32 v137, v137
    v_smfmac_f32_32x32x32_bf16 v[48:63], v[178:181], v[120:127], v8
    s_add_u32 m0, s61, 16384
    s_mov_b32 s60, 16384
    buffer_load_dwordx4 v3, s[20:23], s60 offen offset:0 sc1 lds
    buffer_load_dwordx4 v3, s[20:23], s60 offen offset:1024 sc1 lds
    v_exp_f32 v138, v138
    v_exp_f32 v139, v139
    v_exp_f32 v140, v140
    v_exp_f32 v141, v141
    v_smfmac_f32_32x32x32_bf16 v[64:79], v[174:177], v[128:135], v8
    v_exp_f32 v142, v142
    v_exp_f32 v143, v143
    v_exp_f32 v80, v80
    v_exp_f32 v81, v81
    v_mfma_f32_32x32x8_bf16 v[96:111], v[186:187], v[162:163], 0
    buffer_load_dwordx4 v[220:223], v7, s[20:23], s49 offen sc1
    v_exp_f32 v82, v82
    v_exp_f32 v83, v83
    v_exp_f32 v84, v84
    v_exp_f32 v85, v85
    v_mfma_f32_32x32x16_bf16 v[96:111], v[182:185], v[148:151], v[96:111]
    v_exp_f32 v86, v86
    v_exp_f32 v87, v87
    v_exp_f32 v88, v88
    v_exp_f32 v89, v89
    v_smfmac_f32_32x32x32_bf16 v[64:79], v[178:181], v[136:143], v8
    v_exp_f32 v90, v90
    v_exp_f32 v91, v91
    v_exp_f32 v92, v92
    v_exp_f32 v93, v93
    v_smfmac_f32_32x32x32_bf16 v[16:31], v[188:191], v[80:87], v8
    v_exp_f32 v94, v94
    v_exp_f32 v95, v95
    v_exp_f32 v96, v96
    v_exp_f32 v97, v97
    v_mfma_f32_32x32x8_bf16 v[112:127], v[186:187], v[164:165], 0
    s_add_u32 s49, s49, 262144
    buffer_load_dwordx4 v[168:171], v4, s[20:23], s49 offen sc1
    v_exp_f32 v98, v98
    v_exp_f32 v99, v99
    v_exp_f32 v100, v100
    v_exp_f32 v101, v101
    v_mfma_f32_32x32x16_bf16 v[112:127], v[182:185], v[152:155], v[112:127]
    v_exp_f32 v102, v102
    v_exp_f32 v103, v103
    v_exp_f32 v104, v104
    v_exp_f32 v105, v105
    v_smfmac_f32_32x32x32_bf16 v[16:31], v[192:195], v[88:95], v8
    s_add_u32 m0, s61, 24576
    s_mov_b32 s60, 24576
    buffer_load_dwordx4 v3, s[20:23], s60 offen offset:0 sc1 lds
    buffer_load_dwordx4 v3, s[20:23], s60 offen offset:1024 sc1 lds
    v_exp_f32 v106, v106
    v_exp_f32 v107, v107
    v_exp_f32 v108, v108
    v_exp_f32 v109, v109
    v_smfmac_f32_32x32x32_bf16 v[32:47], v[188:191], v[96:103], v8
    v_exp_f32 v110, v110
    v_exp_f32 v111, v111
    v_exp_f32 v112, v112
    v_exp_f32 v113, v113
    v_mfma_f32_32x32x8_bf16 v[128:143], v[186:187], v[166:167], 0
    buffer_load_dwordx2 v[172:173], v5, s[20:23], s49 offen sc1
    v_exp_f32 v114, v114
    v_exp_f32 v115, v115
    v_exp_f32 v116, v116
    v_exp_f32 v117, v117
    v_mfma_f32_32x32x16_bf16 v[128:143], v[182:185], v[156:159], v[128:143]
    v_exp_f32 v118, v118
    v_exp_f32 v119, v119
    v_exp_f32 v120, v120
    v_exp_f32 v121, v121
    v_smfmac_f32_32x32x32_bf16 v[32:47], v[192:195], v[104:111], v8
    buffer_load_dwordx4 v[228:231], v237, s[24:27], 0 offen offset:32
    v_exp_f32 v122, v122
    v_exp_f32 v123, v123
    v_exp_f32 v124, v124
    v_exp_f32 v125, v125
    v_smfmac_f32_32x32x32_bf16 v[48:63], v[188:191], v[112:119], v8
    v_exp_f32 v126, v126
    v_exp_f32 v127, v127
    v_exp_f32 v128, v128
    v_exp_f32 v129, v129
    s_waitcnt vmcnt(14)
    v_mfma_f32_32x32x8_bf16 v[80:95], v[200:201], v[160:161], 0
    buffer_load_dwordx4 v[174:177], v6, s[20:23], s49 offen sc1
    v_exp_f32 v130, v130
    v_exp_f32 v131, v131
    v_exp_f32 v132, v132
    v_exp_f32 v133, v133
    v_mfma_f32_32x32x16_bf16 v[80:95], v[196:199], v[144:147], v[80:95]
    v_exp_f32 v134, v134
    v_exp_f32 v135, v135
    v_exp_f32 v136, v136
    v_exp_f32 v137, v137
    v_smfmac_f32_32x32x32_bf16 v[48:63], v[192:195], v[120:127], v8
    s_add_u32 m0, s61, 32768
    s_mov_b32 s60, 32768
    buffer_load_dwordx4 v3, s[20:23], s60 offen offset:0 sc1 lds
    buffer_load_dwordx4 v3, s[20:23], s60 offen offset:1024 sc1 lds
    v_exp_f32 v138, v138
    v_exp_f32 v139, v139
    v_exp_f32 v140, v140
    v_exp_f32 v141, v141
    v_smfmac_f32_32x32x32_bf16 v[64:79], v[188:191], v[128:135], v8
    v_exp_f32 v142, v142
    v_exp_f32 v143, v143
    v_exp_f32 v80, v80
    v_exp_f32 v81, v81
    v_mfma_f32_32x32x8_bf16 v[96:111], v[200:201], v[162:163], 0
    buffer_load_dwordx4 v[178:181], v7, s[20:23], s49 offen sc1
    v_exp_f32 v82, v82
    v_exp_f32 v83, v83
    v_exp_f32 v84, v84
    v_exp_f32 v85, v85
    v_mfma_f32_32x32x16_bf16 v[96:111], v[196:199], v[148:151], v[96:111]
    v_exp_f32 v86, v86
    v_exp_f32 v87, v87
    v_exp_f32 v88, v88
    v_exp_f32 v89, v89
    v_smfmac_f32_32x32x32_bf16 v[64:79], v[192:195], v[136:143], v8
    v_exp_f32 v90, v90
    v_exp_f32 v91, v91
    v_exp_f32 v92, v92
    v_exp_f32 v93, v93
    v_smfmac_f32_32x32x32_bf16 v[16:31], v[202:205], v[80:87], v8
    v_exp_f32 v94, v94
    v_exp_f32 v95, v95
    v_exp_f32 v96, v96
    v_exp_f32 v97, v97
    v_mfma_f32_32x32x8_bf16 v[112:127], v[200:201], v[164:165], 0
    s_add_u32 s49, s49, 262144
    buffer_load_dwordx4 v[182:185], v4, s[20:23], s49 offen sc1
    v_exp_f32 v98, v98
    v_exp_f32 v99, v99
    v_exp_f32 v100, v100
    v_exp_f32 v101, v101
    v_mfma_f32_32x32x16_bf16 v[112:127], v[196:199], v[152:155], v[112:127]
    v_exp_f32 v102, v102
    v_exp_f32 v103, v103
    v_exp_f32 v104, v104
    v_exp_f32 v105, v105
    v_smfmac_f32_32x32x32_bf16 v[16:31], v[206:209], v[88:95], v8
    s_add_u32 m0, s61, 40960
    s_mov_b32 s60, 40960
    buffer_load_dwordx4 v3, s[20:23], s60 offen offset:0 sc1 lds
    buffer_load_dwordx4 v3, s[20:23], s60 offen offset:1024 sc1 lds
    v_exp_f32 v106, v106
    v_exp_f32 v107, v107
    v_exp_f32 v108, v108
    v_exp_f32 v109, v109
    v_smfmac_f32_32x32x32_bf16 v[32:47], v[202:205], v[96:103], v8
    v_exp_f32 v110, v110
    v_exp_f32 v111, v111
    v_exp_f32 v112, v112
    v_exp_f32 v113, v113
    v_mfma_f32_32x32x8_bf16 v[128:143], v[200:201], v[166:167], 0
    buffer_load_dwordx2 v[186:187], v5, s[20:23], s49 offen sc1
    v_exp_f32 v114, v114
    v_exp_f32 v115, v115
    v_exp_f32 v116, v116
    v_exp_f32 v117, v117
    v_mfma_f32_32x32x16_bf16 v[128:143], v[196:199], v[156:159], v[128:143]
    v_exp_f32 v118, v118
    v_exp_f32 v119, v119
    v_exp_f32 v120, v120
    v_exp_f32 v121, v121
    v_smfmac_f32_32x32x32_bf16 v[32:47], v[206:209], v[104:111], v8
    v_exp_f32 v122, v122
    v_exp_f32 v123, v123
    v_exp_f32 v124, v124
    v_exp_f32 v125, v125
    v_smfmac_f32_32x32x32_bf16 v[48:63], v[202:205], v[112:119], v8
    v_exp_f32 v126, v126
    v_exp_f32 v127, v127
    v_exp_f32 v128, v128
    v_exp_f32 v129, v129
    s_waitcnt vmcnt(13)
    v_mfma_f32_32x32x8_bf16 v[80:95], v[214:215], v[160:161], 0
    buffer_load_dwordx4 v[188:191], v6, s[20:23], s49 offen sc1
    v_exp_f32 v130, v130
    v_exp_f32 v131, v131
    v_exp_f32 v132, v132
    v_exp_f32 v133, v133
    v_mfma_f32_32x32x16_bf16 v[80:95], v[210:213], v[144:147], v[80:95]
    v_exp_f32 v134, v134
    v_exp_f32 v135, v135
    v_exp_f32 v136, v136
    v_exp_f32 v137, v137
    v_smfmac_f32_32x32x32_bf16 v[48:63], v[206:209], v[120:127], v8
    s_add_u32 m0, s61, 49152
    s_mov_b32 s60, 49152
    buffer_load_dwordx4 v3, s[20:23], s60 offen offset:0 sc1 lds
    buffer_load_dwordx4 v3, s[20:23], s60 offen offset:1024 sc1 lds
    v_exp_f32 v138, v138
    v_exp_f32 v139, v139
    v_exp_f32 v140, v140
    v_exp_f32 v141, v141
    v_smfmac_f32_32x32x32_bf16 v[64:79], v[202:205], v[128:135], v8
    v_exp_f32 v142, v142
    v_exp_f32 v143, v143
    v_exp_f32 v80, v80
    v_exp_f32 v81, v81
    v_mfma_f32_32x32x8_bf16 v[96:111], v[214:215], v[162:163], 0
    buffer_load_dwordx4 v[192:195], v7, s[20:23], s49 offen sc1
    v_exp_f32 v82, v82
    v_exp_f32 v83, v83
    v_exp_f32 v84, v84
    v_exp_f32 v85, v85
    v_mfma_f32_32x32x16_bf16 v[96:111], v[210:213], v[148:151], v[96:111]
    v_exp_f32 v86, v86
    v_exp_f32 v87, v87
    v_exp_f32 v88, v88
    v_exp_f32 v89, v89
    v_smfmac_f32_32x32x32_bf16 v[64:79], v[206:209], v[136:143], v8
    buffer_load_dwordx4 v[232:235], v237, s[24:27], 0 offen offset:64
    v_exp_f32 v90, v90
    v_exp_f32 v91, v91
    v_exp_f32 v92, v92
    v_exp_f32 v93, v93
    v_smfmac_f32_32x32x32_bf16 v[16:31], v[216:219], v[80:87], v8
    v_exp_f32 v94, v94
    v_exp_f32 v95, v95
    v_exp_f32 v96, v96
    v_exp_f32 v97, v97
    v_mfma_f32_32x32x8_bf16 v[112:127], v[214:215], v[164:165], 0
    s_add_u32 s49, s49, 262144
    buffer_load_dwordx4 v[196:199], v4, s[20:23], s49 offen sc1
    v_exp_f32 v98, v98
    v_exp_f32 v99, v99
    v_exp_f32 v100, v100
    v_exp_f32 v101, v101
    v_mfma_f32_32x32x16_bf16 v[112:127], v[210:213], v[152:155], v[112:127]
    v_exp_f32 v102, v102
    v_exp_f32 v103, v103
    v_exp_f32 v104, v104
    v_exp_f32 v105, v105
    v_smfmac_f32_32x32x32_bf16 v[16:31], v[220:223], v[88:95], v8
    s_add_u32 m0, s61, 57344
    s_mov_b32 s60, 57344
    buffer_load_dwordx4 v3, s[20:23], s60 offen offset:0 sc1 lds
    buffer_load_dwordx4 v3, s[20:23], s60 offen offset:1024 sc1 lds
    v_exp_f32 v106, v106
    v_exp_f32 v107, v107
    v_exp_f32 v108, v108
    v_exp_f32 v109, v109
    v_smfmac_f32_32x32x32_bf16 v[32:47], v[216:219], v[96:103], v8
    v_exp_f32 v110, v110
    v_exp_f32 v111, v111
    v_exp_f32 v112, v112
    v_exp_f32 v113, v113
    v_mfma_f32_32x32x8_bf16 v[128:143], v[214:215], v[166:167], 0
    buffer_load_dwordx2 v[200:201], v5, s[20:23], s49 offen sc1
    v_exp_f32 v114, v114
    v_exp_f32 v115, v115
    v_exp_f32 v116, v116
    v_exp_f32 v117, v117
    v_mfma_f32_32x32x16_bf16 v[128:143], v[210:213], v[156:159], v[128:143]
    v_exp_f32 v118, v118
    v_exp_f32 v119, v119
    v_exp_f32 v120, v120
    v_exp_f32 v121, v121
    v_smfmac_f32_32x32x32_bf16 v[32:47], v[220:223], v[104:111], v8
    v_exp_f32 v122, v122
    v_exp_f32 v123, v123
    v_exp_f32 v124, v124
    v_exp_f32 v125, v125
    v_smfmac_f32_32x32x32_bf16 v[48:63], v[216:219], v[112:119], v8
    v_exp_f32 v126, v126
    v_exp_f32 v127, v127
    v_exp_f32 v128, v128
    v_exp_f32 v129, v129
    s_waitcnt vmcnt(13)
    v_mfma_f32_32x32x8_bf16 v[80:95], v[172:173], v[160:161], 0
    buffer_load_dwordx4 v[202:205], v6, s[20:23], s49 offen sc1
    v_exp_f32 v130, v130
    v_exp_f32 v131, v131
    v_exp_f32 v132, v132
    v_exp_f32 v133, v133
    v_mfma_f32_32x32x16_bf16 v[80:95], v[168:171], v[144:147], v[80:95]
    v_exp_f32 v134, v134
    v_exp_f32 v135, v135
    v_exp_f32 v136, v136
    v_exp_f32 v137, v137
    v_smfmac_f32_32x32x32_bf16 v[48:63], v[220:223], v[120:127], v8
    s_add_u32 m0, s61, 65536
    s_mov_b32 s60, 65536
    buffer_load_dwordx4 v3, s[20:23], s60 offen offset:0 sc1 lds
    buffer_load_dwordx4 v3, s[20:23], s60 offen offset:1024 sc1 lds
    v_lshlrev_b32 v10, 4, v1
    s_add_u32 s53, s44, 1
    s_and_b32 s53, s53, 3
    s_mul_i32 s53, s53, 9216
    s_add_u32 s53, s53, 126976
    v_add_u32 v11, s53, v10
    s_add_u32 s53, s44, 2
    s_and_b32 s53, s53, 3
    s_mul_i32 s53, s53, 9216
    s_add_u32 s53, s53, 126976
    v_add_u32 v12, s53, v10
    s_add_u32 s53, s44, 3
    s_and_b32 s53, s53, 3
    s_mul_i32 s53, s53, 9216
    s_add_u32 s53, s53, 126976
    v_add_u32 v13, s53, v10
    s_add_u32 s53, s44, 4
    s_and_b32 s53, s53, 3
    s_mul_i32 s53, s53, 9216
    s_add_u32 s53, s53, 126976
    v_add_u32 v10, s53, v10
    v_exp_f32 v138, v138
    v_exp_f32 v139, v139
    v_exp_f32 v140, v140
    v_exp_f32 v141, v141
    v_smfmac_f32_32x32x32_bf16 v[64:79], v[216:219], v[128:135], v8
    v_exp_f32 v142, v142
    v_exp_f32 v143, v143
    v_exp_f32 v80, v80
    v_exp_f32 v81, v81
    v_mfma_f32_32x32x8_bf16 v[96:111], v[172:173], v[162:163], 0
    buffer_load_dwordx4 v[206:209], v7, s[20:23], s49 offen sc1
    v_exp_f32 v82, v82
    v_exp_f32 v83, v83
    v_exp_f32 v84, v84
    v_exp_f32 v85, v85
    v_mfma_f32_32x32x16_bf16 v[96:111], v[168:171], v[148:151], v[96:111]
    v_exp_f32 v86, v86
    v_exp_f32 v87, v87
    v_exp_f32 v88, v88
    v_exp_f32 v89, v89
    v_smfmac_f32_32x32x32_bf16 v[64:79], v[220:223], v[136:143], v8
    v_exp_f32 v90, v90
    v_exp_f32 v91, v91
    v_exp_f32 v92, v92
    v_exp_f32 v93, v93
    v_smfmac_f32_32x32x32_bf16 v[16:31], v[174:177], v[80:87], v8
    v_exp_f32 v94, v94
    v_exp_f32 v95, v95
    v_exp_f32 v96, v96
    v_exp_f32 v97, v97
    v_mfma_f32_32x32x8_bf16 v[112:127], v[172:173], v[164:165], 0
    s_add_u32 s49, s49, 262144
    buffer_load_dwordx4 v[210:213], v4, s[20:23], s49 offen sc1
    v_exp_f32 v98, v98
    v_exp_f32 v99, v99
    v_exp_f32 v100, v100
    v_exp_f32 v101, v101
    v_mfma_f32_32x32x16_bf16 v[112:127], v[168:171], v[152:155], v[112:127]
    v_exp_f32 v102, v102
    v_exp_f32 v103, v103
    v_exp_f32 v104, v104
    v_exp_f32 v105, v105
    v_smfmac_f32_32x32x32_bf16 v[16:31], v[178:181], v[88:95], v8
    s_add_u32 m0, s61, 73728
    s_mov_b32 s60, 73728
    buffer_load_dwordx4 v3, s[20:23], s60 offen offset:0 sc1 lds
    buffer_load_dwordx4 v3, s[20:23], s60 offen offset:1024 sc1 lds
    v_exp_f32 v106, v106
    v_exp_f32 v107, v107
    v_exp_f32 v108, v108
    v_exp_f32 v109, v109
    v_smfmac_f32_32x32x32_bf16 v[32:47], v[174:177], v[96:103], v8
    v_exp_f32 v110, v110
    v_exp_f32 v111, v111
    v_exp_f32 v112, v112
    v_exp_f32 v113, v113
    v_mfma_f32_32x32x8_bf16 v[128:143], v[172:173], v[166:167], 0
    buffer_load_dwordx2 v[214:215], v5, s[20:23], s49 offen sc1
    v_exp_f32 v114, v114
    v_exp_f32 v115, v115
    v_exp_f32 v116, v116
    v_exp_f32 v117, v117
    v_mfma_f32_32x32x16_bf16 v[128:143], v[168:171], v[156:159], v[128:143]
    v_exp_f32 v118, v118
    v_exp_f32 v119, v119
    v_exp_f32 v120, v120
    v_exp_f32 v121, v121
    v_smfmac_f32_32x32x32_bf16 v[32:47], v[178:181], v[104:111], v8
    s_and_b32 s60, s2, 0xf8
    s_add_u32 s60, s60, s40
    s_mul_i32 s60, s60, 128
    s_min_u32 s60, s60, L_tail_end-L_att_tail-128
    s_add_u32 s60, s60, L_att_tail-L_pc
    s_load_dword s62, s[100:101], s60 offset:0
    s_load_dword s62, s[100:101], s60 offset:64
    v_exp_f32 v122, v122
    v_exp_f32 v123, v123
    v_exp_f32 v124, v124
    v_exp_f32 v125, v125
    v_smfmac_f32_32x32x32_bf16 v[48:63], v[174:177], v[112:119], v8
    v_exp_f32 v126, v126
    v_exp_f32 v127, v127
    v_exp_f32 v128, v128
    v_exp_f32 v129, v129
    s_waitcnt vmcnt(13)
    s_setprio 0
    v_mfma_f32_32x32x8_bf16 v[80:95], v[186:187], v[160:161], 0
    buffer_load_dwordx4 v[216:219], v6, s[20:23], s49 offen sc1
    v_exp_f32 v130, v130
    v_exp_f32 v131, v131
    v_exp_f32 v132, v132
    v_exp_f32 v133, v133
    v_mfma_f32_32x32x16_bf16 v[80:95], v[182:185], v[144:147], v[80:95]
    v_exp_f32 v134, v134
    v_exp_f32 v135, v135
    v_exp_f32 v136, v136
    v_exp_f32 v137, v137
    v_smfmac_f32_32x32x32_bf16 v[48:63], v[178:181], v[120:127], v8
    s_add_u32 m0, s61, 81920
    s_mov_b32 s60, 81920
    buffer_load_dwordx4 v3, s[20:23], s60 offen offset:0 sc1 lds
    buffer_load_dwordx4 v3, s[20:23], s60 offen offset:1024 sc1 lds
    v_exp_f32 v138, v138
    v_exp_f32 v139, v139
    v_exp_f32 v140, v140
    v_exp_f32 v141, v141
    v_smfmac_f32_32x32x32_bf16 v[64:79], v[174:177], v[128:135], v8
    v_exp_f32 v142, v142
    v_exp_f32 v143, v143
    v_exp_f32 v80, v80
    v_exp_f32 v81, v81
    v_mfma_f32_32x32x8_bf16 v[96:111], v[186:187], v[162:163], 0
    buffer_load_dwordx4 v[220:223], v7, s[20:23], s49 offen sc1
    v_exp_f32 v82, v82
    v_exp_f32 v83, v83
    v_exp_f32 v84, v84
    v_exp_f32 v85, v85
    v_mfma_f32_32x32x16_bf16 v[96:111], v[182:185], v[148:151], v[96:111]
    v_exp_f32 v86, v86
    v_exp_f32 v87, v87
    v_exp_f32 v88, v88
    v_exp_f32 v89, v89
    v_smfmac_f32_32x32x32_bf16 v[64:79], v[178:181], v[136:143], v8
    v_exp_f32 v90, v90
    v_exp_f32 v91, v91
    v_exp_f32 v92, v92
    v_exp_f32 v93, v93
    v_smfmac_f32_32x32x32_bf16 v[16:31], v[188:191], v[80:87], v8
    v_exp_f32 v94, v94
    v_exp_f32 v95, v95
    v_exp_f32 v96, v96
    v_exp_f32 v97, v97
    v_mfma_f32_32x32x8_bf16 v[112:127], v[186:187], v[164:165], 0
    v_exp_f32 v98, v98
    v_exp_f32 v99, v99
    v_exp_f32 v100, v100
    v_exp_f32 v101, v101
    v_mfma_f32_32x32x16_bf16 v[112:127], v[182:185], v[152:155], v[112:127]
    v_exp_f32 v102, v102
    v_exp_f32 v103, v103
    v_exp_f32 v104, v104
    v_exp_f32 v105, v105
    v_smfmac_f32_32x32x32_bf16 v[16:31], v[192:195], v[88:95], v8
    v_exp_f32 v106, v106
    v_exp_f32 v107, v107
    v_exp_f32 v108, v108
    v_exp_f32 v109, v109
    v_smfmac_f32_32x32x32_bf16 v[32:47], v[188:191], v[96:103], v8
    v_exp_f32 v110, v110
    v_exp_f32 v111, v111
    v_exp_f32 v112, v112
    v_exp_f32 v113, v113
    v_mfma_f32_32x32x8_bf16 v[128:143], v[186:187], v[166:167], 0
    v_exp_f32 v114, v114
    v_exp_f32 v115, v115
    v_exp_f32 v116, v116
    v_exp_f32 v117, v117
    v_mfma_f32_32x32x16_bf16 v[128:143], v[182:185], v[156:159], v[128:143]
    v_exp_f32 v118, v118
    v_exp_f32 v119, v119
    v_exp_f32 v120, v120
    v_exp_f32 v121, v121
    v_smfmac_f32_32x32x32_bf16 v[32:47], v[192:195], v[104:111], v8
    v_exp_f32 v122, v122
    v_exp_f32 v123, v123
    v_exp_f32 v124, v124
    v_exp_f32 v125, v125
    v_smfmac_f32_32x32x32_bf16 v[48:63], v[188:191], v[112:119], v8
    v_exp_f32 v126, v126
    v_exp_f32 v127, v127
    v_exp_f32 v128, v128
    v_exp_f32 v129, v129
    s_waitcnt vmcnt(8)
    s_barrier
    v_mfma_f32_32x32x8_bf16 v[80:95], v[200:201], v[160:161], 0
    v_exp_f32 v130, v130
    v_exp_f32 v131, v131
    v_exp_f32 v132, v132
    v_exp_f32 v133, v133
    v_mfma_f32_32x32x16_bf16 v[80:95], v[196:199], v[144:147], v[80:95]
    v_exp_f32 v134, v134
    v_exp_f32 v135, v135
    v_exp_f32 v136, v136
    v_exp_f32 v137, v137
    v_smfmac_f32_32x32x32_bf16 v[48:63], v[192:195], v[120:127], v8
    v_exp_f32 v138, v138
    v_exp_f32 v139, v139
    v_exp_f32 v140, v140
    v_exp_f32 v141, v141
    v_smfmac_f32_32x32x32_bf16 v[64:79], v[188:191], v[128:135], v8
    v_exp_f32 v142, v142
    v_exp_f32 v143, v143
    v_exp_f32 v80, v80
    v_exp_f32 v81, v81
    v_mfma_f32_32x32x8_bf16 v[96:111], v[200:201], v[162:163], 0
    v_exp_f32 v82, v82
    v_exp_f32 v83, v83
    v_exp_f32 v84, v84
    v_exp_f32 v85, v85
    v_mfma_f32_32x32x16_bf16 v[96:111], v[196:199], v[148:151], v[96:111]
    v_exp_f32 v86, v86
    v_exp_f32 v87, v87
    v_exp_f32 v88, v88
    v_exp_f32 v89, v89
    v_smfmac_f32_32x32x32_bf16 v[64:79], v[192:195], v[136:143], v8
    v_exp_f32 v90, v90
    v_exp_f32 v91, v91
    v_exp_f32 v92, v92
    v_exp_f32 v93, v93
    v_smfmac_f32_32x32x32_bf16 v[16:31], v[202:205], v[80:87], v8
    v_exp_f32 v94, v94
    v_exp_f32 v95, v95
    v_exp_f32 v96, v96
    v_exp_f32 v97, v97
    v_mfma_f32_32x32x8_bf16 v[112:127], v[200:201], v[164:165], 0
    v_exp_f32 v98, v98
    v_exp_f32 v99, v99
    v_exp_f32 v100, v100
    v_exp_f32 v101, v101
    v_mfma_f32_32x32x16_bf16 v[112:127], v[196:199], v[152:155], v[112:127]
    v_exp_f32 v102, v102
    v_exp_f32 v103, v103
    v_exp_f32 v104, v104
    v_exp_f32 v105, v105
    v_smfmac_f32_32x32x32_bf16 v[16:31], v[206:209], v[88:95], v8
    v_exp_f32 v106, v106
    v_exp_f32 v107, v107
    v_exp_f32 v108, v108
    v_exp_f32 v109, v109
    v_smfmac_f32_32x32x32_bf16 v[32:47], v[202:205], v[96:103], v8
    v_exp_f32 v110, v110
    v_exp_f32 v111, v111
    v_exp_f32 v112, v112
    v_exp_f32 v113, v113
    v_mfma_f32_32x32x8_bf16 v[128:143], v[200:201], v[166:167], 0
    v_exp_f32 v114, v114
    v_exp_f32 v115, v115
    v_exp_f32 v116, v116
    v_exp_f32 v117, v117
    v_mfma_f32_32x32x16_bf16 v[128:143], v[196:199], v[156:159], v[128:143]
    v_exp_f32 v118, v118
    v_exp_f32 v119, v119
    v_exp_f32 v120, v120
    v_exp_f32 v121, v121
    v_smfmac_f32_32x32x32_bf16 v[32:47], v[206:209], v[104:111], v8
    v_exp_f32 v122, v122
    v_exp_f32 v123, v123
    v_exp_f32 v124, v124
    v_exp_f32 v125, v125
    v_smfmac_f32_32x32x32_bf16 v[48:63], v[202:205], v[112:119], v8
    v_exp_f32 v126, v126
    v_exp_f32 v127, v127
    v_exp_f32 v128, v128
    v_exp_f32 v129, v129
    s_waitcnt vmcnt(0)
    v_mfma_f32_32x32x8_bf16 v[80:95], v[214:215], v[160:161], 0
    v_exp_f32 v130, v130
    v_exp_f32 v131, v131
    v_exp_f32 v132, v132
    v_exp_f32 v133, v133
    v_mfma_f32_32x32x16_bf16 v[80:95], v[210:213], v[144:147], v[80:95]
    v_exp_f32 v134, v134
    v_exp_f32 v135, v135
    v_exp_f32 v136, v136
    v_exp_f32 v137, v137
    v_smfmac_f32_32x32x32_bf16 v[48:63], v[206:209], v[120:127], v8
    v_exp_f32 v138, v138
    v_exp_f32 v139, v139
    v_exp_f32 v140, v140
    v_exp_f32 v141, v141
    v_smfmac_f32_32x32x32_bf16 v[64:79], v[202:205], v[128:135], v8
    v_exp_f32 v142, v142
    v_exp_f32 v143, v143
    v_exp_f32 v80, v80
    v_exp_f32 v81, v81
    v_mfma_f32_32x32x8_bf16 v[96:111], v[214:215], v[162:163], 0
    v_exp_f32 v82, v82
    v_exp_f32 v83, v83
    v_exp_f32 v84, v84
    v_exp_f32 v85, v85
    v_mfma_f32_32x32x16_bf16 v[96:111], v[210:213], v[148:151], v[96:111]
    v_exp_f32 v86, v86
    v_exp_f32 v87, v87
    v_exp_f32 v88, v88
    v_exp_f32 v89, v89
    v_smfmac_f32_32x32x32_bf16 v[64:79], v[206:209], v[136:143], v8
    v_exp_f32 v90, v90
    v_exp_f32 v91, v91
    v_exp_f32 v92, v92
    v_exp_f32 v93, v93
    v_smfmac_f32_32x32x32_bf16 v[16:31], v[216:219], v[80:87], v8
    v_exp_f32 v94, v94
    v_exp_f32 v95, v95
    v_exp_f32 v96, v96
    v_exp_f32 v97, v97
    v_mfma_f32_32x32x8_bf16 v[112:127], v[214:215], v[164:165], 0
    v_exp_f32 v98, v98
    v_exp_f32 v99, v99
    v_exp_f32 v100, v100
    v_exp_f32 v101, v101
    v_mfma_f32_32x32x16_bf16 v[112:127], v[210:213], v[152:155], v[112:127]
    v_exp_f32 v102, v102
    v_exp_f32 v103, v103
    v_exp_f32 v104, v104
    v_exp_f32 v105, v105
    v_smfmac_f32_32x32x32_bf16 v[16:31], v[220:223], v[88:95], v8
    v_exp_f32 v106, v106
    v_exp_f32 v107, v107
    v_exp_f32 v108, v108
    v_exp_f32 v109, v109
    v_smfmac_f32_32x32x32_bf16 v[32:47], v[216:219], v[96:103], v8
    v_exp_f32 v110, v110
    v_exp_f32 v111, v111
    v_exp_f32 v112, v112
    v_exp_f32 v113, v113
    v_mfma_f32_32x32x8_bf16 v[128:143], v[214:215], v[166:167], 0
    v_exp_f32 v114, v114
    v_exp_f32 v115, v115
    v_exp_f32 v116, v116
    v_exp_f32 v117, v117
    v_mfma_f32_32x32x16_bf16 v[128:143], v[210:213], v[156:159], v[128:143]
    v_exp_f32 v118, v118
    v_exp_f32 v119, v119
    ds_write_b128 v11, v[16:19] offset:0
    v_exp_f32 v120, v120
    v_exp_f32 v121, v121
    v_smfmac_f32_32x32x32_bf16 v[32:47], v[220:223], v[104:111], v8
    v_exp_f32 v122, v122
    v_exp_f32 v123, v123
    ds_write_b128 v11, v[20:23] offset:1024
    v_exp_f32 v124, v124
    v_exp_f32 v125, v125
    v_smfmac_f32_32x32x32_bf16 v[48:63], v[216:219], v[112:119], v8
    v_exp_f32 v126, v126
    ds_write_b128 v11, v[24:27] offset:2048
    v_exp_f32 v127, v127
    v_exp_f32 v128, v128
    v_exp_f32 v129, v129
    v_exp_f32 v130, v130
    v_exp_f32 v131, v131
    v_exp_f32 v132, v132
    v_exp_f32 v133, v133
    v_exp_f32 v134, v134
    v_exp_f32 v135, v135
    ds_write_b128 v12, v[32:35] offset:3072
    v_exp_f32 v136, v136
    v_exp_f32 v137, v137
    v_smfmac_f32_32x32x32_bf16 v[48:63], v[220:223], v[120:127], v8
    v_exp_f32 v138, v138
    v_exp_f32 v139, v139
    ds_write_b128 v12, v[36:39] offset:4096
    v_exp_f32 v140, v140
    v_exp_f32 v141, v141
    v_smfmac_f32_32x32x32_bf16 v[64:79], v[216:219], v[128:135], v8
    v_exp_f32 v142, v142
    ds_write_b128 v12, v[40:43] offset:5120
    v_exp_f32 v143, v143
L_att_tail:
    s_mul_i32 s53, s44, 9216
    s_add_u32 s53, s53, 90112
    v_smfmac_f32_32x32x32_bf16 v[64:79], v[220:223], v[136:143], v8
    s_setprio 3
    s_nop 0
    ds_write_b128 v13, v[48:51] offset:6144
    ds_write_b128 v13, v[52:55] offset:7168
    ds_write_b128 v13, v[56:59] offset:8192
    v_and_b32 v12, 31, v1
    v_lshl_add_u32 v12, v12, 3, s53
    s_mov_b32 s52, 0x71800000
    s_mov_b32 s53, 0x2b800000
    s_waitcnt lgkmcnt(0)
    s_barrier
    ds_read_b128 v[80:83], v10 offset:0
    ds_read_b128 v[84:87], v10 offset:1024
    ds_read_b128 v[88:91], v10 offset:2048
    ds_read_b128 v[92:95], v10 offset:3072
    ds_read_b128 v[96:99], v10 offset:4096
    ds_read_b128 v[100:103], v10 offset:5120
    ds_read_b128 v[104:107], v10 offset:6144
    ds_read_b128 v[108:111], v10 offset:7168
    ds_read_b128 v[112:115], v10 offset:8192
    ds_read_b64 v[120:121], v12
    s_waitcnt lgkmcnt(7)
    v_pk_add_f32 v[64:65], v[64:65], v[80:81]
    v_pk_add_f32 v[66:67], v[66:67], v[82:83]
    v_pk_add_f32 v[68:69], v[68:69], v[84:85]
    v_pk_add_f32 v[70:71], v[70:71], v[86:87]
    v_pk_add_f32 v[72:73], v[72:73], v[88:89]
    v_pk_add_f32 v[74:75], v[74:75], v[90:91]
    s_waitcnt lgkmcnt(4)
    v_pk_add_f32 v[64:65], v[64:65], v[92:93]
    v_pk_add_f32 v[66:67], v[66:67], v[94:95]
    v_pk_add_f32 v[68:69], v[68:69], v[96:97]
    v_pk_add_f32 v[70:71], v[70:71], v[98:99]
    v_pk_add_f32 v[72:73], v[72:73], v[100:101]
    v_pk_add_f32 v[74:75], v[74:75], v[102:103]
    s_waitcnt lgkmcnt(1)
    v_pk_add_f32 v[64:65], v[64:65], v[104:105]
    v_pk_add_f32 v[66:67], v[66:67], v[106:107]
    v_pk_add_f32 v[68:69], v[68:69], v[108:109]
    v_pk_add_f32 v[70:71], v[70:71], v[110:111]
    v_pk_add_f32 v[72:73], v[72:73], v[112:113]
    v_pk_add_f32 v[74:75], v[74:75], v[114:115]
    v_mov_b32 v13, v72
    v_mov_b32 v14, v72
    v_maximum3_f32 v15, |v64|, |v65|, |v66|
    v_maximum3_f32 v15, v15, |v67|, |v68|
    v_permlane32_swap_b32 v13, v14
    v_maximum3_f32 v15, v15, |v69|, |v70|
    v_maximum3_f32 v15, v15, |v71|, |v72|
    v_maximum3_f32 v15, v15, |v73|, |v74|
    v_maximum3_f32 v15, v15, |v75|, |v75|
    v_cmp_nle_f32 s[58:59], s53, v14
    v_cmp_nge_f32 vcc, s52, v15
    s_nop 0
    s_or_b64 vcc, vcc, s[58:59]
    s_cbranch_vccnz L_att_fallback
L_att_norm1:
    v_rcp_f32 v14, v14
    s_nop 0
    v_pk_mul_f32 v[64:65], v[64:65], v[14:15] op_sel_hi:[1,0]
    v_pk_mul_f32 v[66:67], v[66:67], v[14:15] op_sel_hi:[1,0]
    v_pk_mul_f32 v[68:69], v[68:69], v[14:15] op_sel_hi:[1,0]
    v_pk_mul_f32 v[70:71], v[70:71], v[14:15] op_sel_hi:[1,0]
    v_pk_mul_f32 v[72:73], v[72:73], v[14:15] op_sel_hi:[1,0]
    v_pk_mul_f32 v[74:75], v[74:75], v[14:15] op_sel_hi:[1,0]
    v_cvt_pk_bf16_f32 v116, v64, v65
    v_cvt_pk_bf16_f32 v117, v66, v67
    v_cvt_pk_bf16_f32 v118, v68, v69
    v_cvt_pk_bf16_f32 v119, v70, v71
    v_cvt_pk_bf16_f32 v122, v72, v73
    v_cvt_pk_bf16_f32 v123, v74, v75
    v_permlane32_swap_b32 v116, v118
    v_permlane32_swap_b32 v117, v119
    buffer_store_dwordx4 v[116:119], v4, s[20:23], s47 offen sc0 sc1
    s_waitcnt lgkmcnt(0)
    s_mov_b32 exec_hi, 0
    buffer_store_dwordx4 v[120:123], v5, s[20:23], s47 offen sc0 sc1
    s_mov_b32 exec_hi, -1
    s_setprio 0
    s_lshl_b32 s52, s41, 4
    s_add_u32 s52, s52, s42
    s_lshr_b32 s58, s52, 4
    s_and_b32 s60, s58, 3
    s_lshl_b32 s60, s60, 11
    s_and_b32 s59, s58, 4
    s_lshl_b32 s59, s59, 12
    s_add_u32 s60, s60, s59
    s_and_b32 s59, s58, 8
    s_lshl_b32 s59, s59, 10
    s_add_u32 s60, s60, s59
    s_xor_b32 s60, s60, s99
    s_add_u32 s60, s60, 29392896
    s_and_b32 s59, s52, 15
    s_lshl_b32 s59, s59, 7
    s_add_u32 s60, s60, s59
    v_lshl_add_u32 v249, v1, 2, s60
    s_bfe_u32 s41, s2, 0x20001
    s_lshl_b32 s41, s41, 2
    s_bfe_u32 s42, s2, 0x20003
    s_add_u32 s41, s41, s42
    s_lshl_b32 s41, s41, 1
    s_bfe_u32 s42, s2, 0x10005
    s_add_u32 s41, s41, s42
    s_lshr_b32 s42, s2, 6
    s_and_b32 s60, s2, 1
    s_lshl_b32 s60, s60, 2
    s_add_u32 s42, s42, s60
    s_and_b32 s43, s40, 1
    s_bfe_u32 s44, s40, 0x10001
    s_lshl_b32 s48, s41, 1
    s_add_u32 s48, s48, s43
    s_lshr_b32 s53, s41, 1
    s_and_b32 s60, s53, 3
    s_lshl_b32 s60, s60, 11
    s_and_b32 s59, s53, 4
    s_lshl_b32 s59, s59, 12
    s_add_u32 s60, s60, s59
    s_and_b32 s59, s53, 8
    s_lshl_b32 s59, s59, 10
    s_add_u32 s60, s60, s59
    s_xor_b32 s60, s60, s99
    s_add_u32 s60, s60, 29392896
    v_min_u32 v250, 15, v1
    v_lshl_add_u32 v250, v250, 7, s60
    v_permlane16_swap_b32 v224, v226
    v_permlane16_swap_b32 v225, v227
    v_permlane16_swap_b32 v228, v230
    v_permlane16_swap_b32 v229, v231
    v_permlane16_swap_b32 v232, v234
    v_permlane16_swap_b32 v233, v235
    v_lshlrev_b32 v192, 16, v224
    v_and_b32 v193, 0xffff0000, v224
    v_lshlrev_b32 v194, 16, v225
    v_and_b32 v195, 0xffff0000, v225
    v_lshlrev_b32 v196, 16, v226
    v_and_b32 v197, 0xffff0000, v226
    v_lshlrev_b32 v198, 16, v227
    v_and_b32 v199, 0xffff0000, v227
    v_lshlrev_b32 v200, 16, v228
    v_and_b32 v201, 0xffff0000, v228
    v_lshlrev_b32 v202, 16, v229
    v_and_b32 v203, 0xffff0000, v229
    v_lshlrev_b32 v204, 16, v230
    v_and_b32 v205, 0xffff0000, v230
    v_lshlrev_b32 v206, 16, v231
    v_and_b32 v207, 0xffff0000, v231
    v_lshlrev_b32 v208, 16, v232
    v_and_b32 v209, 0xffff0000, v232
    v_lshlrev_b32 v210, 16, v233
    v_and_b32 v211, 0xffff0000, v233
    v_lshlrev_b32 v212, 16, v234
    v_and_b32 v213, 0xffff0000, v234
    v_lshlrev_b32 v214, 16, v235
    v_and_b32 v215, 0xffff0000, v235
    s_waitcnt vmcnt(0)
    s_barrier
    s_cmp_eq_u32 s40, 0
    s_cbranch_scc0 L_ho_att_a
    s_mov_b32 exec_hi, 0
    buffer_store_dword v248, v249, s[20:23], 0 offen sc0 sc1
    s_mov_b64 exec, -1
L_ho_att_a:
    v_lshlrev_b32 v10, 4, v1
    s_mul_i32 s45, s44, 8192
    s_mul_i32 s46, s44, 3072
    v_add_u32 v4, s45, v10
    v_add_u32 v5, s46, v10
    v_lshrrev_b32 v11, 4, v1
    v_and_b32 v12, 15, v1
    v_lshlrev_b32 v12, 4, v12
    v_lshl_add_u32 v6, v11, 9, v12
    s_and_b32 s55, s48, 15
    s_mul_i32 s55, s55, 81920
    s_bfe_u32 s60, s48, 65540
    s_lshl_b32 s60, s60, 21
    s_add_u32 s55, s55, s60
    s_lshl_b32 s60, s48, 1
    s_xor_b32 s60, s60, s48
    s_and_b32 s60, s60, 32
    s_lshl_b32 s60, s60, 8
    s_xor_b32 s60, s60, s99
    s_add_u32 s55, s55, s60
    s_add_u32 s55, s55, 37748736
    s_bfe_u32 s56, s48, 0x40001
    s_lshl_b32 s56, s56, 14
    s_and_b32 s60, s48, 1
    s_lshl_b32 s60, s60, 12
    s_add_u32 s56, s56, s60
    s_and_b32 s60, s48, 32
    s_lshl_b32 s60, s60, 8
    s_xor_b32 s60, s60, s99
    s_add_u32 s56, s56, s60
    s_add_u32 s56, s56, 29622272
    s_lshl_b32 s57, s42, 9
    s_add_u32 s56, s56, s57
    s_lshl_b32 s57, s44, 8
    s_add_u32 s56, s56, s57
    s_mul_i32 s57, s42, 5120
    s_mul_i32 s58, s44, 3072
    s_add_u32 s57, s57, s58
    v_lshlrev_b32 v3, 3, v1
    s_add_u32 s58, s57, 0
    s_and_b32 s59, s58, 0xffffe000
    s_add_u32 s58, s58, s59
    s_add_u32 s50, s58, s55
    s_add_u32 s58, s57, 1024
    s_and_b32 s59, s58, 0xffffe000
    s_add_u32 s58, s58, s59
    s_add_u32 s51, s58, s55
    s_add_u32 s58, s57, 2048
    s_and_b32 s59, s58, 0xffffe000
    s_add_u32 s58, s58, s59
    s_add_u32 s52, s58, s55
    s_mul_i32 s45, s40, 6144
    s_xor_b32 s46, s40, 2
    s_mul_i32 s46, s46, 6144
    s_lshl_b32 s47, s44, 11
    s_add_u32 s46, s46, s47
    s_add_u32 s45, s45, 102400
    s_add_u32 s46, s46, 102400
    v_lshlrev_b32 v2, 4, v1
    v_add_u32 v15, s46, v2
    v_add_u32 v14, s45, v2
    s_and_b32 s49, s48, 15
    s_mul_i32 s49, s49, 81920
    s_bfe_u32 s60, s48, 65540
    s_lshl_b32 s60, s60, 21
    s_add_u32 s49, s49, s60
    s_lshl_b32 s60, s48, 1
    s_xor_b32 s60, s60, s48
    s_and_b32 s60, s60, 32
    s_lshl_b32 s60, s60, 8
    s_xor_b32 s60, s60, s99
    s_add_u32 s49, s49, s60
    s_add_u32 s49, s49, 41943040
    s_lshl_b32 s45, s44, 11
    s_add_u32 s49, s49, s45
    s_cmp_eq_u32 s40, 0
    s_cbranch_scc0 L_ho_att_done
    s_mov_b32 s62, 0
    s_waitcnt vmcnt(0)
L_ho_att:
    buffer_load_dword v251, v250, s[20:23], 0 offen sc0 sc1
    s_add_u32 s62, s62, 1
    s_waitcnt vmcnt(0)
L_ho_att_chk:
    v_cmp_ne_u32 vcc, s3, v251
    s_cmp_gt_u32 s62, 400000
    s_cbranch_scc1 L_ho_att_done
    s_cbranch_vccz L_ho_att_done
    s_branch L_ho_att
L_ho_att_done:
    s_barrier
    buffer_load_dwordx4 v[96:99], v6, s[20:23], s49 offen offset:0 sc1
    buffer_load_dwordx4 v[100:103], v6, s[20:23], s49 offen offset:256 sc1
    v_lshrrev_b32 v12, 4, v1
    s_mul_i32 s45, s44, 192
    s_add_u32 s45, s45, 126976
    v_lshl_add_u32 v12, v12, 4, s45
    ds_read_b128 v[160:163], v12 offset:0
    ds_read_b128 v[164:167], v12 offset:64
    ds_read_b128 v[168:171], v12 offset:128
    ds_read_b128 v[172:175], v12 offset:320
    ds_read_b128 v[176:179], v12 offset:384
    ds_read_b128 v[180:183], v12 offset:448
    ds_read_b128 v[232:235], v12 offset:640
    ds_read_b128 v[236:239], v12 offset:704
    ds_read_b128 v[240:243], v12 offset:768
    s_add_u32 s49, s49, 4096
    buffer_load_dwordx4 v[104:107], v6, s[20:23], s49 offen offset:0 sc1
    buffer_load_dwordx4 v[108:111], v6, s[20:23], s49 offen offset:256 sc1
    ds_read_b128 v[56:59], v4 offset:0
    ds_read_b128 v[60:63], v4 offset:1024
    ds_read_b128 v[64:67], v5 offset:2048
    ds_read_b128 v[68:71], v5 offset:3072
    ds_read_b128 v[72:75], v5 offset:4096
    ds_read_b128 v[76:79], v4 offset:10240
    ds_read_b128 v[80:83], v4 offset:11264
    ds_read_b128 v[84:87], v5 offset:12288
    ds_read_b128 v[88:91], v5 offset:13312
    ds_read_b128 v[92:95], v5 offset:14336
    s_add_u32 s49, s49, 12288
    buffer_load_dwordx4 v[112:115], v6, s[20:23], s49 offen offset:0 sc1
    buffer_load_dwordx4 v[116:119], v6, s[20:23], s49 offen offset:256 sc1
    s_add_u32 s49, s49, 4096
    buffer_load_dwordx4 v[120:123], v6, s[20:23], s49 offen offset:0 sc1
    buffer_load_dwordx4 v[124:127], v6, s[20:23], s49 offen offset:256 sc1
    s_waitcnt vmcnt(6) lgkmcnt(5)
    v_mfma_f32_16x16x32_bf16 v[16:19], v[56:59], v[96:99], 0
    v_mfma_f32_16x16x32_bf16 v[20:23], v[56:59], v[100:103], 0
    ds_read_b128 v[56:59], v4 offset:20480
    v_mfma_f32_16x16x32_bf16 v[24:27], v[60:63], v[96:99], 0
    s_add_u32 s49, s49, 12288
    buffer_load_dwordx4 v[128:131], v6, s[20:23], s49 offen offset:0 sc1
    v_mfma_f32_16x16x32_bf16 v[28:31], v[60:63], v[100:103], 0
    ds_read_b128 v[60:63], v4 offset:21504
    v_mfma_f32_16x16x32_bf16 v[32:35], v[64:67], v[96:99], 0
    buffer_load_dwordx4 v[132:135], v6, s[20:23], s49 offen offset:256 sc1
    v_mfma_f32_16x16x32_bf16 v[36:39], v[64:67], v[100:103], 0
    ds_read_b128 v[64:67], v5 offset:22528
    v_mfma_f32_16x16x32_bf16 v[40:43], v[68:71], v[96:99], 0
    s_add_u32 s49, s49, 4096
    buffer_load_dwordx4 v[136:139], v6, s[20:23], s49 offen offset:0 sc1
    v_mfma_f32_16x16x32_bf16 v[44:47], v[68:71], v[100:103], 0
    ds_read_b128 v[68:71], v5 offset:23552
    v_mfma_f32_16x16x32_bf16 v[48:51], v[72:75], v[96:99], 0
    buffer_load_dwordx4 v[140:143], v6, s[20:23], s49 offen offset:256 sc1
    v_mfma_f32_16x16x32_bf16 v[52:55], v[72:75], v[100:103], 0
    s_waitcnt vmcnt(8) lgkmcnt(4)
    v_mfma_f32_16x16x32_bf16 v[16:19], v[76:79], v[104:107], v[16:19]
    ds_read_b128 v[72:75], v5 offset:24576
    v_mfma_f32_16x16x32_bf16 v[20:23], v[76:79], v[108:111], v[20:23]
    ds_read_b128 v[76:79], v4 offset:30720
    v_mfma_f32_16x16x32_bf16 v[24:27], v[80:83], v[104:107], v[24:27]
    s_add_u32 s49, s49, 12288
    buffer_load_dwordx4 v[144:147], v6, s[20:23], s49 offen offset:0 sc1
    v_mfma_f32_16x16x32_bf16 v[28:31], v[80:83], v[108:111], v[28:31]
    ds_read_b128 v[80:83], v4 offset:31744
    v_mfma_f32_16x16x32_bf16 v[32:35], v[84:87], v[104:107], v[32:35]
    buffer_load_dwordx4 v[148:151], v6, s[20:23], s49 offen offset:256 sc1
    v_mfma_f32_16x16x32_bf16 v[36:39], v[84:87], v[108:111], v[36:39]
    ds_read_b128 v[84:87], v5 offset:32768
    v_mfma_f32_16x16x32_bf16 v[40:43], v[88:91], v[104:107], v[40:43]
    s_add_u32 s49, s49, 4096
    buffer_load_dwordx4 v[152:155], v6, s[20:23], s49 offen offset:0 sc1
    v_mfma_f32_16x16x32_bf16 v[44:47], v[88:91], v[108:111], v[44:47]
    ds_read_b128 v[88:91], v5 offset:33792
    v_mfma_f32_16x16x32_bf16 v[48:51], v[92:95], v[104:107], v[48:51]
    buffer_load_dwordx4 v[156:159], v6, s[20:23], s49 offen offset:256 sc1
    v_mfma_f32_16x16x32_bf16 v[52:55], v[92:95], v[108:111], v[52:55]
    s_waitcnt vmcnt(10) lgkmcnt(4)
    v_mfma_f32_16x16x32_bf16 v[16:19], v[56:59], v[112:115], v[16:19]
    ds_read_b128 v[92:95], v5 offset:34816
    v_mfma_f32_16x16x32_bf16 v[20:23], v[56:59], v[116:119], v[20:23]
    ds_read_b128 v[56:59], v4 offset:40960
    v_mfma_f32_16x16x32_bf16 v[24:27], v[60:63], v[112:115], v[24:27]
    s_add_u32 s49, s49, 12288
    buffer_load_dwordx4 v[96:99], v6, s[20:23], s49 offen offset:0 sc1
    v_mfma_f32_16x16x32_bf16 v[28:31], v[60:63], v[116:119], v[28:31]
    ds_read_b128 v[60:63], v4 offset:41984
    v_mfma_f32_16x16x32_bf16 v[32:35], v[64:67], v[112:115], v[32:35]
    v_mfma_f32_16x16x32_bf16 v[36:39], v[64:67], v[116:119], v[36:39]
    ds_read_b128 v[64:67], v5 offset:43008
    v_mfma_f32_16x16x32_bf16 v[40:43], v[68:71], v[112:115], v[40:43]
    buffer_load_dwordx4 v[100:103], v6, s[20:23], s49 offen offset:256 sc1
    v_mfma_f32_16x16x32_bf16 v[44:47], v[68:71], v[116:119], v[44:47]
    ds_read_b128 v[68:71], v5 offset:44032
    v_mfma_f32_16x16x32_bf16 v[48:51], v[72:75], v[112:115], v[48:51]
    s_add_u32 s49, s49, 4096
    s_barrier
    v_mfma_f32_16x16x32_bf16 v[52:55], v[72:75], v[116:119], v[52:55]
    s_waitcnt vmcnt(10) lgkmcnt(4)
    v_mfma_f32_16x16x32_bf16 v[16:19], v[76:79], v[120:123], v[16:19]
    ds_read_b128 v[72:75], v5 offset:45056
    v_add_u32 v4, 51200, v4
    v_add_u32 v5, 51200, v5
    v_mfma_f32_16x16x32_bf16 v[20:23], v[76:79], v[124:127], v[20:23]
    ds_read_b128 v[76:79], v4 offset:0
    v_mfma_f32_16x16x32_bf16 v[24:27], v[80:83], v[120:123], v[24:27]
    buffer_load_dwordx4 v[104:107], v6, s[20:23], s49 offen offset:0 sc1
    v_mfma_f32_16x16x32_bf16 v[28:31], v[80:83], v[124:127], v[28:31]
    ds_read_b128 v[80:83], v4 offset:1024
    v_mfma_f32_16x16x32_bf16 v[32:35], v[84:87], v[120:123], v[32:35]
    v_mfma_f32_16x16x32_bf16 v[36:39], v[84:87], v[124:127], v[36:39]
    ds_read_b128 v[84:87], v5 offset:2048
    v_mfma_f32_16x16x32_bf16 v[40:43], v[88:91], v[120:123], v[40:43]
    buffer_load_dwordx4 v[108:111], v6, s[20:23], s49 offen offset:256 sc1
    v_mfma_f32_16x16x32_bf16 v[44:47], v[88:91], v[124:127], v[44:47]
    ds_read_b128 v[88:91], v5 offset:3072
    v_mfma_f32_16x16x32_bf16 v[48:51], v[92:95], v[120:123], v[48:51]
    v_mfma_f32_16x16x32_bf16 v[52:55], v[92:95], v[124:127], v[52:55]
    s_waitcnt vmcnt(10) lgkmcnt(4)
    v_mfma_f32_16x16x32_bf16 v[16:19], v[56:59], v[128:131], v[16:19]
    ds_read_b128 v[92:95], v5 offset:4096
    v_mfma_f32_16x16x32_bf16 v[20:23], v[56:59], v[132:135], v[20:23]
    ds_read_b128 v[56:59], v4 offset:10240
    v_mfma_f32_16x16x32_bf16 v[24:27], v[60:63], v[128:131], v[24:27]
    v_mfma_f32_16x16x32_bf16 v[28:31], v[60:63], v[132:135], v[28:31]
    ds_read_b128 v[60:63], v4 offset:11264
    v_mfma_f32_16x16x32_bf16 v[32:35], v[64:67], v[128:131], v[32:35]
    v_mfma_f32_16x16x32_bf16 v[36:39], v[64:67], v[132:135], v[36:39]
    ds_read_b128 v[64:67], v5 offset:12288
    v_mfma_f32_16x16x32_bf16 v[40:43], v[68:71], v[128:131], v[40:43]
    v_mfma_f32_16x16x32_bf16 v[44:47], v[68:71], v[132:135], v[44:47]
    ds_read_b128 v[68:71], v5 offset:13312
    v_mfma_f32_16x16x32_bf16 v[48:51], v[72:75], v[128:131], v[48:51]
    v_mfma_f32_16x16x32_bf16 v[52:55], v[72:75], v[132:135], v[52:55]
    s_waitcnt vmcnt(8) lgkmcnt(4)
    v_mfma_f32_16x16x32_bf16 v[16:19], v[76:79], v[136:139], v[16:19]
    ds_read_b128 v[72:75], v5 offset:14336
    v_mfma_f32_16x16x32_bf16 v[20:23], v[76:79], v[140:143], v[20:23]
    ds_read_b128 v[76:79], v4 offset:20480
    v_mfma_f32_16x16x32_bf16 v[24:27], v[80:83], v[136:139], v[24:27]
    v_mfma_f32_16x16x32_bf16 v[28:31], v[80:83], v[140:143], v[28:31]
    ds_read_b128 v[80:83], v4 offset:21504
    v_mfma_f32_16x16x32_bf16 v[32:35], v[84:87], v[136:139], v[32:35]
    v_mfma_f32_16x16x32_bf16 v[36:39], v[84:87], v[140:143], v[36:39]
    ds_read_b128 v[84:87], v5 offset:22528
    v_mfma_f32_16x16x32_bf16 v[40:43], v[88:91], v[136:139], v[40:43]
    v_mfma_f32_16x16x32_bf16 v[44:47], v[88:91], v[140:143], v[44:47]
    ds_read_b128 v[88:91], v5 offset:23552
    v_mfma_f32_16x16x32_bf16 v[48:51], v[92:95], v[136:139], v[48:51]
    v_mfma_f32_16x16x32_bf16 v[52:55], v[92:95], v[140:143], v[52:55]
    s_waitcnt vmcnt(6) lgkmcnt(4)
    v_mfma_f32_16x16x32_bf16 v[16:19], v[56:59], v[144:147], v[16:19]
    ds_read_b128 v[92:95], v5 offset:24576
    v_mfma_f32_16x16x32_bf16 v[20:23], v[56:59], v[148:151], v[20:23]
    ds_read_b128 v[56:59], v4 offset:30720
    v_mfma_f32_16x16x32_bf16 v[24:27], v[60:63], v[144:147], v[24:27]
    v_mfma_f32_16x16x32_bf16 v[28:31], v[60:63], v[148:151], v[28:31]
    ds_read_b128 v[60:63], v4 offset:31744
    v_mfma_f32_16x16x32_bf16 v[32:35], v[64:67], v[144:147], v[32:35]
    v_mfma_f32_16x16x32_bf16 v[36:39], v[64:67], v[148:151], v[36:39]
    ds_read_b128 v[64:67], v5 offset:32768
    v_mfma_f32_16x16x32_bf16 v[40:43], v[68:71], v[144:147], v[40:43]
    v_mfma_f32_16x16x32_bf16 v[44:47], v[68:71], v[148:151], v[44:47]
    ds_read_b128 v[68:71], v5 offset:33792
    v_mfma_f32_16x16x32_bf16 v[48:51], v[72:75], v[144:147], v[48:51]
    v_mfma_f32_16x16x32_bf16 v[52:55], v[72:75], v[148:151], v[52:55]
    s_waitcnt vmcnt(4) lgkmcnt(4)
    v_mfma_f32_16x16x32_bf16 v[16:19], v[76:79], v[152:155], v[16:19]
    ds_read_b128 v[72:75], v5 offset:34816
    v_mfma_f32_16x16x32_bf16 v[20:23], v[76:79], v[156:159], v[20:23]
    ds_read_b128 v[76:79], v4 offset:40960
    v_mfma_f32_16x16x32_bf16 v[24:27], v[80:83], v[152:155], v[24:27]
    v_mfma_f32_16x16x32_bf16 v[28:31], v[80:83], v[156:159], v[28:31]
    ds_read_b128 v[80:83], v4 offset:41984
    v_mfma_f32_16x16x32_bf16 v[32:35], v[84:87], v[152:155], v[32:35]
    v_mfma_f32_16x16x32_bf16 v[36:39], v[84:87], v[156:159], v[36:39]
    ds_read_b128 v[84:87], v5 offset:43008
    v_mfma_f32_16x16x32_bf16 v[40:43], v[88:91], v[152:155], v[40:43]
    v_mfma_f32_16x16x32_bf16 v[44:47], v[88:91], v[156:159], v[44:47]
    ds_read_b128 v[88:91], v5 offset:44032
    v_mfma_f32_16x16x32_bf16 v[48:51], v[92:95], v[152:155], v[48:51]
    v_mfma_f32_16x16x32_bf16 v[52:55], v[92:95], v[156:159], v[52:55]
    ds_read_b128 v[92:95], v5 offset:45056
    s_waitcnt vmcnt(2) lgkmcnt(5)
    v_mfma_f32_16x16x32_bf16 v[40:43], v[68:71], v[96:99], v[40:43]
    v_mfma_f32_16x16x32_bf16 v[44:47], v[68:71], v[100:103], v[44:47]
    v_mfma_f32_16x16x32_bf16 v[48:51], v[72:75], v[96:99], v[48:51]
    v_mfma_f32_16x16x32_bf16 v[52:55], v[72:75], v[100:103], v[52:55]
    v_mfma_f32_16x16x32_bf16 v[32:35], v[64:67], v[96:99], v[32:35]
    v_mfma_f32_16x16x32_bf16 v[36:39], v[64:67], v[100:103], v[36:39]
    s_waitcnt vmcnt(0) lgkmcnt(0)
    v_mfma_f32_16x16x32_bf16 v[40:43], v[88:91], v[104:107], v[40:43]
    v_mfma_f32_16x16x32_bf16 v[44:47], v[88:91], v[108:111], v[44:47]
    v_mfma_f32_16x16x32_bf16 v[48:51], v[92:95], v[104:107], v[48:51]
    v_mfma_f32_16x16x32_bf16 v[52:55], v[92:95], v[108:111], v[52:55]
    v_mfma_f32_16x16x32_bf16 v[32:35], v[84:87], v[104:107], v[32:35]
    v_mfma_f32_16x16x32_bf16 v[36:39], v[84:87], v[108:111], v[36:39]
    v_mfma_f32_16x16x32_bf16 v[16:19], v[56:59], v[96:99], v[16:19]
    v_mfma_f32_16x16x32_bf16 v[20:23], v[56:59], v[100:103], v[20:23]
    v_mfma_f32_16x16x32_bf16 v[24:27], v[60:63], v[96:99], v[24:27]
    v_mfma_f32_16x16x32_bf16 v[28:31], v[60:63], v[100:103], v[28:31]
    ds_write_b128 v14, v[40:43] offset:2048
    v_mfma_f32_16x16x32_bf16 v[16:19], v[76:79], v[104:107], v[16:19]
    ds_write_b128 v14, v[44:47] offset:3072
    v_mfma_f32_16x16x32_bf16 v[20:23], v[76:79], v[108:111], v[20:23]
    ds_write_b128 v14, v[48:51] offset:4096
    v_mfma_f32_16x16x32_bf16 v[24:27], v[80:83], v[104:107], v[24:27]
    ds_write_b128 v14, v[52:55] offset:5120
    v_mfma_f32_16x16x32_bf16 v[28:31], v[80:83], v[108:111], v[28:31]
    s_cmp_eq_u32 s44, 0
    s_cbranch_scc1 L_op_x
    ds_write_b128 v14, v[32:35] offset:0
    ds_write_b128 v14, v[36:39] offset:1024
L_op_x:
    s_waitcnt lgkmcnt(0)
    s_barrier
    ds_read_b128 v[56:59], v15 offset:0
    ds_read_b128 v[60:63], v15 offset:1024
    ds_read_b128 v[64:67], v15 offset:2048
    ds_read_b128 v[68:71], v15 offset:3072
    ds_read_b128 v[72:75], v15 offset:4096
    ds_read_b128 v[76:79], v15 offset:5120
    s_waitcnt lgkmcnt(4)
    v_pk_add_f32 v[16:17], v[16:17], v[56:57]
    v_pk_add_f32 v[18:19], v[18:19], v[58:59]
    v_pk_add_f32 v[20:21], v[20:21], v[60:61]
    v_pk_add_f32 v[22:23], v[22:23], v[62:63]
    v_pk_fma_f32 v[192:193], v[16:17], v[160:161], v[192:193]
    v_pk_fma_f32 v[194:195], v[18:19], v[162:163], v[194:195]
    v_pk_fma_f32 v[196:197], v[20:21], v[160:161], v[196:197]
    v_pk_fma_f32 v[198:199], v[22:23], v[162:163], v[198:199]
    v_pk_mul_f32 v[16:17], v[192:193], v[172:173]
    v_pk_mul_f32 v[18:19], v[194:195], v[174:175]
    v_pk_mul_f32 v[20:21], v[196:197], v[172:173]
    v_pk_mul_f32 v[22:23], v[198:199], v[174:175]
    v_cvt_pk_bf16_f32 v104, v16, v17
    v_cvt_pk_bf16_f32 v105, v18, v19
    v_cvt_pk_bf16_f32 v106, v20, v21
    v_cvt_pk_bf16_f32 v107, v22, v23
    s_nop 0
    v_permlane16_swap_b32 v104, v106
    v_permlane16_swap_b32 v105, v107
    buffer_store_dwordx4 v[104:107], v2, s[20:23], s50 offen sc0 sc1
    s_waitcnt lgkmcnt(2)
    v_pk_add_f32 v[24:25], v[24:25], v[64:65]
    v_pk_add_f32 v[26:27], v[26:27], v[66:67]
    v_pk_add_f32 v[28:29], v[28:29], v[68:69]
    v_pk_add_f32 v[30:31], v[30:31], v[70:71]
    v_pk_fma_f32 v[200:201], v[24:25], v[164:165], v[200:201]
    v_pk_fma_f32 v[202:203], v[26:27], v[166:167], v[202:203]
    v_pk_fma_f32 v[204:205], v[28:29], v[164:165], v[204:205]
    v_pk_fma_f32 v[206:207], v[30:31], v[166:167], v[206:207]
    v_pk_mul_f32 v[24:25], v[200:201], v[176:177]
    v_pk_mul_f32 v[26:27], v[202:203], v[178:179]
    v_pk_mul_f32 v[28:29], v[204:205], v[176:177]
    v_pk_mul_f32 v[30:31], v[206:207], v[178:179]
    v_cvt_pk_bf16_f32 v108, v24, v25
    v_cvt_pk_bf16_f32 v109, v26, v27
    v_cvt_pk_bf16_f32 v110, v28, v29
    v_cvt_pk_bf16_f32 v111, v30, v31
    s_nop 0
    v_permlane16_swap_b32 v108, v110
    v_permlane16_swap_b32 v109, v111
    buffer_store_dwordx4 v[108:111], v2, s[20:23], s51 offen sc0 sc1
    s_cmp_eq_u32 s44, 1
    s_cbranch_scc1 L_op_two
    s_waitcnt lgkmcnt(0)
    v_pk_add_f32 v[32:33], v[32:33], v[72:73]
    v_pk_add_f32 v[34:35], v[34:35], v[74:75]
    v_pk_add_f32 v[36:37], v[36:37], v[76:77]
    v_pk_add_f32 v[38:39], v[38:39], v[78:79]
    v_pk_fma_f32 v[208:209], v[32:33], v[168:169], v[208:209]
    v_pk_fma_f32 v[210:211], v[34:35], v[170:171], v[210:211]
    v_pk_fma_f32 v[212:213], v[36:37], v[168:169], v[212:213]
    v_pk_fma_f32 v[214:215], v[38:39], v[170:171], v[214:215]
    v_pk_mul_f32 v[32:33], v[208:209], v[180:181]
    v_pk_mul_f32 v[34:35], v[210:211], v[182:183]
    v_pk_mul_f32 v[36:37], v[212:213], v[180:181]
    v_pk_mul_f32 v[38:39], v[214:215], v[182:183]
    v_cvt_pk_bf16_f32 v112, v32, v33
    v_cvt_pk_bf16_f32 v113, v34, v35
    v_cvt_pk_bf16_f32 v114, v36, v37
    v_cvt_pk_bf16_f32 v115, v38, v39
    s_nop 0
    v_permlane16_swap_b32 v112, v114
    v_permlane16_swap_b32 v113, v115
    buffer_store_dwordx4 v[112:115], v2, s[20:23], s52 offen sc0 sc1
    v_pk_add_f32 v[96:97], v[208:209], v[210:211]
    v_pk_mul_f32 v[100:101], v[208:209], v[208:209]
    v_pk_fma_f32 v[100:101], v[210:211], v[210:211], v[100:101]
    v_pk_add_f32 v[98:99], v[212:213], v[214:215]
    v_pk_mul_f32 v[102:103], v[212:213], v[212:213]
    v_pk_fma_f32 v[102:103], v[214:215], v[214:215], v[102:103]
    v_pk_add_f32 v[96:97], v[96:97], v[192:193]
    v_pk_fma_f32 v[100:101], v[192:193], v[192:193], v[100:101]
    v_pk_add_f32 v[96:97], v[96:97], v[194:195]
    v_pk_fma_f32 v[100:101], v[194:195], v[194:195], v[100:101]
    v_pk_add_f32 v[98:99], v[98:99], v[196:197]
    v_pk_fma_f32 v[102:103], v[196:197], v[196:197], v[102:103]
    v_pk_add_f32 v[98:99], v[98:99], v[198:199]
    v_pk_fma_f32 v[102:103], v[198:199], v[198:199], v[102:103]
    s_branch L_op_st
L_op_two:
    v_pk_add_f32 v[96:97], v[192:193], v[194:195]
    v_pk_mul_f32 v[100:101], v[192:193], v[192:193]
    v_pk_fma_f32 v[100:101], v[194:195], v[194:195], v[100:101]
    v_pk_add_f32 v[98:99], v[196:197], v[198:199]
    v_pk_mul_f32 v[102:103], v[196:197], v[196:197]
    v_pk_fma_f32 v[102:103], v[198:199], v[198:199], v[102:103]
L_op_st:
    v_pk_add_f32 v[96:97], v[96:97], v[200:201]
    v_pk_fma_f32 v[100:101], v[200:201], v[200:201], v[100:101]
    v_pk_add_f32 v[96:97], v[96:97], v[202:203]
    v_pk_fma_f32 v[100:101], v[202:203], v[202:203], v[100:101]
    v_pk_add_f32 v[98:99], v[98:99], v[204:205]
    v_pk_fma_f32 v[102:103], v[204:205], v[204:205], v[102:103]
    v_pk_add_f32 v[98:99], v[98:99], v[206:207]
    v_pk_fma_f32 v[102:103], v[206:207], v[206:207], v[102:103]
    v_add_f32 v8, v96, v97
    v_add_f32 v10, v98, v99
    v_add_f32 v9, v100, v101
    v_add_f32 v11, v102, v103
    v_permlane16_swap_b32 v8, v10
    s_waitcnt lgkmcnt(0)
    v_permlane16_swap_b32 v9, v11
    v_pk_add_f32 v[8:9], v[8:9], v[10:11]
    v_mov_b64 v[10:11], v[8:9]
    s_nop 1
    v_permlane32_swap_b32 v8, v10
    v_permlane32_swap_b32 v9, v11
    v_pk_add_f32 v[8:9], v[8:9], v[10:11]
    s_mov_b32 exec_hi, 0
    buffer_store_dwordx2 v[8:9], v3, s[20:23], s56 offen sc0 sc1
    s_mov_b32 exec_hi, -1
    s_lshl_b32 s52, s41, 3
    s_add_u32 s52, s52, s42
    s_lshr_b32 s58, s52, 4
    s_and_b32 s60, s58, 3
    s_lshl_b32 s60, s60, 11
    s_and_b32 s59, s58, 4
    s_lshl_b32 s59, s59, 12
    s_add_u32 s60, s60, s59
    s_and_b32 s59, s58, 8
    s_lshl_b32 s59, s59, 10
    s_add_u32 s60, s60, s59
    s_xor_b32 s60, s60, s99
    s_add_u32 s60, s60, 29425664
    s_and_b32 s59, s52, 15
    s_lshl_b32 s59, s59, 7
    s_add_u32 s60, s60, s59
    v_lshl_add_u32 v249, v1, 2, s60
    s_bfe_u32 s41, s2, 0x20001
    s_lshl_b32 s41, s41, 2
    s_bfe_u32 s44, s2, 0x20003
    s_add_u32 s41, s41, s44
    s_and_b32 s42, s2, 1
    s_mul_i32 s42, s42, 7
    s_lshr_b32 s44, s2, 5
    s_and_b32 s43, s41, 7
    s_min_u32 s43, s43, 6
    s_cmp_eq_u32 s44, 7
    s_cselect_b32 s44, s43, s44
    s_add_u32 s42, s42, s44
    s_mov_b32 s43, 3456
    s_lshl_b32 s46, s42, 8
    s_mov_b32 s8, s32
    s_mov_b32 s9, s33
    s_mov_b32 s10, 2211840
    s_mov_b32 s11, 0x20000
    s_and_b32 s60, s41, 3
    s_lshl_b32 s60, s60, 11
    s_and_b32 s59, s41, 4
    s_lshl_b32 s59, s59, 12
    s_add_u32 s60, s60, s59
    s_and_b32 s59, s41, 8
    s_lshl_b32 s59, s59, 10
    s_add_u32 s60, s60, s59
    s_xor_b32 s60, s60, s99
    s_add_u32 s60, s60, 29425664
    v_min_u32 v250, 15, v1
    v_lshl_add_u32 v250, v250, 7, s60
    v_bfe_u32 v10, v1, 2, 2
    v_lshrrev_b32 v11, 5, v1
    v_lshl_add_u32 v11, v11, 3, v10
    v_lshlrev_b32 v11, 8, v11
    v_bfe_u32 v12, v1, 4, 1
    v_lshl_add_u32 v11, v12, 5, v11
    v_and_b32 v12, 3, v1
    v_lshl_add_u32 v11, v12, 3, v11
    v_xor_b32 v12, 0, v10
    v_lshl_add_u32 v4, v12, 6, v11
    v_xor_b32 v12, 1, v10
    v_lshl_add_u32 v5, v12, 6, v11
    v_xor_b32 v12, 2, v10
    v_lshl_add_u32 v6, v12, 6, v11
    v_xor_b32 v12, 3, v10
    v_lshl_add_u32 v7, v12, 6, v11
    s_waitcnt vmcnt(0)
    s_barrier
    s_cmp_eq_u32 s40, 0
    s_cbranch_scc0 L_ho_op_a
    s_mov_b32 exec_hi, 0
    buffer_store_dword v248, v249, s[20:23], 0 offen sc0 sc1
    s_mov_b64 exec, -1
L_ho_op_a:
    s_and_b32 s52, s48, 3
    s_lshl_b32 s52, s52, 8
    s_add_u32 s52, s52, 133120
    v_lshl_add_u32 v15, v1, 2, s52
    s_lshl_b32 s52, s40, 9
    s_add_u32 s52, s52, 131072
    v_lshl_add_u32 v13, v1, 3, s52
    v_lshlrev_b32 v14, 5, v1
    v_add_u32 v14, 134144, v14
    s_lshl_b32 s63, s41, 2
    s_add_u32 s63, s63, s40
    s_and_b32 s53, s63, 15
    s_mul_i32 s53, s53, 81920
    s_bfe_u32 s60, s63, 65540
    s_lshl_b32 s60, s60, 21
    s_add_u32 s53, s53, s60
    s_lshl_b32 s60, s63, 1
    s_xor_b32 s60, s60, s63
    s_and_b32 s60, s60, 32
    s_lshl_b32 s60, s60, 8
    s_xor_b32 s60, s60, s99
    s_add_u32 s53, s53, s60
    s_add_u32 s53, s53, 37748736
    s_and_b32 s55, s63, 7
    s_mul_i32 s55, s55, 229376
    s_bfe_u32 s60, s63, 131075
    s_lshl_b32 s60, s60, 21
    s_add_u32 s55, s55, s60
    s_lshl_b32 s60, s63, 2
    s_xor_b32 s60, s60, s63
    s_and_b32 s60, s60, 32
    s_lshl_b32 s60, s60, 8
    s_xor_b32 s60, s60, s99
    s_add_u32 s55, s55, s60
    s_add_u32 s55, s55, 46137344
    v_lshlrev_b32 v9, 4, v1
    s_lshl_b32 s56, s42, 14
    s_add_u32 s55, s55, s56
    s_add_u32 s56, s55, 4096
    s_cmp_eq_u32 s42, 13
    s_cselect_b32 s54, 0x40000000, 0
    v_or_b32 v8, s54, v9
    s_cmp_ge_u32 s2, 224
    s_cselect_b32 s62, s40, 0
    s_cmp_eq_u32 s62, 0
    s_cbranch_scc0 L_vec
L_vec_done:
    s_cmp_eq_u32 s40, 0
    s_cbranch_scc0 L_ho_op_done
    s_mov_b32 s62, 0
    s_waitcnt vmcnt(0)
L_ho_op:
    buffer_load_dword v251, v250, s[20:23], 0 offen sc0 sc1
    s_add_u32 s62, s62, 1
    s_waitcnt vmcnt(0)
L_ho_op_chk:
    v_cmp_ne_u32 vcc, s3, v251
    s_cmp_gt_u32 s62, 400000
    s_cbranch_scc1 L_ho_op_done
    s_cbranch_vccz L_ho_op_done
    s_branch L_ho_op
L_ho_op_done:
    s_barrier
    s_cmp_lt_u32 s2, 224
    s_cbranch_scc0 L_f1_skip
    buffer_load_dwordx4 v[128:131], v9, s[20:23], s53 offen offset:0 sc1
    buffer_load_dwordx4 v[132:135], v9, s[20:23], s53 offen offset:1024 sc1
    v_add_u32 v4, 131072, v4
    ds_read_b64_tr_b16 v[80:81], v4 offset:0
    ds_read_b64_tr_b16 v[82:83], v4 offset:1024
    v_add_u32 v5, 131072, v5
    ds_read_b64_tr_b16 v[84:85], v5 offset:0
    ds_read_b64_tr_b16 v[86:87], v5 offset:1024
    v_add_u32 v6, 131072, v6
    ds_read_b64_tr_b16 v[88:89], v6 offset:0
    ds_read_b64_tr_b16 v[90:91], v6 offset:1024
    v_add_u32 v7, 131072, v7
    ds_read_b64_tr_b16 v[92:93], v7 offset:0
    ds_read_b64_tr_b16 v[94:95], v7 offset:1024
    ds_read_b64_tr_b16 v[96:97], v4 offset:4096
    ds_read_b64_tr_b16 v[98:99], v4 offset:5120
    ds_read_b64_tr_b16 v[100:101], v5 offset:4096
    ds_read_b64_tr_b16 v[102:103], v5 offset:5120
    ds_read_b64_tr_b16 v[104:105], v6 offset:4096
    ds_read_b64_tr_b16 v[106:107], v6 offset:5120
    ds_read_b64_tr_b16 v[108:109], v7 offset:4096
    ds_read_b64_tr_b16 v[110:111], v7 offset:5120
    buffer_load_dwordx4 v[136:139], v9, s[20:23], s53 offen offset:2048 sc1
    buffer_load_dwordx4 v[140:143], v9, s[20:23], s53 offen offset:3072 sc1
    s_add_u32 s53, s53, 4096
    buffer_load_dwordx4 v[144:147], v9, s[20:23], s53 offen offset:0 sc1
    buffer_load_dwordx4 v[148:151], v9, s[20:23], s53 offen offset:1024 sc1
    buffer_load_dwordx4 v[152:155], v9, s[20:23], s53 offen offset:2048 sc1
    buffer_load_dwordx4 v[156:159], v9, s[20:23], s53 offen offset:3072 sc1
    s_waitcnt vmcnt(7) lgkmcnt(8)
    v_mfma_f32_32x32x16_bf16 v[16:31], v[80:83], v[128:131], 0
    ds_read_b64_tr_b16 v[80:81], v4 offset:8192
    ds_read_b64_tr_b16 v[82:83], v4 offset:9216
    v_mfma_f32_32x32x16_bf16 v[32:47], v[84:87], v[128:131], 0
    ds_read_b64_tr_b16 v[84:85], v5 offset:8192
    ds_read_b64_tr_b16 v[86:87], v5 offset:9216
    s_add_u32 s53, s53, 12288
    buffer_load_dwordx4 v[160:163], v9, s[20:23], s53 offen offset:0 sc1
    v_mfma_f32_32x32x16_bf16 v[48:63], v[88:91], v[128:131], 0
    ds_read_b64_tr_b16 v[88:89], v6 offset:8192
    ds_read_b64_tr_b16 v[90:91], v6 offset:9216
    v_mfma_f32_32x32x16_bf16 v[64:79], v[92:95], v[128:131], 0
    ds_read_b64_tr_b16 v[92:93], v7 offset:8192
    ds_read_b64_tr_b16 v[94:95], v7 offset:9216
    buffer_load_dwordx4 v[164:167], v9, s[20:23], s53 offen offset:1024 sc1
    s_waitcnt vmcnt(8) lgkmcnt(8)
    v_mfma_f32_32x32x16_bf16 v[16:31], v[96:99], v[132:135], v[16:31]
    ds_read_b64_tr_b16 v[96:97], v4 offset:12288
    ds_read_b64_tr_b16 v[98:99], v4 offset:13312
    v_mfma_f32_32x32x16_bf16 v[32:47], v[100:103], v[132:135], v[32:47]
    ds_read_b64_tr_b16 v[100:101], v5 offset:12288
    ds_read_b64_tr_b16 v[102:103], v5 offset:13312
    buffer_load_dwordx4 v[168:171], v9, s[20:23], s53 offen offset:2048 sc1
    v_mfma_f32_32x32x16_bf16 v[48:63], v[104:107], v[132:135], v[48:63]
    ds_read_b64_tr_b16 v[104:105], v6 offset:12288
    ds_read_b64_tr_b16 v[106:107], v6 offset:13312
    v_mfma_f32_32x32x16_bf16 v[64:79], v[108:111], v[132:135], v[64:79]
    ds_read_b64_tr_b16 v[108:109], v7 offset:12288
    ds_read_b64_tr_b16 v[110:111], v7 offset:13312
    buffer_load_dwordx4 v[172:175], v9, s[20:23], s53 offen offset:3072 sc1
    s_waitcnt vmcnt(9) lgkmcnt(8)
    v_mfma_f32_32x32x16_bf16 v[16:31], v[80:83], v[136:139], v[16:31]
    ds_read_b64_tr_b16 v[80:81], v4 offset:16384
    ds_read_b64_tr_b16 v[82:83], v4 offset:17408
    v_mfma_f32_32x32x16_bf16 v[32:47], v[84:87], v[136:139], v[32:47]
    ds_read_b64_tr_b16 v[84:85], v5 offset:16384
    ds_read_b64_tr_b16 v[86:87], v5 offset:17408
    s_add_u32 s53, s53, 4096
    buffer_load_dwordx4 v[176:179], v9, s[20:23], s53 offen offset:0 sc1
    v_mfma_f32_32x32x16_bf16 v[48:63], v[88:91], v[136:139], v[48:63]
    ds_read_b64_tr_b16 v[88:89], v6 offset:16384
    ds_read_b64_tr_b16 v[90:91], v6 offset:17408
    v_mfma_f32_32x32x16_bf16 v[64:79], v[92:95], v[136:139], v[64:79]
    ds_read_b64_tr_b16 v[92:93], v7 offset:16384
    ds_read_b64_tr_b16 v[94:95], v7 offset:17408
    buffer_load_dwordx4 v[180:183], v9, s[20:23], s53 offen offset:1024 sc1
    s_waitcnt vmcnt(10) lgkmcnt(8)
    v_mfma_f32_32x32x16_bf16 v[16:31], v[96:99], v[140:143], v[16:31]
    ds_read_b64_tr_b16 v[96:97], v4 offset:20480
    ds_read_b64_tr_b16 v[98:99], v4 offset:21504
    v_mfma_f32_32x32x16_bf16 v[32:47], v[100:103], v[140:143], v[32:47]
    ds_read_b64_tr_b16 v[100:101], v5 offset:20480
    ds_read_b64_tr_b16 v[102:103], v5 offset:21504
    v_mfma_f32_32x32x16_bf16 v[48:63], v[104:107], v[140:143], v[48:63]
    ds_read_b64_tr_b16 v[104:105], v6 offset:20480
    ds_read_b64_tr_b16 v[106:107], v6 offset:21504
    v_mfma_f32_32x32x16_bf16 v[64:79], v[108:111], v[140:143], v[64:79]
    ds_read_b64_tr_b16 v[108:109], v7 offset:20480
    ds_read_b64_tr_b16 v[110:111], v7 offset:21504
    buffer_load_dwordx4 v[184:187], v9, s[20:23], s53 offen offset:2048 sc1
    s_waitcnt vmcnt(10) lgkmcnt(8)
    v_mfma_f32_32x32x16_bf16 v[16:31], v[80:83], v[144:147], v[16:31]
    ds_read_b64_tr_b16 v[80:81], v4 offset:24576
    ds_read_b64_tr_b16 v[82:83], v4 offset:25600
    v_mfma_f32_32x32x16_bf16 v[32:47], v[84:87], v[144:147], v[32:47]
    ds_read_b64_tr_b16 v[84:85], v5 offset:24576
    ds_read_b64_tr_b16 v[86:87], v5 offset:25600
    v_mfma_f32_32x32x16_bf16 v[48:63], v[88:91], v[144:147], v[48:63]
    ds_read_b64_tr_b16 v[88:89], v6 offset:24576
    ds_read_b64_tr_b16 v[90:91], v6 offset:25600
    v_mfma_f32_32x32x16_bf16 v[64:79], v[92:95], v[144:147], v[64:79]
    ds_read_b64_tr_b16 v[92:93], v7 offset:24576
    ds_read_b64_tr_b16 v[94:95], v7 offset:25600
    buffer_load_dwordx4 v[188:191], v9, s[20:23], s53 offen offset:3072 sc1
    s_waitcnt vmcnt(10) lgkmcnt(8)
    s_barrier
    v_mfma_f32_32x32x16_bf16 v[16:31], v[96:99], v[148:151], v[16:31]
    ds_read_b64_tr_b16 v[96:97], v4 offset:28672
    ds_read_b64_tr_b16 v[98:99], v4 offset:29696
    v_mfma_f32_32x32x16_bf16 v[32:47], v[100:103], v[148:151], v[32:47]
    ds_read_b64_tr_b16 v[100:101], v5 offset:28672
    ds_read_b64_tr_b16 v[102:103], v5 offset:29696
    v_mfma_f32_32x32x16_bf16 v[48:63], v[104:107], v[148:151], v[48:63]
    ds_read_b64_tr_b16 v[104:105], v6 offset:28672
    ds_read_b64_tr_b16 v[106:107], v6 offset:29696
    v_mfma_f32_32x32x16_bf16 v[64:79], v[108:111], v[148:151], v[64:79]
    ds_read_b64_tr_b16 v[108:109], v7 offset:28672
    ds_read_b64_tr_b16 v[110:111], v7 offset:29696
    s_add_u32 s53, s53, 12288
    buffer_load_dwordx4 v[128:131], v9, s[20:23], s53 offen offset:0 sc1
    s_waitcnt vmcnt(10) lgkmcnt(8)
    v_mfma_f32_32x32x16_bf16 v[16:31], v[80:83], v[152:155], v[16:31]
    v_subrev_u32 v4, 131072, v4
    ds_read_b64_tr_b16 v[80:81], v4 offset:0
    ds_read_b64_tr_b16 v[82:83], v4 offset:1024
    v_mfma_f32_32x32x16_bf16 v[32:47], v[84:87], v[152:155], v[32:47]
    v_subrev_u32 v5, 131072, v5
    ds_read_b64_tr_b16 v[84:85], v5 offset:0
    ds_read_b64_tr_b16 v[86:87], v5 offset:1024
    v_mfma_f32_32x32x16_bf16 v[48:63], v[88:91], v[152:155], v[48:63]
    v_subrev_u32 v6, 131072, v6
    ds_read_b64_tr_b16 v[88:89], v6 offset:0
    ds_read_b64_tr_b16 v[90:91], v6 offset:1024
    v_mfma_f32_32x32x16_bf16 v[64:79], v[92:95], v[152:155], v[64:79]
    v_subrev_u32 v7, 131072, v7
    ds_read_b64_tr_b16 v[92:93], v7 offset:0
    ds_read_b64_tr_b16 v[94:95], v7 offset:1024
    buffer_load_dwordx4 v[132:135], v9, s[20:23], s53 offen offset:1024 sc1
    s_waitcnt vmcnt(10) lgkmcnt(8)
    v_mfma_f32_32x32x16_bf16 v[16:31], v[96:99], v[156:159], v[16:31]
    ds_read_b64_tr_b16 v[96:97], v4 offset:4096
    ds_read_b64_tr_b16 v[98:99], v4 offset:5120
    v_mfma_f32_32x32x16_bf16 v[32:47], v[100:103], v[156:159], v[32:47]
    ds_read_b64_tr_b16 v[100:101], v5 offset:4096
    ds_read_b64_tr_b16 v[102:103], v5 offset:5120
    v_mfma_f32_32x32x16_bf16 v[48:63], v[104:107], v[156:159], v[48:63]
    ds_read_b64_tr_b16 v[104:105], v6 offset:4096
    ds_read_b64_tr_b16 v[106:107], v6 offset:5120
    v_mfma_f32_32x32x16_bf16 v[64:79], v[108:111], v[156:159], v[64:79]
    ds_read_b64_tr_b16 v[108:109], v7 offset:4096
    ds_read_b64_tr_b16 v[110:111], v7 offset:5120
    buffer_load_dwordx4 v[136:139], v9, s[20:23], s53 offen offset:2048 sc1
    s_waitcnt vmcnt(10) lgkmcnt(8)
    v_mfma_f32_32x32x16_bf16 v[16:31], v[80:83], v[160:163], v[16:31]
    ds_read_b64_tr_b16 v[80:81], v4 offset:8192
    ds_read_b64_tr_b16 v[82:83], v4 offset:9216
    v_mfma_f32_32x32x16_bf16 v[32:47], v[84:87], v[160:163], v[32:47]
    ds_read_b64_tr_b16 v[84:85], v5 offset:8192
    ds_read_b64_tr_b16 v[86:87], v5 offset:9216
    v_mfma_f32_32x32x16_bf16 v[48:63], v[88:91], v[160:163], v[48:63]
    ds_read_b64_tr_b16 v[88:89], v6 offset:8192
    ds_read_b64_tr_b16 v[90:91], v6 offset:9216
    v_mfma_f32_32x32x16_bf16 v[64:79], v[92:95], v[160:163], v[64:79]
    ds_read_b64_tr_b16 v[92:93], v7 offset:8192
    ds_read_b64_tr_b16 v[94:95], v7 offset:9216
    buffer_load_dwordx4 v[140:143], v9, s[20:23], s53 offen offset:3072 sc1
    s_waitcnt vmcnt(10) lgkmcnt(8)
    v_mfma_f32_32x32x16_bf16 v[16:31], v[96:99], v[164:167], v[16:31]
    ds_read_b64_tr_b16 v[96:97], v4 offset:12288
    ds_read_b64_tr_b16 v[98:99], v4 offset:13312
    v_mfma_f32_32x32x16_bf16 v[32:47], v[100:103], v[164:167], v[32:47]
    ds_read_b64_tr_b16 v[100:101], v5 offset:12288
    ds_read_b64_tr_b16 v[102:103], v5 offset:13312
    v_mfma_f32_32x32x16_bf16 v[48:63], v[104:107], v[164:167], v[48:63]
    ds_read_b64_tr_b16 v[104:105], v6 offset:12288
    ds_read_b64_tr_b16 v[106:107], v6 offset:13312
    v_mfma_f32_32x32x16_bf16 v[64:79], v[108:111], v[164:167], v[64:79]
    ds_read_b64_tr_b16 v[108:109], v7 offset:12288
    ds_read_b64_tr_b16 v[110:111], v7 offset:13312
    s_add_u32 s53, s53, 4096
    buffer_load_dwordx4 v[144:147], v9, s[20:23], s53 offen offset:0 sc1
    s_waitcnt vmcnt(10) lgkmcnt(8)
    v_mfma_f32_32x32x16_bf16 v[16:31], v[80:83], v[168:171], v[16:31]
    ds_read_b64_tr_b16 v[80:81], v4 offset:16384
    ds_read_b64_tr_b16 v[82:83], v4 offset:17408
    v_mfma_f32_32x32x16_bf16 v[32:47], v[84:87], v[168:171], v[32:47]
    ds_read_b64_tr_b16 v[84:85], v5 offset:16384
    ds_read_b64_tr_b16 v[86:87], v5 offset:17408
    v_mfma_f32_32x32x16_bf16 v[48:63], v[88:91], v[168:171], v[48:63]
    ds_read_b64_tr_b16 v[88:89], v6 offset:16384
    ds_read_b64_tr_b16 v[90:91], v6 offset:17408
    v_mfma_f32_32x32x16_bf16 v[64:79], v[92:95], v[168:171], v[64:79]
    ds_read_b64_tr_b16 v[92:93], v7 offset:16384
    ds_read_b64_tr_b16 v[94:95], v7 offset:17408
    buffer_load_dwordx4 v[148:151], v9, s[20:23], s53 offen offset:1024 sc1
    s_waitcnt vmcnt(10) lgkmcnt(8)
    v_mfma_f32_32x32x16_bf16 v[16:31], v[96:99], v[172:175], v[16:31]
    ds_read_b64_tr_b16 v[96:97], v4 offset:20480
    ds_read_b64_tr_b16 v[98:99], v4 offset:21504
    v_mfma_f32_32x32x16_bf16 v[32:47], v[100:103], v[172:175], v[32:47]
    ds_read_b64_tr_b16 v[100:101], v5 offset:20480
    ds_read_b64_tr_b16 v[102:103], v5 offset:21504
    v_mfma_f32_32x32x16_bf16 v[48:63], v[104:107], v[172:175], v[48:63]
    ds_read_b64_tr_b16 v[104:105], v6 offset:20480
    ds_read_b64_tr_b16 v[106:107], v6 offset:21504
    v_mfma_f32_32x32x16_bf16 v[64:79], v[108:111], v[172:175], v[64:79]
    ds_read_b64_tr_b16 v[108:109], v7 offset:20480
    ds_read_b64_tr_b16 v[110:111], v7 offset:21504
    buffer_load_dwordx4 v[152:155], v9, s[20:23], s53 offen offset:2048 sc1
    s_waitcnt vmcnt(10) lgkmcnt(8)
    v_mfma_f32_32x32x16_bf16 v[16:31], v[80:83], v[176:179], v[16:31]
    ds_read_b64_tr_b16 v[80:81], v4 offset:24576
    ds_read_b64_tr_b16 v[82:83], v4 offset:25600
    v_mfma_f32_32x32x16_bf16 v[32:47], v[84:87], v[176:179], v[32:47]
    ds_read_b64_tr_b16 v[84:85], v5 offset:24576
    ds_read_b64_tr_b16 v[86:87], v5 offset:25600
    v_mfma_f32_32x32x16_bf16 v[48:63], v[88:91], v[176:179], v[48:63]
    ds_read_b64_tr_b16 v[88:89], v6 offset:24576
    ds_read_b64_tr_b16 v[90:91], v6 offset:25600
    v_mfma_f32_32x32x16_bf16 v[64:79], v[92:95], v[176:179], v[64:79]
    ds_read_b64_tr_b16 v[92:93], v7 offset:24576
    ds_read_b64_tr_b16 v[94:95], v7 offset:25600
    buffer_load_dwordx4 v[156:159], v9, s[20:23], s53 offen offset:3072 sc1
    s_waitcnt vmcnt(10) lgkmcnt(8)
    v_mfma_f32_32x32x16_bf16 v[16:31], v[96:99], v[180:183], v[16:31]
    ds_read_b64_tr_b16 v[96:97], v4 offset:28672
    ds_read_b64_tr_b16 v[98:99], v4 offset:29696
    v_mfma_f32_32x32x16_bf16 v[32:47], v[100:103], v[180:183], v[32:47]
    ds_read_b64_tr_b16 v[100:101], v5 offset:28672
    ds_read_b64_tr_b16 v[102:103], v5 offset:29696
    v_mfma_f32_32x32x16_bf16 v[48:63], v[104:107], v[180:183], v[48:63]
    ds_read_b64_tr_b16 v[104:105], v6 offset:28672
    ds_read_b64_tr_b16 v[106:107], v6 offset:29696
    v_mfma_f32_32x32x16_bf16 v[64:79], v[108:111], v[180:183], v[64:79]
    ds_read_b64_tr_b16 v[108:109], v7 offset:28672
    ds_read_b64_tr_b16 v[110:111], v7 offset:29696
    s_add_u32 s53, s53, 12288
    buffer_load_dwordx4 v[160:163], v9, s[20:23], s53 offen offset:0 sc1
    s_waitcnt vmcnt(10) lgkmcnt(8)
    v_mfma_f32_32x32x16_bf16 v[16:31], v[80:83], v[184:187], v[16:31]
    ds_read_b64_tr_b16 v[80:81], v4 offset:32768
    ds_read_b64_tr_b16 v[82:83], v4 offset:33792
    v_mfma_f32_32x32x16_bf16 v[32:47], v[84:87], v[184:187], v[32:47]
    ds_read_b64_tr_b16 v[84:85], v5 offset:32768
    ds_read_b64_tr_b16 v[86:87], v5 offset:33792
    buffer_load_dwordx4 v[164:167], v9, s[20:23], s53 offen offset:1024 sc1
    v_mfma_f32_32x32x16_bf16 v[48:63], v[88:91], v[184:187], v[48:63]
    ds_read_b64_tr_b16 v[88:89], v6 offset:32768
    ds_read_b64_tr_b16 v[90:91], v6 offset:33792
    v_mfma_f32_32x32x16_bf16 v[64:79], v[92:95], v[184:187], v[64:79]
    ds_read_b64_tr_b16 v[92:93], v7 offset:32768
    ds_read_b64_tr_b16 v[94:95], v7 offset:33792
    buffer_load_dwordx4 v[168:171], v9, s[20:23], s53 offen offset:2048 sc1
    s_waitcnt vmcnt(11) lgkmcnt(8)
    v_mfma_f32_32x32x16_bf16 v[16:31], v[96:99], v[188:191], v[16:31]
    ds_read_b64_tr_b16 v[96:97], v4 offset:36864
    ds_read_b64_tr_b16 v[98:99], v4 offset:37888
    v_mfma_f32_32x32x16_bf16 v[32:47], v[100:103], v[188:191], v[32:47]
    ds_read_b64_tr_b16 v[100:101], v5 offset:36864
    ds_read_b64_tr_b16 v[102:103], v5 offset:37888
    buffer_load_dwordx4 v[172:175], v9, s[20:23], s53 offen offset:3072 sc1
    v_mfma_f32_32x32x16_bf16 v[48:63], v[104:107], v[188:191], v[48:63]
    ds_read_b64_tr_b16 v[104:105], v6 offset:36864
    ds_read_b64_tr_b16 v[106:107], v6 offset:37888
    v_mfma_f32_32x32x16_bf16 v[64:79], v[108:111], v[188:191], v[64:79]
    ds_read_b64_tr_b16 v[108:109], v7 offset:36864
    ds_read_b64_tr_b16 v[110:111], v7 offset:37888
    s_add_u32 s53, s53, 4096
    buffer_load_dwordx4 v[176:179], v9, s[20:23], s53 offen offset:0 sc1
    s_waitcnt vmcnt(12) lgkmcnt(8)
    v_mfma_f32_32x32x16_bf16 v[16:31], v[80:83], v[128:131], v[16:31]
    ds_read_b64_tr_b16 v[80:81], v4 offset:40960
    ds_read_b64_tr_b16 v[82:83], v4 offset:41984
    v_mfma_f32_32x32x16_bf16 v[32:47], v[84:87], v[128:131], v[32:47]
    ds_read_b64_tr_b16 v[84:85], v5 offset:40960
    ds_read_b64_tr_b16 v[86:87], v5 offset:41984
    buffer_load_dwordx4 v[180:183], v9, s[20:23], s53 offen offset:1024 sc1
    v_mfma_f32_32x32x16_bf16 v[48:63], v[88:91], v[128:131], v[48:63]
    ds_read_b64_tr_b16 v[88:89], v6 offset:40960
    ds_read_b64_tr_b16 v[90:91], v6 offset:41984
    v_mfma_f32_32x32x16_bf16 v[64:79], v[92:95], v[128:131], v[64:79]
    ds_read_b64_tr_b16 v[92:93], v7 offset:40960
    ds_read_b64_tr_b16 v[94:95], v7 offset:41984
    buffer_load_dwordx4 v[184:187], v9, s[20:23], s53 offen offset:2048 sc1
    s_waitcnt vmcnt(13) lgkmcnt(8)
    v_mfma_f32_32x32x16_bf16 v[16:31], v[96:99], v[132:135], v[16:31]
    ds_read_b64_tr_b16 v[96:97], v4 offset:45056
    ds_read_b64_tr_b16 v[98:99], v4 offset:46080
    v_mfma_f32_32x32x16_bf16 v[32:47], v[100:103], v[132:135], v[32:47]
    ds_read_b64_tr_b16 v[100:101], v5 offset:45056
    ds_read_b64_tr_b16 v[102:103], v5 offset:46080
    buffer_load_dwordx4 v[188:191], v9, s[20:23], s53 offen offset:3072 sc1
    v_mfma_f32_32x32x16_bf16 v[48:63], v[104:107], v[132:135], v[48:63]
    ds_read_b64_tr_b16 v[104:105], v6 offset:45056
    ds_read_b64_tr_b16 v[106:107], v6 offset:46080
    v_mfma_f32_32x32x16_bf16 v[64:79], v[108:111], v[132:135], v[64:79]
    ds_read_b64_tr_b16 v[108:109], v7 offset:45056
    ds_read_b64_tr_b16 v[110:111], v7 offset:46080
    s_add_u32 s53, s53, 12288
    buffer_load_dwordx4 v[128:131], v9, s[20:23], s53 offen offset:0 sc1
    s_waitcnt vmcnt(14) lgkmcnt(8)
    v_mfma_f32_32x32x16_bf16 v[16:31], v[80:83], v[136:139], v[16:31]
    ds_read_b64_tr_b16 v[80:81], v4 offset:49152
    ds_read_b64_tr_b16 v[82:83], v4 offset:50176
    v_mfma_f32_32x32x16_bf16 v[32:47], v[84:87], v[136:139], v[32:47]
    ds_read_b64_tr_b16 v[84:85], v5 offset:49152
    ds_read_b64_tr_b16 v[86:87], v5 offset:50176
    v_mfma_f32_32x32x16_bf16 v[48:63], v[88:91], v[136:139], v[48:63]
    ds_read_b64_tr_b16 v[88:89], v6 offset:49152
    ds_read_b64_tr_b16 v[90:91], v6 offset:50176
    v_mfma_f32_32x32x16_bf16 v[64:79], v[92:95], v[136:139], v[64:79]
    ds_read_b64_tr_b16 v[92:93], v7 offset:49152
    ds_read_b64_tr_b16 v[94:95], v7 offset:50176
    buffer_load_dwordx4 v[132:135], v9, s[20:23], s53 offen offset:1024 sc1
    s_waitcnt vmcnt(14) lgkmcnt(8)
    v_mfma_f32_32x32x16_bf16 v[16:31], v[96:99], v[140:143], v[16:31]
    ds_read_b64_tr_b16 v[96:97], v4 offset:53248
    ds_read_b64_tr_b16 v[98:99], v4 offset:54272
    v_mfma_f32_32x32x16_bf16 v[32:47], v[100:103], v[140:143], v[32:47]
    ds_read_b64_tr_b16 v[100:101], v5 offset:53248
    ds_read_b64_tr_b16 v[102:103], v5 offset:54272
    v_mfma_f32_32x32x16_bf16 v[48:63], v[104:107], v[140:143], v[48:63]
    ds_read_b64_tr_b16 v[104:105], v6 offset:53248
    ds_read_b64_tr_b16 v[106:107], v6 offset:54272
    v_mfma_f32_32x32x16_bf16 v[64:79], v[108:111], v[140:143], v[64:79]
    ds_read_b64_tr_b16 v[108:109], v7 offset:53248
    ds_read_b64_tr_b16 v[110:111], v7 offset:54272
    buffer_load_dwordx4 v[136:139], v9, s[20:23], s53 offen offset:2048 sc1
    s_waitcnt vmcnt(14) lgkmcnt(8)
    v_mfma_f32_32x32x16_bf16 v[16:31], v[80:83], v[144:147], v[16:31]
    ds_read_b64_tr_b16 v[80:81], v4 offset:57344
    ds_read_b64_tr_b16 v[82:83], v4 offset:58368
    v_mfma_f32_32x32x16_bf16 v[32:47], v[84:87], v[144:147], v[32:47]
    ds_read_b64_tr_b16 v[84:85], v5 offset:57344
    ds_read_b64_tr_b16 v[86:87], v5 offset:58368
    v_mfma_f32_32x32x16_bf16 v[48:63], v[88:91], v[144:147], v[48:63]
    ds_read_b64_tr_b16 v[88:89], v6 offset:57344
    ds_read_b64_tr_b16 v[90:91], v6 offset:58368
    v_mfma_f32_32x32x16_bf16 v[64:79], v[92:95], v[144:147], v[64:79]
    ds_read_b64_tr_b16 v[92:93], v7 offset:57344
    ds_read_b64_tr_b16 v[94:95], v7 offset:58368
    buffer_load_dwordx4 v[140:143], v9, s[20:23], s53 offen offset:3072 sc1
    s_waitcnt vmcnt(14) lgkmcnt(8)
    v_mfma_f32_32x32x16_bf16 v[16:31], v[96:99], v[148:151], v[16:31]
    ds_read_b64_tr_b16 v[96:97], v4 offset:61440
    ds_read_b64_tr_b16 v[98:99], v4 offset:62464
    v_mfma_f32_32x32x16_bf16 v[32:47], v[100:103], v[148:151], v[32:47]
    ds_read_b64_tr_b16 v[100:101], v5 offset:61440
    ds_read_b64_tr_b16 v[102:103], v5 offset:62464
    v_mfma_f32_32x32x16_bf16 v[48:63], v[104:107], v[148:151], v[48:63]
    ds_read_b64_tr_b16 v[104:105], v6 offset:61440
    ds_read_b64_tr_b16 v[106:107], v6 offset:62464
    v_mfma_f32_32x32x16_bf16 v[64:79], v[108:111], v[148:151], v[64:79]
    ds_read_b64_tr_b16 v[108:109], v7 offset:61440
    ds_read_b64_tr_b16 v[110:111], v7 offset:62464
    s_add_u32 s53, s53, 4096
    buffer_load_dwordx4 v[144:147], v9, s[20:23], s53 offen offset:0 sc1
    s_waitcnt vmcnt(14) lgkmcnt(8)
    v_mfma_f32_32x32x16_bf16 v[16:31], v[80:83], v[152:155], v[16:31]
    v_add_u32 v4, 65536, v4
    ds_read_b64_tr_b16 v[80:81], v4 offset:0
    ds_read_b64_tr_b16 v[82:83], v4 offset:1024
    v_mfma_f32_32x32x16_bf16 v[32:47], v[84:87], v[152:155], v[32:47]
    v_add_u32 v5, 65536, v5
    ds_read_b64_tr_b16 v[84:85], v5 offset:0
    ds_read_b64_tr_b16 v[86:87], v5 offset:1024
    v_mfma_f32_32x32x16_bf16 v[48:63], v[88:91], v[152:155], v[48:63]
    v_add_u32 v6, 65536, v6
    ds_read_b64_tr_b16 v[88:89], v6 offset:0
    ds_read_b64_tr_b16 v[90:91], v6 offset:1024
    v_mfma_f32_32x32x16_bf16 v[64:79], v[92:95], v[152:155], v[64:79]
    v_add_u32 v7, 65536, v7
    ds_read_b64_tr_b16 v[92:93], v7 offset:0
    ds_read_b64_tr_b16 v[94:95], v7 offset:1024
    buffer_load_dwordx4 v[148:151], v9, s[20:23], s53 offen offset:1024 sc1
    s_waitcnt vmcnt(14) lgkmcnt(8)
    v_mfma_f32_32x32x16_bf16 v[16:31], v[96:99], v[156:159], v[16:31]
    ds_read_b64_tr_b16 v[96:97], v4 offset:4096
    ds_read_b64_tr_b16 v[98:99], v4 offset:5120
    v_mfma_f32_32x32x16_bf16 v[32:47], v[100:103], v[156:159], v[32:47]
    ds_read_b64_tr_b16 v[100:101], v5 offset:4096
    ds_read_b64_tr_b16 v[102:103], v5 offset:5120
    v_mfma_f32_32x32x16_bf16 v[48:63], v[104:107], v[156:159], v[48:63]
    ds_read_b64_tr_b16 v[104:105], v6 offset:4096
    ds_read_b64_tr_b16 v[106:107], v6 offset:5120
    v_mfma_f32_32x32x16_bf16 v[64:79], v[108:111], v[156:159], v[64:79]
    ds_read_b64_tr_b16 v[108:109], v7 offset:4096
    ds_read_b64_tr_b16 v[110:111], v7 offset:5120
    buffer_load_dwordx4 v[152:155], v9, s[20:23], s53 offen offset:2048 sc1
    s_waitcnt vmcnt(14) lgkmcnt(8)
    v_mfma_f32_32x32x16_bf16 v[16:31], v[80:83], v[160:163], v[16:31]
    ds_read_b64_tr_b16 v[80:81], v4 offset:8192
    ds_read_b64_tr_b16 v[82:83], v4 offset:9216
    v_mfma_f32_32x32x16_bf16 v[32:47], v[84:87], v[160:163], v[32:47]
    ds_read_b64_tr_b16 v[84:85], v5 offset:8192
    ds_read_b64_tr_b16 v[86:87], v5 offset:9216
    v_mfma_f32_32x32x16_bf16 v[48:63], v[88:91], v[160:163], v[48:63]
    ds_read_b64_tr_b16 v[88:89], v6 offset:8192
    ds_read_b64_tr_b16 v[90:91], v6 offset:9216
    v_mfma_f32_32x32x16_bf16 v[64:79], v[92:95], v[160:163], v[64:79]
    ds_read_b64_tr_b16 v[92:93], v7 offset:8192
    ds_read_b64_tr_b16 v[94:95], v7 offset:9216
    buffer_load_dwordx4 v[156:159], v9, s[20:23], s53 offen offset:3072 sc1
    s_waitcnt vmcnt(14) lgkmcnt(8)
    v_mfma_f32_32x32x16_bf16 v[16:31], v[96:99], v[164:167], v[16:31]
    ds_read_b64_tr_b16 v[96:97], v4 offset:12288
    ds_read_b64_tr_b16 v[98:99], v4 offset:13312
    v_mfma_f32_32x32x16_bf16 v[32:47], v[100:103], v[164:167], v[32:47]
    ds_read_b64_tr_b16 v[100:101], v5 offset:12288
    ds_read_b64_tr_b16 v[102:103], v5 offset:13312
    v_mfma_f32_32x32x16_bf16 v[48:63], v[104:107], v[164:167], v[48:63]
    ds_read_b64_tr_b16 v[104:105], v6 offset:12288
    ds_read_b64_tr_b16 v[106:107], v6 offset:13312
    v_mfma_f32_32x32x16_bf16 v[64:79], v[108:111], v[164:167], v[64:79]
    ds_read_b64_tr_b16 v[108:109], v7 offset:12288
    ds_read_b64_tr_b16 v[110:111], v7 offset:13312
    s_waitcnt vmcnt(13) lgkmcnt(8)
    s_barrier
    v_mfma_f32_32x32x16_bf16 v[16:31], v[80:83], v[168:171], v[16:31]
    ds_read_b64_tr_b16 v[80:81], v4 offset:16384
    ds_read_b64_tr_b16 v[82:83], v4 offset:17408
    v_mfma_f32_32x32x16_bf16 v[32:47], v[84:87], v[168:171], v[32:47]
    ds_read_b64_tr_b16 v[84:85], v4 offset:20480
    ds_read_b64_tr_b16 v[86:87], v4 offset:21504
    ds_read_b64 v[124:125], v13
    v_mfma_f32_32x32x16_bf16 v[48:63], v[88:91], v[168:171], v[48:63]
    ds_read_b64_tr_b16 v[88:89], v4 offset:24576
    ds_read_b64_tr_b16 v[90:91], v4 offset:25600
    v_mfma_f32_32x32x16_bf16 v[64:79], v[92:95], v[168:171], v[64:79]
    ds_read_b64_tr_b16 v[92:93], v4 offset:28672
    ds_read_b64_tr_b16 v[94:95], v4 offset:29696
    ds_read_b128 v[112:115], v14
    s_waitcnt vmcnt(12) lgkmcnt(10)
    v_mfma_f32_32x32x16_bf16 v[16:31], v[96:99], v[172:175], v[16:31]
    ds_read_b64_tr_b16 v[96:97], v4 offset:32768
    ds_read_b64_tr_b16 v[98:99], v4 offset:33792
    v_mfma_f32_32x32x16_bf16 v[32:47], v[100:103], v[172:175], v[32:47]
    ds_read_b64_tr_b16 v[100:101], v4 offset:36864
    ds_read_b64_tr_b16 v[102:103], v4 offset:37888
    ds_read_b128 v[116:119], v14 offset:16
    v_mfma_f32_32x32x16_bf16 v[48:63], v[104:107], v[172:175], v[48:63]
    ds_read_b64_tr_b16 v[104:105], v5 offset:16384
    ds_read_b64_tr_b16 v[106:107], v5 offset:17408
    v_mfma_f32_32x32x16_bf16 v[64:79], v[108:111], v[172:175], v[64:79]
    ds_read_b64_tr_b16 v[108:109], v5 offset:20480
    ds_read_b64_tr_b16 v[110:111], v5 offset:21504
    ds_read_b32 v120, v15
    s_waitcnt vmcnt(8) lgkmcnt(11)
    v_mfma_f32_32x32x16_bf16 v[16:31], v[80:83], v[176:179], v[16:31]
    ds_read_b64_tr_b16 v[80:81], v5 offset:24576
    ds_read_b64_tr_b16 v[82:83], v5 offset:25600
    v_mfma_f32_32x32x16_bf16 v[16:31], v[84:87], v[180:183], v[16:31]
    ds_read_b64_tr_b16 v[84:85], v5 offset:28672
    ds_read_b64_tr_b16 v[86:87], v5 offset:29696
    v_mfma_f32_32x32x16_bf16 v[16:31], v[88:91], v[184:187], v[16:31]
    ds_read_b64_tr_b16 v[88:89], v5 offset:32768
    ds_read_b64_tr_b16 v[90:91], v5 offset:33792
    v_mfma_f32_32x32x16_bf16 v[16:31], v[92:95], v[188:191], v[16:31]
    ds_read_b64_tr_b16 v[92:93], v5 offset:36864
    ds_read_b64_tr_b16 v[94:95], v5 offset:37888
    s_waitcnt vmcnt(6) lgkmcnt(9)
    v_mfma_f32_32x32x16_bf16 v[16:31], v[96:99], v[128:131], v[16:31]
    ds_read_b64_tr_b16 v[96:97], v4 offset:40960
    ds_read_b64_tr_b16 v[98:99], v4 offset:41984
    v_mfma_f32_32x32x16_bf16 v[16:31], v[100:103], v[132:135], v[16:31]
    ds_read_b64_tr_b16 v[100:101], v4 offset:45056
    ds_read_b64_tr_b16 v[102:103], v4 offset:46080
    v_mfma_f32_32x32x16_bf16 v[32:47], v[104:107], v[176:179], v[32:47]
    ds_read_b64_tr_b16 v[104:105], v4 offset:49152
    ds_read_b64_tr_b16 v[106:107], v4 offset:50176
    v_mfma_f32_32x32x16_bf16 v[32:47], v[108:111], v[180:183], v[32:47]
    ds_read_b64_tr_b16 v[108:109], v4 offset:53248
    ds_read_b64_tr_b16 v[110:111], v4 offset:54272
    s_waitcnt lgkmcnt(8)
    v_mfma_f32_32x32x16_bf16 v[32:47], v[80:83], v[184:187], v[32:47]
    ds_read_b64_tr_b16 v[80:81], v4 offset:57344
    ds_read_b64_tr_b16 v[82:83], v4 offset:58368
    v_mfma_f32_32x32x16_bf16 v[32:47], v[84:87], v[188:191], v[32:47]
    ds_read_b64_tr_b16 v[84:85], v4 offset:61440
    ds_read_b64_tr_b16 v[86:87], v4 offset:62464
    v_mfma_f32_32x32x16_bf16 v[32:47], v[88:91], v[128:131], v[32:47]
    ds_read_b64_tr_b16 v[88:89], v5 offset:40960
    ds_read_b64_tr_b16 v[90:91], v5 offset:41984
    v_mfma_f32_32x32x16_bf16 v[32:47], v[92:95], v[132:135], v[32:47]
    ds_read_b64_tr_b16 v[92:93], v5 offset:45056
    ds_read_b64_tr_b16 v[94:95], v5 offset:46080
    s_waitcnt vmcnt(2) lgkmcnt(8)
    v_mfma_f32_32x32x16_bf16 v[16:31], v[96:99], v[136:139], v[16:31]
    ds_read_b64_tr_b16 v[96:97], v5 offset:49152
    ds_read_b64_tr_b16 v[98:99], v5 offset:50176
    v_mfma_f32_32x32x8_bf16 v[48:63], v[116:117], v[124:125], v[48:63]
    v_mfma_f32_32x32x16_bf16 v[16:31], v[100:103], v[140:143], v[16:31]
    ds_read_b64_tr_b16 v[100:101], v5 offset:53248
    ds_read_b64_tr_b16 v[102:103], v5 offset:54272
    v_mfma_f32_32x32x8_bf16 v[64:79], v[118:119], v[124:125], v[64:79]
    v_mfma_f32_32x32x16_bf16 v[16:31], v[104:107], v[144:147], v[16:31]
    ds_read_b64_tr_b16 v[104:105], v5 offset:57344
    ds_read_b64_tr_b16 v[106:107], v5 offset:58368
    v_mfma_f32_32x32x8_bf16 v[16:31], v[112:113], v[124:125], v[16:31]
    v_mfma_f32_32x32x16_bf16 v[16:31], v[108:111], v[148:151], v[16:31]
    ds_read_b64_tr_b16 v[108:109], v5 offset:61440
    ds_read_b64_tr_b16 v[110:111], v5 offset:62464
    v_mfma_f32_32x32x8_bf16 v[32:47], v[114:115], v[124:125], v[32:47]
    s_waitcnt vmcnt(0) lgkmcnt(8)
    v_mfma_f32_32x32x16_bf16 v[16:31], v[80:83], v[152:155], v[16:31]
    ds_read_b64_tr_b16 v[80:81], v6 offset:16384
    ds_read_b64_tr_b16 v[82:83], v6 offset:17408
    v_mfma_f32_32x32x16_bf16 v[16:31], v[84:87], v[156:159], v[16:31]
    ds_read_b64_tr_b16 v[84:85], v6 offset:20480
    ds_read_b64_tr_b16 v[86:87], v6 offset:21504
    v_mfma_f32_32x32x16_bf16 v[32:47], v[88:91], v[136:139], v[32:47]
    ds_read_b64_tr_b16 v[88:89], v6 offset:24576
    ds_read_b64_tr_b16 v[90:91], v6 offset:25600
    v_mfma_f32_32x32x16_bf16 v[32:47], v[92:95], v[140:143], v[32:47]
    ds_read_b64_tr_b16 v[92:93], v6 offset:28672
    ds_read_b64_tr_b16 v[94:95], v6 offset:29696
    s_waitcnt lgkmcnt(8)
    v_mfma_f32_32x32x16_bf16 v[32:47], v[96:99], v[144:147], v[32:47]
    ds_read_b64_tr_b16 v[96:97], v6 offset:32768
    ds_read_b64_tr_b16 v[98:99], v6 offset:33792
    v_mfma_f32_32x32x16_bf16 v[32:47], v[100:103], v[148:151], v[32:47]
    ds_read_b64_tr_b16 v[100:101], v6 offset:36864
    ds_read_b64_tr_b16 v[102:103], v6 offset:37888
    v_cvt_pk_bf16_f32 v216, v16, v17
    v_cvt_pk_bf16_f32 v217, v18, v19
    v_cvt_pk_bf16_f32 v218, v20, v21
    v_mfma_f32_32x32x16_bf16 v[32:47], v[104:107], v[152:155], v[32:47]
    ds_read_b64_tr_b16 v[104:105], v6 offset:40960
    ds_read_b64_tr_b16 v[106:107], v6 offset:41984
    v_cvt_pk_bf16_f32 v219, v22, v23
    v_cvt_pk_bf16_f32 v220, v24, v25
    v_cvt_pk_bf16_f32 v221, v26, v27
    v_mfma_f32_32x32x16_bf16 v[32:47], v[108:111], v[156:159], v[32:47]
    ds_read_b64_tr_b16 v[108:109], v6 offset:45056
    ds_read_b64_tr_b16 v[110:111], v6 offset:46080
    v_cvt_pk_bf16_f32 v222, v28, v29
    v_cvt_pk_bf16_f32 v223, v30, v31
    v_pk_max_i16 v216, v216, 0
    s_waitcnt lgkmcnt(8)
    v_mfma_f32_32x32x16_bf16 v[48:63], v[80:83], v[176:179], v[48:63]
    ds_read_b64_tr_b16 v[80:81], v6 offset:49152
    ds_read_b64_tr_b16 v[82:83], v6 offset:50176
    v_pk_max_i16 v217, v217, 0
    v_pk_max_i16 v218, v218, 0
    v_pk_max_i16 v219, v219, 0
    v_mfma_f32_32x32x16_bf16 v[48:63], v[84:87], v[180:183], v[48:63]
    ds_read_b64_tr_b16 v[84:85], v6 offset:53248
    ds_read_b64_tr_b16 v[86:87], v6 offset:54272
    v_pk_max_i16 v220, v220, 0
    v_pk_max_i16 v221, v221, 0
    v_pk_max_i16 v222, v222, 0
    v_mfma_f32_32x32x16_bf16 v[48:63], v[88:91], v[184:187], v[48:63]
    ds_read_b64_tr_b16 v[88:89], v6 offset:57344
    ds_read_b64_tr_b16 v[90:91], v6 offset:58368
    v_pk_max_i16 v223, v223, 0
    s_nop 0
    v_permlane32_swap_b32 v216, v218
    v_mfma_f32_32x32x16_bf16 v[48:63], v[92:95], v[188:191], v[48:63]
    ds_read_b64_tr_b16 v[92:93], v6 offset:61440
    ds_read_b64_tr_b16 v[94:95], v6 offset:62464
    v_permlane32_swap_b32 v217, v219
    v_permlane32_swap_b32 v220, v222
    v_permlane32_swap_b32 v221, v223
    s_waitcnt lgkmcnt(8)
    v_mfma_f32_32x32x16_bf16 v[48:63], v[96:99], v[128:131], v[48:63]
    ds_read_b64_tr_b16 v[96:97], v7 offset:16384
    ds_read_b64_tr_b16 v[98:99], v7 offset:17408
    buffer_store_dwordx4 v[216:219], v9, s[20:23], s55 offen offset:0 sc0 sc1
    buffer_store_dwordx4 v[220:223], v9, s[20:23], s55 offen offset:1024 sc0 sc1
    v_mfma_f32_32x32x16_bf16 v[48:63], v[100:103], v[132:135], v[48:63]
    ds_read_b64_tr_b16 v[100:101], v7 offset:20480
    ds_read_b64_tr_b16 v[102:103], v7 offset:21504
    v_cvt_pk_bf16_f32 v224, v32, v33
    v_cvt_pk_bf16_f32 v225, v34, v35
    v_cvt_pk_bf16_f32 v226, v36, v37
    v_mfma_f32_32x32x16_bf16 v[48:63], v[104:107], v[136:139], v[48:63]
    ds_read_b64_tr_b16 v[104:105], v7 offset:24576
    ds_read_b64_tr_b16 v[106:107], v7 offset:25600
    v_cvt_pk_bf16_f32 v227, v38, v39
    v_cvt_pk_bf16_f32 v228, v40, v41
    v_cvt_pk_bf16_f32 v229, v42, v43
    v_mfma_f32_32x32x16_bf16 v[48:63], v[108:111], v[140:143], v[48:63]
    ds_read_b64_tr_b16 v[108:109], v7 offset:28672
    ds_read_b64_tr_b16 v[110:111], v7 offset:29696
    v_cvt_pk_bf16_f32 v230, v44, v45
    v_cvt_pk_bf16_f32 v231, v46, v47
    v_pk_max_i16 v224, v224, 0
    s_waitcnt lgkmcnt(8)
    v_mfma_f32_32x32x16_bf16 v[48:63], v[80:83], v[144:147], v[48:63]
    ds_read_b64_tr_b16 v[80:81], v7 offset:32768
    ds_read_b64_tr_b16 v[82:83], v7 offset:33792
    v_pk_max_i16 v225, v225, 0
    v_pk_max_i16 v226, v226, 0
    v_pk_max_i16 v227, v227, 0
    v_mfma_f32_32x32x16_bf16 v[48:63], v[84:87], v[148:151], v[48:63]
    ds_read_b64_tr_b16 v[84:85], v7 offset:36864
    ds_read_b64_tr_b16 v[86:87], v7 offset:37888
    v_pk_max_i16 v228, v228, 0
    v_pk_max_i16 v229, v229, 0
    v_pk_max_i16 v230, v230, 0
    v_mfma_f32_32x32x16_bf16 v[48:63], v[88:91], v[152:155], v[48:63]
    ds_read_b64_tr_b16 v[88:89], v7 offset:40960
    ds_read_b64_tr_b16 v[90:91], v7 offset:41984
    v_pk_max_i16 v231, v231, 0
    s_nop 0
    v_permlane32_swap_b32 v224, v226
    v_mfma_f32_32x32x16_bf16 v[48:63], v[92:95], v[156:159], v[48:63]
    ds_read_b64_tr_b16 v[92:93], v7 offset:45056
    ds_read_b64_tr_b16 v[94:95], v7 offset:46080
    v_permlane32_swap_b32 v225, v227
    v_permlane32_swap_b32 v228, v230
    v_permlane32_swap_b32 v229, v231
    s_waitcnt lgkmcnt(8)
    v_mfma_f32_32x32x16_bf16 v[64:79], v[96:99], v[176:179], v[64:79]
    ds_read_b64_tr_b16 v[96:97], v7 offset:49152
    ds_read_b64_tr_b16 v[98:99], v7 offset:50176
    buffer_store_dwordx4 v[224:227], v9, s[20:23], s55 offen offset:2048 sc0 sc1
    buffer_store_dwordx4 v[228:231], v9, s[20:23], s55 offen offset:3072 sc0 sc1
    v_mfma_f32_32x32x16_bf16 v[64:79], v[100:103], v[180:183], v[64:79]
    ds_read_b64_tr_b16 v[100:101], v7 offset:53248
    ds_read_b64_tr_b16 v[102:103], v7 offset:54272
    v_mfma_f32_32x32x16_bf16 v[64:79], v[104:107], v[184:187], v[64:79]
    ds_read_b64_tr_b16 v[104:105], v7 offset:57344
    ds_read_b64_tr_b16 v[106:107], v7 offset:58368
    v_mfma_f32_32x32x16_bf16 v[64:79], v[108:111], v[188:191], v[64:79]
    ds_read_b64_tr_b16 v[108:109], v7 offset:61440
    ds_read_b64_tr_b16 v[110:111], v7 offset:62464
    v_cvt_pk_bf16_f32 v216, v48, v49
    v_cvt_pk_bf16_f32 v217, v50, v51
    v_cvt_pk_bf16_f32 v218, v52, v53
    s_waitcnt lgkmcnt(8)
    v_mfma_f32_32x32x16_bf16 v[64:79], v[80:83], v[128:131], v[64:79]
    v_cvt_pk_bf16_f32 v219, v54, v55
    v_cvt_pk_bf16_f32 v220, v56, v57
    v_cvt_pk_bf16_f32 v221, v58, v59
    v_mfma_f32_32x32x16_bf16 v[64:79], v[84:87], v[132:135], v[64:79]
    v_cvt_pk_bf16_f32 v222, v60, v61
    v_cvt_pk_bf16_f32 v223, v62, v63
    v_pk_max_i16 v216, v216, 0
    v_mfma_f32_32x32x16_bf16 v[64:79], v[88:91], v[136:139], v[64:79]
    v_pk_max_i16 v217, v217, 0
    v_pk_max_i16 v218, v218, 0
    v_pk_max_i16 v219, v219, 0
    v_mfma_f32_32x32x16_bf16 v[64:79], v[92:95], v[140:143], v[64:79]
    v_pk_max_i16 v220, v220, 0
    v_pk_max_i16 v221, v221, 0
    v_pk_max_i16 v222, v222, 0
    s_waitcnt lgkmcnt(0)
    v_mfma_f32_32x32x16_bf16 v[64:79], v[96:99], v[144:147], v[64:79]
    v_pk_max_i16 v223, v223, 0
    s_nop 0
    v_permlane32_swap_b32 v216, v218
    v_mfma_f32_32x32x16_bf16 v[64:79], v[100:103], v[148:151], v[64:79]
    v_permlane32_swap_b32 v217, v219
    v_permlane32_swap_b32 v220, v222
    v_permlane32_swap_b32 v221, v223
    v_mfma_f32_32x32x16_bf16 v[64:79], v[104:107], v[152:155], v[64:79]
    buffer_store_dwordx4 v[216:219], v8, s[20:23], s56 offen offset:0 sc0 sc1
    buffer_store_dwordx4 v[220:223], v8, s[20:23], s56 offen offset:1024 sc0 sc1
    v_mfma_f32_32x32x16_bf16 v[64:79], v[108:111], v[156:159], v[64:79]
    s_nop 11
    v_cvt_pk_bf16_f32 v224, v64, v65
    v_cvt_pk_bf16_f32 v225, v66, v67
    v_cvt_pk_bf16_f32 v226, v68, v69
    v_cvt_pk_bf16_f32 v227, v70, v71
    v_cvt_pk_bf16_f32 v228, v72, v73
    v_cvt_pk_bf16_f32 v229, v74, v75
    v_cvt_pk_bf16_f32 v230, v76, v77
    v_cvt_pk_bf16_f32 v231, v78, v79
    v_pk_max_i16 v224, v224, 0
    v_pk_max_i16 v225, v225, 0
    v_pk_max_i16 v226, v226, 0
    v_pk_max_i16 v227, v227, 0
    v_pk_max_i16 v228, v228, 0
    v_pk_max_i16 v229, v229, 0
    v_pk_max_i16 v230, v230, 0
    v_pk_max_i16 v231, v231, 0
    s_nop 0
    v_permlane32_swap_b32 v224, v226
    v_permlane32_swap_b32 v225, v227
    v_permlane32_swap_b32 v228, v230
    v_permlane32_swap_b32 v229, v231
    buffer_store_dwordx4 v[224:227], v8, s[20:23], s56 offen offset:2048 sc0 sc1
    buffer_store_dwordx4 v[228:231], v8, s[20:23], s56 offen offset:3072 sc0 sc1
L_f1_done:
    s_lshl_b32 s52, s41, 4
    s_add_u32 s52, s52, s42
    s_lshr_b32 s58, s52, 4
    s_and_b32 s60, s58, 3
    s_lshl_b32 s60, s60, 11
    s_and_b32 s59, s58, 4
    s_lshl_b32 s59, s59, 12
    s_add_u32 s60, s60, s59
    s_and_b32 s59, s58, 8
    s_lshl_b32 s59, s59, 10
    s_add_u32 s60, s60, s59
    s_xor_b32 s60, s60, s99
    s_add_u32 s60, s60, 29458432
    s_and_b32 s59, s52, 15
    s_lshl_b32 s59, s59, 7
    s_add_u32 s60, s60, s59
    v_lshl_add_u32 v249, v1, 2, s60
    s_and_b32 s60, s41, 3
    s_lshl_b32 s60, s60, 11
    s_and_b32 s59, s41, 4
    s_lshl_b32 s59, s59, 12
    s_add_u32 s60, s60, s59
    s_and_b32 s59, s41, 8
    s_lshl_b32 s59, s59, 10
    s_add_u32 s60, s60, s59
    s_xor_b32 s60, s60, s99
    s_add_u32 s60, s60, 29458432
    v_min_u32 v250, 13, v1
    v_lshl_add_u32 v250, v250, 7, s60
    v_rcp_f32 v9, v120
    s_nop 0
    v_mov_b32 v8, v9
    s_nop 1
    v_permlane16_swap_b32 v8, v9
    v_mul_f32 v160, v8, v232
    v_mul_f32 v161, v8, v233
    v_mul_f32 v162, v8, v234
    v_mul_f32 v163, v8, v235
    v_mul_f32 v164, v9, v232
    v_mul_f32 v165, v9, v233
    v_mul_f32 v166, v9, v234
    v_mul_f32 v167, v9, v235
    v_mul_f32 v168, v8, v236
    v_mul_f32 v169, v8, v237
    v_mul_f32 v170, v8, v238
    v_mul_f32 v171, v8, v239
    v_mul_f32 v172, v9, v236
    v_mul_f32 v173, v9, v237
    v_mul_f32 v174, v9, v238
    v_mul_f32 v175, v9, v239
    v_mul_f32 v176, v8, v240
    v_mul_f32 v177, v8, v241
    v_mul_f32 v178, v8, v242
    v_mul_f32 v179, v8, v243
    v_mul_f32 v180, v9, v240
    v_mul_f32 v181, v9, v241
    v_mul_f32 v182, v9, v242
    v_mul_f32 v183, v9, v243
    s_waitcnt vmcnt(0)
    s_barrier
    s_cmp_eq_u32 s40, 0
    s_cbranch_scc0 L_ho_f1_a
    s_cmp_lt_u32 s2, 224
    s_cbranch_scc0 L_ho_f1_a
    s_mov_b32 exec_hi, 0
    buffer_store_dword v248, v249, s[20:23], 0 offen sc0 sc1
    s_mov_b64 exec, -1
L_ho_f1_a:
    s_bfe_u32 s41, s2, 0x20001
    s_lshl_b32 s41, s41, 2
    s_bfe_u32 s42, s2, 0x20003
    s_add_u32 s41, s41, s42
    s_lshl_b32 s41, s41, 1
    s_bfe_u32 s42, s2, 0x10005
    s_add_u32 s41, s41, s42
    s_lshr_b32 s42, s2, 6
    s_and_b32 s60, s2, 1
    s_lshl_b32 s60, s60, 2
    s_add_u32 s42, s42, s60
    s_and_b32 s43, s40, 1
    s_bfe_u32 s44, s40, 0x10001
    s_lshl_b32 s48, s41, 1
    s_add_u32 s48, s48, s43
    v_lshlrev_b32 v10, 4, v1
    s_mul_i32 s45, s44, 8192
    s_mul_i32 s46, s44, 3072
    v_add_u32 v4, s45, v10
    v_add_u32 v5, s46, v10
    v_lshrrev_b32 v11, 4, v1
    v_and_b32 v12, 15, v1
    v_lshlrev_b32 v12, 4, v12
    v_lshl_add_u32 v6, v11, 9, v12
    v_and_b32 v10, 31, v1
    v_mul_u32_u24 v7, 1280, v10
    v_lshrrev_b32 v10, 5, v1
    v_lshl_add_u32 v7, v10, 4, v7
    s_mul_i32 s54, s48, 40960
    s_mul_i32 s55, s42, 160
    s_add_u32 s54, s54, s55
    s_mul_i32 s55, s44, 96
    s_add_u32 s54, s54, s55
    s_mul_i32 s45, s40, 6144
    s_xor_b32 s46, s40, 2
    s_mul_i32 s46, s46, 6144
    s_lshl_b32 s47, s44, 11
    s_add_u32 s46, s46, s47
    s_add_u32 s45, s45, 92160
    s_add_u32 s46, s46, 92160
    v_lshlrev_b32 v2, 4, v1
    v_add_u32 v15, s46, v2
    v_add_u32 v14, s45, v2
    s_and_b32 s49, s48, 7
    s_mul_i32 s49, s49, 229376
    s_bfe_u32 s60, s48, 131075
    s_lshl_b32 s60, s60, 21
    s_add_u32 s49, s49, s60
    s_lshl_b32 s60, s48, 2
    s_xor_b32 s60, s60, s48
    s_and_b32 s60, s60, 32
    s_lshl_b32 s60, s60, 8
    s_xor_b32 s60, s60, s99
    s_add_u32 s49, s49, s60
    s_add_u32 s49, s49, 46137344
    s_lshl_b32 s45, s44, 11
    s_add_u32 s49, s49, s45
    s_cmp_eq_u32 s40, 0
    s_cbranch_scc0 L_ho_f1_done
    s_mov_b32 s62, 0
    s_waitcnt vmcnt(0)
L_ho_f1:
    buffer_load_dword v251, v250, s[20:23], 0 offen sc0 sc1
    s_add_u32 s62, s62, 1
    s_waitcnt vmcnt(0)
L_ho_f1_chk:
    v_cmp_ne_u32 vcc, s3, v251
    s_cmp_gt_u32 s62, 400000
    s_cbranch_scc1 L_ho_f1_done
    s_cbranch_vccz L_ho_f1_done
    s_branch L_ho_f1
L_ho_f1_done:
    s_barrier
    buffer_load_dwordx4 v[96:99], v6, s[20:23], s49 offen offset:0 sc1
    buffer_load_dwordx4 v[100:103], v6, s[20:23], s49 offen offset:256 sc1
    v_add_u32 v4, 102400, v4
    v_add_u32 v5, 102400, v5
    ds_read_b128 v[56:59], v4 offset:40960
    ds_read_b128 v[60:63], v4 offset:41984
    ds_read_b128 v[64:67], v5 offset:43008
    ds_read_b128 v[68:71], v5 offset:44032
    ds_read_b128 v[72:75], v5 offset:45056
    v_add_u32 v4, 51200, v4
    v_add_u32 v5, 51200, v5
    ds_read_b128 v[76:79], v4 offset:0
    ds_read_b128 v[80:83], v4 offset:1024
    ds_read_b128 v[84:87], v5 offset:2048
    ds_read_b128 v[88:91], v5 offset:3072
    ds_read_b128 v[92:95], v5 offset:4096
    s_add_u32 s49, s49, 4096
    buffer_load_dwordx4 v[104:107], v6, s[20:23], s49 offen offset:0 sc1
    buffer_load_dwordx4 v[108:111], v6, s[20:23], s49 offen offset:256 sc1
    s_add_u32 s49, s49, 12288
    buffer_load_dwordx4 v[112:115], v6, s[20:23], s49 offen offset:0 sc1
    buffer_load_dwordx4 v[116:119], v6, s[20:23], s49 offen offset:256 sc1
    s_add_u32 s49, s49, 4096
    buffer_load_dwordx4 v[120:123], v6, s[20:23], s49 offen offset:0 sc1
    buffer_load_dwordx4 v[124:127], v6, s[20:23], s49 offen offset:256 sc1
    s_waitcnt vmcnt(6) lgkmcnt(5)
    v_mfma_f32_16x16x32_bf16 v[16:19], v[56:59], v[96:99], 0
    v_subrev_u32 v4, 153600, v4
    v_subrev_u32 v5, 153600, v5
    v_mfma_f32_16x16x32_bf16 v[20:23], v[56:59], v[100:103], 0
    ds_read_b128 v[56:59], v4 offset:0
    v_mfma_f32_16x16x32_bf16 v[24:27], v[60:63], v[96:99], 0
    s_add_u32 s49, s49, 12288
    buffer_load_dwordx4 v[128:131], v6, s[20:23], s49 offen offset:0 sc1
    v_mfma_f32_16x16x32_bf16 v[28:31], v[60:63], v[100:103], 0
    ds_read_b128 v[60:63], v4 offset:1024
    v_mfma_f32_16x16x32_bf16 v[32:35], v[64:67], v[96:99], 0
    buffer_load_dwordx4 v[132:135], v6, s[20:23], s49 offen offset:256 sc1
    v_mfma_f32_16x16x32_bf16 v[36:39], v[64:67], v[100:103], 0
    ds_read_b128 v[64:67], v5 offset:2048
    v_mfma_f32_16x16x32_bf16 v[40:43], v[68:71], v[96:99], 0
    s_add_u32 s49, s49, 4096
    buffer_load_dwordx4 v[136:139], v6, s[20:23], s49 offen offset:0 sc1
    v_mfma_f32_16x16x32_bf16 v[44:47], v[68:71], v[100:103], 0
    ds_read_b128 v[68:71], v5 offset:3072
    v_mfma_f32_16x16x32_bf16 v[48:51], v[72:75], v[96:99], 0
    buffer_load_dwordx4 v[140:143], v6, s[20:23], s49 offen offset:256 sc1
    v_mfma_f32_16x16x32_bf16 v[52:55], v[72:75], v[100:103], 0
    s_waitcnt vmcnt(8) lgkmcnt(4)
    v_mfma_f32_16x16x32_bf16 v[16:19], v[76:79], v[104:107], v[16:19]
    ds_read_b128 v[72:75], v5 offset:4096
    v_mfma_f32_16x16x32_bf16 v[20:23], v[76:79], v[108:111], v[20:23]
    ds_read_b128 v[76:79], v4 offset:10240
    v_mfma_f32_16x16x32_bf16 v[24:27], v[80:83], v[104:107], v[24:27]
    s_add_u32 s49, s49, 12288
    buffer_load_dwordx4 v[144:147], v6, s[20:23], s49 offen offset:0 sc1
    v_mfma_f32_16x16x32_bf16 v[28:31], v[80:83], v[108:111], v[28:31]
    ds_read_b128 v[80:83], v4 offset:11264
    v_mfma_f32_16x16x32_bf16 v[32:35], v[84:87], v[104:107], v[32:35]
    buffer_load_dwordx4 v[148:151], v6, s[20:23], s49 offen offset:256 sc1
    v_mfma_f32_16x16x32_bf16 v[36:39], v[84:87], v[108:111], v[36:39]
    ds_read_b128 v[84:87], v5 offset:12288
    v_mfma_f32_16x16x32_bf16 v[40:43], v[88:91], v[104:107], v[40:43]
    s_add_u32 s49, s49, 4096
    buffer_load_dwordx4 v[152:155], v6, s[20:23], s49 offen offset:0 sc1
    v_mfma_f32_16x16x32_bf16 v[44:47], v[88:91], v[108:111], v[44:47]
    ds_read_b128 v[88:91], v5 offset:13312
    v_mfma_f32_16x16x32_bf16 v[48:51], v[92:95], v[104:107], v[48:51]
    buffer_load_dwordx4 v[156:159], v6, s[20:23], s49 offen offset:256 sc1
    v_mfma_f32_16x16x32_bf16 v[52:55], v[92:95], v[108:111], v[52:55]
    s_waitcnt vmcnt(10) lgkmcnt(4)
    v_mfma_f32_16x16x32_bf16 v[16:19], v[56:59], v[112:115], v[16:19]
    ds_read_b128 v[92:95], v5 offset:14336
    v_mfma_f32_16x16x32_bf16 v[20:23], v[56:59], v[116:119], v[20:23]
    ds_read_b128 v[56:59], v4 offset:20480
    v_mfma_f32_16x16x32_bf16 v[24:27], v[60:63], v[112:115], v[24:27]
    s_add_u32 s49, s49, 12288
    buffer_load_dwordx4 v[96:99], v6, s[20:23], s49 offen offset:0 sc1
    v_mfma_f32_16x16x32_bf16 v[28:31], v[60:63], v[116:119], v[28:31]
    ds_read_b128 v[60:63], v4 offset:21504
    v_mfma_f32_16x16x32_bf16 v[32:35], v[64:67], v[112:115], v[32:35]
    v_mfma_f32_16x16x32_bf16 v[36:39], v[64:67], v[116:119], v[36:39]
    ds_read_b128 v[64:67], v5 offset:22528
    v_mfma_f32_16x16x32_bf16 v[40:43], v[68:71], v[112:115], v[40:43]
    buffer_load_dwordx4 v[100:103], v6, s[20:23], s49 offen offset:256 sc1
    v_mfma_f32_16x16x32_bf16 v[44:47], v[68:71], v[116:119], v[44:47]
    ds_read_b128 v[68:71], v5 offset:23552
    v_mfma_f32_16x16x32_bf16 v[48:51], v[72:75], v[112:115], v[48:51]
    s_add_u32 s49, s49, 4096
    v_mfma_f32_16x16x32_bf16 v[52:55], v[72:75], v[116:119], v[52:55]
    s_waitcnt vmcnt(10) lgkmcnt(4)
    v_mfma_f32_16x16x32_bf16 v[16:19], v[76:79], v[120:123], v[16:19]
    ds_read_b128 v[72:75], v5 offset:24576
    v_mfma_f32_16x16x32_bf16 v[20:23], v[76:79], v[124:127], v[20:23]
    ds_read_b128 v[76:79], v4 offset:30720
    v_mfma_f32_16x16x32_bf16 v[24:27], v[80:83], v[120:123], v[24:27]
    buffer_load_dwordx4 v[104:107], v6, s[20:23], s49 offen offset:0 sc1
    v_mfma_f32_16x16x32_bf16 v[28:31], v[80:83], v[124:127], v[28:31]
    ds_read_b128 v[80:83], v4 offset:31744
    v_mfma_f32_16x16x32_bf16 v[32:35], v[84:87], v[120:123], v[32:35]
    v_mfma_f32_16x16x32_bf16 v[36:39], v[84:87], v[124:127], v[36:39]
    ds_read_b128 v[84:87], v5 offset:32768
    v_mfma_f32_16x16x32_bf16 v[40:43], v[88:91], v[120:123], v[40:43]
    buffer_load_dwordx4 v[108:111], v6, s[20:23], s49 offen offset:256 sc1
    v_mfma_f32_16x16x32_bf16 v[44:47], v[88:91], v[124:127], v[44:47]
    ds_read_b128 v[88:91], v5 offset:33792
    v_mfma_f32_16x16x32_bf16 v[48:51], v[92:95], v[120:123], v[48:51]
    s_add_u32 s49, s49, 12288
    v_mfma_f32_16x16x32_bf16 v[52:55], v[92:95], v[124:127], v[52:55]
    ds_read_b128 v[92:95], v5 offset:34816
    s_waitcnt vmcnt(10) lgkmcnt(0)
    s_barrier
    v_mfma_f32_16x16x32_bf16 v[16:19], v[56:59], v[128:131], v[16:19]
    v_mfma_f32_16x16x32_bf16 v[20:23], v[56:59], v[132:135], v[20:23]
    ds_read_b128 v[56:59], v4 offset:40960
    v_mfma_f32_16x16x32_bf16 v[24:27], v[60:63], v[128:131], v[24:27]
    buffer_load_dwordx4 v[112:115], v6, s[20:23], s49 offen offset:0 sc1
    v_mfma_f32_16x16x32_bf16 v[28:31], v[60:63], v[132:135], v[28:31]
    ds_read_b128 v[60:63], v4 offset:41984
    v_mfma_f32_16x16x32_bf16 v[32:35], v[64:67], v[128:131], v[32:35]
    v_mfma_f32_16x16x32_bf16 v[36:39], v[64:67], v[132:135], v[36:39]
    ds_read_b128 v[64:67], v5 offset:43008
    v_mfma_f32_16x16x32_bf16 v[40:43], v[68:71], v[128:131], v[40:43]
    buffer_load_dwordx4 v[116:119], v6, s[20:23], s49 offen offset:256 sc1
    v_mfma_f32_16x16x32_bf16 v[44:47], v[68:71], v[132:135], v[44:47]
    ds_read_b128 v[68:71], v5 offset:44032
    v_mfma_f32_16x16x32_bf16 v[48:51], v[72:75], v[128:131], v[48:51]
    s_add_u32 s49, s49, 4096
    v_mfma_f32_16x16x32_bf16 v[52:55], v[72:75], v[132:135], v[52:55]
    s_waitcnt vmcnt(10) lgkmcnt(4)
    v_mfma_f32_16x16x32_bf16 v[16:19], v[76:79], v[136:139], v[16:19]
    ds_read_b128 v[72:75], v5 offset:45056
    v_add_u32 v4, 51200, v4
    v_add_u32 v5, 51200, v5
    v_mfma_f32_16x16x32_bf16 v[20:23], v[76:79], v[140:143], v[20:23]
    ds_read_b128 v[76:79], v4 offset:0
    v_mfma_f32_16x16x32_bf16 v[24:27], v[80:83], v[136:139], v[24:27]
    buffer_load_dwordx4 v[120:123], v6, s[20:23], s49 offen offset:0 sc1
    v_mfma_f32_16x16x32_bf16 v[28:31], v[80:83], v[140:143], v[28:31]
    ds_read_b128 v[80:83], v4 offset:1024
    v_mfma_f32_16x16x32_bf16 v[32:35], v[84:87], v[136:139], v[32:35]
    v_mfma_f32_16x16x32_bf16 v[36:39], v[84:87], v[140:143], v[36:39]
    ds_read_b128 v[84:87], v5 offset:2048
    v_mfma_f32_16x16x32_bf16 v[40:43], v[88:91], v[136:139], v[40:43]
    buffer_load_dwordx4 v[124:127], v6, s[20:23], s49 offen offset:256 sc1
    v_mfma_f32_16x16x32_bf16 v[44:47], v[88:91], v[140:143], v[44:47]
    ds_read_b128 v[88:91], v5 offset:3072
    v_mfma_f32_16x16x32_bf16 v[48:51], v[92:95], v[136:139], v[48:51]
    s_add_u32 s49, s49, 12288
    v_mfma_f32_16x16x32_bf16 v[52:55], v[92:95], v[140:143], v[52:55]
    s_waitcnt vmcnt(10) lgkmcnt(4)
    v_mfma_f32_16x16x32_bf16 v[16:19], v[56:59], v[144:147], v[16:19]
    ds_read_b128 v[92:95], v5 offset:4096
    v_mfma_f32_16x16x32_bf16 v[20:23], v[56:59], v[148:151], v[20:23]
    ds_read_b128 v[56:59], v4 offset:10240
    v_mfma_f32_16x16x32_bf16 v[24:27], v[60:63], v[144:147], v[24:27]
    buffer_load_dwordx4 v[128:131], v6, s[20:23], s49 offen offset:0 sc1
    v_mfma_f32_16x16x32_bf16 v[28:31], v[60:63], v[148:151], v[28:31]
    ds_read_b128 v[60:63], v4 offset:11264
    v_mfma_f32_16x16x32_bf16 v[32:35], v[64:67], v[144:147], v[32:35]
    v_mfma_f32_16x16x32_bf16 v[36:39], v[64:67], v[148:151], v[36:39]
    ds_read_b128 v[64:67], v5 offset:12288
    v_mfma_f32_16x16x32_bf16 v[40:43], v[68:71], v[144:147], v[40:43]
    buffer_load_dwordx4 v[132:135], v6, s[20:23], s49 offen offset:256 sc1
    v_mfma_f32_16x16x32_bf16 v[44:47], v[68:71], v[148:151], v[44:47]
    ds_read_b128 v[68:71], v5 offset:13312
    v_mfma_f32_16x16x32_bf16 v[48:51], v[72:75], v[144:147], v[48:51]
    s_add_u32 s49, s49, 4096
    v_mfma_f32_16x16x32_bf16 v[52:55], v[72:75], v[148:151], v[52:55]
    s_waitcnt vmcnt(10) lgkmcnt(4)
    v_mfma_f32_16x16x32_bf16 v[16:19], v[76:79], v[152:155], v[16:19]
    ds_read_b128 v[72:75], v5 offset:14336
    v_mfma_f32_16x16x32_bf16 v[20:23], v[76:79], v[156:159], v[20:23]
    ds_read_b128 v[76:79], v4 offset:20480
    v_mfma_f32_16x16x32_bf16 v[24:27], v[80:83], v[152:155], v[24:27]
    buffer_load_dwordx4 v[136:139], v6, s[20:23], s49 offen offset:0 sc1
    v_mfma_f32_16x16x32_bf16 v[28:31], v[80:83], v[156:159], v[28:31]
    ds_read_b128 v[80:83], v4 offset:21504
    v_mfma_f32_16x16x32_bf16 v[32:35], v[84:87], v[152:155], v[32:35]
    v_mfma_f32_16x16x32_bf16 v[36:39], v[84:87], v[156:159], v[36:39]
    ds_read_b128 v[84:87], v5 offset:22528
    v_mfma_f32_16x16x32_bf16 v[40:43], v[88:91], v[152:155], v[40:43]
    buffer_load_dwordx4 v[140:143], v6, s[20:23], s49 offen offset:256 sc1
    v_mfma_f32_16x16x32_bf16 v[44:47], v[88:91], v[156:159], v[44:47]
    ds_read_b128 v[88:91], v5 offset:23552
    v_mfma_f32_16x16x32_bf16 v[48:51], v[92:95], v[152:155], v[48:51]
    s_add_u32 s49, s49, 12288
    v_mfma_f32_16x16x32_bf16 v[52:55], v[92:95], v[156:159], v[52:55]
    s_waitcnt vmcnt(10) lgkmcnt(4)
    v_mfma_f32_16x16x32_bf16 v[16:19], v[56:59], v[96:99], v[16:19]
    ds_read_b128 v[92:95], v5 offset:24576
    v_mfma_f32_16x16x32_bf16 v[20:23], v[56:59], v[100:103], v[20:23]
    ds_read_b128 v[56:59], v4 offset:30720
    v_mfma_f32_16x16x32_bf16 v[24:27], v[60:63], v[96:99], v[24:27]
    buffer_load_dwordx4 v[144:147], v6, s[20:23], s49 offen offset:0 sc1
    v_mfma_f32_16x16x32_bf16 v[28:31], v[60:63], v[100:103], v[28:31]
    ds_read_b128 v[60:63], v4 offset:31744
    v_mfma_f32_16x16x32_bf16 v[32:35], v[64:67], v[96:99], v[32:35]
    v_mfma_f32_16x16x32_bf16 v[36:39], v[64:67], v[100:103], v[36:39]
    ds_read_b128 v[64:67], v5 offset:32768
    v_mfma_f32_16x16x32_bf16 v[40:43], v[68:71], v[96:99], v[40:43]
    buffer_load_dwordx4 v[148:151], v6, s[20:23], s49 offen offset:256 sc1
    v_mfma_f32_16x16x32_bf16 v[44:47], v[68:71], v[100:103], v[44:47]
    ds_read_b128 v[68:71], v5 offset:33792
    v_mfma_f32_16x16x32_bf16 v[48:51], v[72:75], v[96:99], v[48:51]
    s_add_u32 s49, s49, 4096
    v_mfma_f32_16x16x32_bf16 v[52:55], v[72:75], v[100:103], v[52:55]
    s_waitcnt vmcnt(10) lgkmcnt(4)
    v_mfma_f32_16x16x32_bf16 v[16:19], v[76:79], v[104:107], v[16:19]
    ds_read_b128 v[72:75], v5 offset:34816
    v_mfma_f32_16x16x32_bf16 v[20:23], v[76:79], v[108:111], v[20:23]
    ds_read_b128 v[76:79], v4 offset:40960
    v_mfma_f32_16x16x32_bf16 v[24:27], v[80:83], v[104:107], v[24:27]
    buffer_load_dwordx4 v[152:155], v6, s[20:23], s49 offen offset:0 sc1
    v_mfma_f32_16x16x32_bf16 v[28:31], v[80:83], v[108:111], v[28:31]
    ds_read_b128 v[80:83], v4 offset:41984
    v_mfma_f32_16x16x32_bf16 v[32:35], v[84:87], v[104:107], v[32:35]
    v_mfma_f32_16x16x32_bf16 v[36:39], v[84:87], v[108:111], v[36:39]
    ds_read_b128 v[84:87], v5 offset:43008
    v_mfma_f32_16x16x32_bf16 v[40:43], v[88:91], v[104:107], v[40:43]
    buffer_load_dwordx4 v[156:159], v6, s[20:23], s49 offen offset:256 sc1
    v_mfma_f32_16x16x32_bf16 v[44:47], v[88:91], v[108:111], v[44:47]
    ds_read_b128 v[88:91], v5 offset:44032
    v_mfma_f32_16x16x32_bf16 v[48:51], v[92:95], v[104:107], v[48:51]
    s_add_u32 s49, s49, 12288
    v_mfma_f32_16x16x32_bf16 v[52:55], v[92:95], v[108:111], v[52:55]
    ds_read_b128 v[92:95], v5 offset:45056
    s_waitcnt vmcnt(10) lgkmcnt(0)
    s_barrier
    v_mfma_f32_16x16x32_bf16 v[16:19], v[56:59], v[112:115], v[16:19]
    v_add_u32 v4, 51200, v4
    v_add_u32 v5, 51200, v5
    v_mfma_f32_16x16x32_bf16 v[20:23], v[56:59], v[116:119], v[20:23]
    ds_read_b128 v[56:59], v4 offset:0
    v_mfma_f32_16x16x32_bf16 v[24:27], v[60:63], v[112:115], v[24:27]
    buffer_load_dwordx4 v[96:99], v6, s[20:23], s49 offen offset:0 sc1
    v_mfma_f32_16x16x32_bf16 v[28:31], v[60:63], v[116:119], v[28:31]
    ds_read_b128 v[60:63], v4 offset:1024
    v_mfma_f32_16x16x32_bf16 v[32:35], v[64:67], v[112:115], v[32:35]
    v_mfma_f32_16x16x32_bf16 v[36:39], v[64:67], v[116:119], v[36:39]
    ds_read_b128 v[64:67], v5 offset:2048
    v_mfma_f32_16x16x32_bf16 v[40:43], v[68:71], v[112:115], v[40:43]
    buffer_load_dwordx4 v[100:103], v6, s[20:23], s49 offen offset:256 sc1
    v_mfma_f32_16x16x32_bf16 v[44:47], v[68:71], v[116:119], v[44:47]
    ds_read_b128 v[68:71], v5 offset:3072
    v_mfma_f32_16x16x32_bf16 v[48:51], v[72:75], v[112:115], v[48:51]
    s_add_u32 s49, s49, 4096
    v_mfma_f32_16x16x32_bf16 v[52:55], v[72:75], v[116:119], v[52:55]
    s_waitcnt vmcnt(10) lgkmcnt(4)
    v_mfma_f32_16x16x32_bf16 v[16:19], v[76:79], v[120:123], v[16:19]
    ds_read_b128 v[72:75], v5 offset:4096
    v_mfma_f32_16x16x32_bf16 v[20:23], v[76:79], v[124:127], v[20:23]
    ds_read_b128 v[76:79], v4 offset:10240
    v_mfma_f32_16x16x32_bf16 v[24:27], v[80:83], v[120:123], v[24:27]
    buffer_load_dwordx4 v[104:107], v6, s[20:23], s49 offen offset:0 sc1
    v_mfma_f32_16x16x32_bf16 v[28:31], v[80:83], v[124:127], v[28:31]
    ds_read_b128 v[80:83], v4 offset:11264
    v_mfma_f32_16x16x32_bf16 v[32:35], v[84:87], v[120:123], v[32:35]
    v_mfma_f32_16x16x32_bf16 v[36:39], v[84:87], v[124:127], v[36:39]
    ds_read_b128 v[84:87], v5 offset:12288
    v_mfma_f32_16x16x32_bf16 v[40:43], v[88:91], v[120:123], v[40:43]
    buffer_load_dwordx4 v[108:111], v6, s[20:23], s49 offen offset:256 sc1
    v_mfma_f32_16x16x32_bf16 v[44:47], v[88:91], v[124:127], v[44:47]
    ds_read_b128 v[88:91], v5 offset:13312
    v_mfma_f32_16x16x32_bf16 v[48:51], v[92:95], v[120:123], v[48:51]
    s_add_u32 s49, s49, 12288
    v_mfma_f32_16x16x32_bf16 v[52:55], v[92:95], v[124:127], v[52:55]
    s_waitcnt vmcnt(10) lgkmcnt(4)
    v_mfma_f32_16x16x32_bf16 v[16:19], v[56:59], v[128:131], v[16:19]
    ds_read_b128 v[92:95], v5 offset:14336
    v_mfma_f32_16x16x32_bf16 v[20:23], v[56:59], v[132:135], v[20:23]
    ds_read_b128 v[56:59], v4 offset:20480
    v_mfma_f32_16x16x32_bf16 v[24:27], v[60:63], v[128:131], v[24:27]
    buffer_load_dwordx4 v[112:115], v6, s[20:23], s49 offen offset:0 sc1
    v_mfma_f32_16x16x32_bf16 v[28:31], v[60:63], v[132:135], v[28:31]
    ds_read_b128 v[60:63], v4 offset:21504
    v_mfma_f32_16x16x32_bf16 v[32:35], v[64:67], v[128:131], v[32:35]
    v_mfma_f32_16x16x32_bf16 v[36:39], v[64:67], v[132:135], v[36:39]
    ds_read_b128 v[64:67], v5 offset:22528
    v_mfma_f32_16x16x32_bf16 v[40:43], v[68:71], v[128:131], v[40:43]
    buffer_load_dwordx4 v[116:119], v6, s[20:23], s49 offen offset:256 sc1
    v_mfma_f32_16x16x32_bf16 v[44:47], v[68:71], v[132:135], v[44:47]
    ds_read_b128 v[68:71], v5 offset:23552
    v_mfma_f32_16x16x32_bf16 v[48:51], v[72:75], v[128:131], v[48:51]
    s_add_u32 s49, s49, 4096
    v_mfma_f32_16x16x32_bf16 v[52:55], v[72:75], v[132:135], v[52:55]
    s_waitcnt vmcnt(10) lgkmcnt(4)
    v_mfma_f32_16x16x32_bf16 v[16:19], v[76:79], v[136:139], v[16:19]
    ds_read_b128 v[72:75], v5 offset:24576
    v_mfma_f32_16x16x32_bf16 v[20:23], v[76:79], v[140:143], v[20:23]
    ds_read_b128 v[76:79], v4 offset:30720
    v_mfma_f32_16x16x32_bf16 v[24:27], v[80:83], v[136:139], v[24:27]
    buffer_load_dwordx4 v[120:123], v6, s[20:23], s49 offen offset:0 sc1
    v_mfma_f32_16x16x32_bf16 v[28:31], v[80:83], v[140:143], v[28:31]
    ds_read_b128 v[80:83], v4 offset:31744
    v_mfma_f32_16x16x32_bf16 v[32:35], v[84:87], v[136:139], v[32:35]
    v_mfma_f32_16x16x32_bf16 v[36:39], v[84:87], v[140:143], v[36:39]
    ds_read_b128 v[84:87], v5 offset:32768
    v_mfma_f32_16x16x32_bf16 v[40:43], v[88:91], v[136:139], v[40:43]
    buffer_load_dwordx4 v[124:127], v6, s[20:23], s49 offen offset:256 sc1
    v_mfma_f32_16x16x32_bf16 v[44:47], v[88:91], v[140:143], v[44:47]
    ds_read_b128 v[88:91], v5 offset:33792
    v_mfma_f32_16x16x32_bf16 v[48:51], v[92:95], v[136:139], v[48:51]
    s_add_u32 s49, s49, 12288
    v_mfma_f32_16x16x32_bf16 v[52:55], v[92:95], v[140:143], v[52:55]
    s_waitcnt vmcnt(10) lgkmcnt(4)
    v_mfma_f32_16x16x32_bf16 v[16:19], v[56:59], v[144:147], v[16:19]
    ds_read_b128 v[92:95], v5 offset:34816
    v_mfma_f32_16x16x32_bf16 v[20:23], v[56:59], v[148:151], v[20:23]
    ds_read_b128 v[56:59], v4 offset:40960
    v_mfma_f32_16x16x32_bf16 v[24:27], v[60:63], v[144:147], v[24:27]
    buffer_load_dwordx4 v[128:131], v6, s[20:23], s49 offen offset:0 sc1
    v_mfma_f32_16x16x32_bf16 v[28:31], v[60:63], v[148:151], v[28:31]
    ds_read_b128 v[60:63], v4 offset:41984
    v_mfma_f32_16x16x32_bf16 v[32:35], v[64:67], v[144:147], v[32:35]
    v_mfma_f32_16x16x32_bf16 v[36:39], v[64:67], v[148:151], v[36:39]
    ds_read_b128 v[64:67], v5 offset:43008
    v_mfma_f32_16x16x32_bf16 v[40:43], v[68:71], v[144:147], v[40:43]
    buffer_load_dwordx4 v[132:135], v6, s[20:23], s49 offen offset:256 sc1
    v_mfma_f32_16x16x32_bf16 v[44:47], v[68:71], v[148:151], v[44:47]
    ds_read_b128 v[68:71], v5 offset:44032
    v_mfma_f32_16x16x32_bf16 v[48:51], v[72:75], v[144:147], v[48:51]
    s_add_u32 s49, s49, 4096
    v_mfma_f32_16x16x32_bf16 v[52:55], v[72:75], v[148:151], v[52:55]
    s_waitcnt vmcnt(10) lgkmcnt(4)
    v_mfma_f32_16x16x32_bf16 v[16:19], v[76:79], v[152:155], v[16:19]
    ds_read_b128 v[72:75], v5 offset:45056
    v_add_u32 v4, 51200, v4
    v_add_u32 v5, 51200, v5
    v_mfma_f32_16x16x32_bf16 v[20:23], v[76:79], v[156:159], v[20:23]
    ds_read_b128 v[76:79], v4 offset:0
    v_mfma_f32_16x16x32_bf16 v[24:27], v[80:83], v[152:155], v[24:27]
    buffer_load_dwordx4 v[136:139], v6, s[20:23], s49 offen offset:0 sc1
    v_mfma_f32_16x16x32_bf16 v[28:31], v[80:83], v[156:159], v[28:31]
    ds_read_b128 v[80:83], v4 offset:1024
    v_mfma_f32_16x16x32_bf16 v[32:35], v[84:87], v[152:155], v[32:35]
    v_mfma_f32_16x16x32_bf16 v[36:39], v[84:87], v[156:159], v[36:39]
    ds_read_b128 v[84:87], v5 offset:2048
    v_mfma_f32_16x16x32_bf16 v[40:43], v[88:91], v[152:155], v[40:43]
    buffer_load_dwordx4 v[140:143], v6, s[20:23], s49 offen offset:256 sc1
    v_mfma_f32_16x16x32_bf16 v[44:47], v[88:91], v[156:159], v[44:47]
    ds_read_b128 v[88:91], v5 offset:3072
    v_mfma_f32_16x16x32_bf16 v[48:51], v[92:95], v[152:155], v[48:51]
    s_add_u32 s49, s49, 12288
    v_mfma_f32_16x16x32_bf16 v[52:55], v[92:95], v[156:159], v[52:55]
    ds_read_b128 v[92:95], v5 offset:4096
    s_waitcnt vmcnt(10) lgkmcnt(0)
    s_barrier
    v_mfma_f32_16x16x32_bf16 v[16:19], v[56:59], v[96:99], v[16:19]
    v_subrev_u32 v4, 153600, v4
    v_subrev_u32 v5, 153600, v5
    v_mfma_f32_16x16x32_bf16 v[20:23], v[56:59], v[100:103], v[20:23]
    ds_read_b128 v[56:59], v4 offset:0
    v_mfma_f32_16x16x32_bf16 v[24:27], v[60:63], v[96:99], v[24:27]
    buffer_load_dwordx4 v[144:147], v6, s[20:23], s49 offen offset:0 sc1
    v_mfma_f32_16x16x32_bf16 v[28:31], v[60:63], v[100:103], v[28:31]
    ds_read_b128 v[60:63], v4 offset:1024
    v_mfma_f32_16x16x32_bf16 v[32:35], v[64:67], v[96:99], v[32:35]
    v_mfma_f32_16x16x32_bf16 v[36:39], v[64:67], v[100:103], v[36:39]
    ds_read_b128 v[64:67], v5 offset:2048
    v_mfma_f32_16x16x32_bf16 v[40:43], v[68:71], v[96:99], v[40:43]
    buffer_load_dwordx4 v[148:151], v6, s[20:23], s49 offen offset:256 sc1
    v_mfma_f32_16x16x32_bf16 v[44:47], v[68:71], v[100:103], v[44:47]
    ds_read_b128 v[68:71], v5 offset:3072
    v_mfma_f32_16x16x32_bf16 v[48:51], v[72:75], v[96:99], v[48:51]
    s_add_u32 s49, s49, 4096
    v_mfma_f32_16x16x32_bf16 v[52:55], v[72:75], v[100:103], v[52:55]
    s_waitcnt vmcnt(10) lgkmcnt(4)
    v_mfma_f32_16x16x32_bf16 v[16:19], v[76:79], v[104:107], v[16:19]
    ds_read_b128 v[72:75], v5 offset:4096
    v_mfma_f32_16x16x32_bf16 v[20:23], v[76:79], v[108:111], v[20:23]
    ds_read_b128 v[76:79], v4 offset:10240
    v_mfma_f32_16x16x32_bf16 v[24:27], v[80:83], v[104:107], v[24:27]
    buffer_load_dwordx4 v[152:155], v6, s[20:23], s49 offen offset:0 sc1
    v_mfma_f32_16x16x32_bf16 v[28:31], v[80:83], v[108:111], v[28:31]
    ds_read_b128 v[80:83], v4 offset:11264
    v_mfma_f32_16x16x32_bf16 v[32:35], v[84:87], v[104:107], v[32:35]
    v_mfma_f32_16x16x32_bf16 v[36:39], v[84:87], v[108:111], v[36:39]
    ds_read_b128 v[84:87], v5 offset:12288
    v_mfma_f32_16x16x32_bf16 v[40:43], v[88:91], v[104:107], v[40:43]
    buffer_load_dwordx4 v[156:159], v6, s[20:23], s49 offen offset:256 sc1
    v_mfma_f32_16x16x32_bf16 v[44:47], v[88:91], v[108:111], v[44:47]
    ds_read_b128 v[88:91], v5 offset:13312
    v_mfma_f32_16x16x32_bf16 v[48:51], v[92:95], v[104:107], v[48:51]
    s_add_u32 s49, s49, 12288
    v_mfma_f32_16x16x32_bf16 v[52:55], v[92:95], v[108:111], v[52:55]
    s_waitcnt vmcnt(10) lgkmcnt(4)
    v_mfma_f32_16x16x32_bf16 v[16:19], v[56:59], v[112:115], v[16:19]
    ds_read_b128 v[92:95], v5 offset:14336
    v_mfma_f32_16x16x32_bf16 v[20:23], v[56:59], v[116:119], v[20:23]
    ds_read_b128 v[56:59], v4 offset:20480
    v_mfma_f32_16x16x32_bf16 v[24:27], v[60:63], v[112:115], v[24:27]
    buffer_load_dwordx4 v[96:99], v6, s[20:23], s49 offen offset:0 sc1
    v_mfma_f32_16x16x32_bf16 v[28:31], v[60:63], v[116:119], v[28:31]
    ds_read_b128 v[60:63], v4 offset:21504
    v_mfma_f32_16x16x32_bf16 v[32:35], v[64:67], v[112:115], v[32:35]
    v_mfma_f32_16x16x32_bf16 v[36:39], v[64:67], v[116:119], v[36:39]
    ds_read_b128 v[64:67], v5 offset:22528
    v_mfma_f32_16x16x32_bf16 v[40:43], v[68:71], v[112:115], v[40:43]
    buffer_load_dwordx4 v[100:103], v6, s[20:23], s49 offen offset:256 sc1
    v_mfma_f32_16x16x32_bf16 v[44:47], v[68:71], v[116:119], v[44:47]
    ds_read_b128 v[68:71], v5 offset:23552
    v_mfma_f32_16x16x32_bf16 v[48:51], v[72:75], v[112:115], v[48:51]
    s_add_u32 s49, s49, 4096
    v_mfma_f32_16x16x32_bf16 v[52:55], v[72:75], v[116:119], v[52:55]
    s_waitcnt vmcnt(10) lgkmcnt(4)
    v_mfma_f32_16x16x32_bf16 v[16:19], v[76:79], v[120:123], v[16:19]
    ds_read_b128 v[72:75], v5 offset:24576
    v_mfma_f32_16x16x32_bf16 v[20:23], v[76:79], v[124:127], v[20:23]
    ds_read_b128 v[76:79], v4 offset:30720
    v_mfma_f32_16x16x32_bf16 v[24:27], v[80:83], v[120:123], v[24:27]
    buffer_load_dwordx4 v[104:107], v6, s[20:23], s49 offen offset:0 sc1
    v_mfma_f32_16x16x32_bf16 v[28:31], v[80:83], v[124:127], v[28:31]
    ds_read_b128 v[80:83], v4 offset:31744
    v_mfma_f32_16x16x32_bf16 v[32:35], v[84:87], v[120:123], v[32:35]
    v_mfma_f32_16x16x32_bf16 v[36:39], v[84:87], v[124:127], v[36:39]
    ds_read_b128 v[84:87], v5 offset:32768
    v_mfma_f32_16x16x32_bf16 v[40:43], v[88:91], v[120:123], v[40:43]
    buffer_load_dwordx4 v[108:111], v6, s[20:23], s49 offen offset:256 sc1
    v_mfma_f32_16x16x32_bf16 v[44:47], v[88:91], v[124:127], v[44:47]
    ds_read_b128 v[88:91], v5 offset:33792
    v_mfma_f32_16x16x32_bf16 v[48:51], v[92:95], v[120:123], v[48:51]
    s_add_u32 s49, s49, 12288
    v_mfma_f32_16x16x32_bf16 v[52:55], v[92:95], v[124:127], v[52:55]
    s_waitcnt vmcnt(10) lgkmcnt(4)
    v_mfma_f32_16x16x32_bf16 v[16:19], v[56:59], v[128:131], v[16:19]
    ds_read_b128 v[92:95], v5 offset:34816
    v_mfma_f32_16x16x32_bf16 v[20:23], v[56:59], v[132:135], v[20:23]
    ds_read_b128 v[56:59], v4 offset:40960
    v_mfma_f32_16x16x32_bf16 v[24:27], v[60:63], v[128:131], v[24:27]
    buffer_load_dwordx4 v[112:115], v6, s[20:23], s49 offen offset:0 sc1
    v_mfma_f32_16x16x32_bf16 v[28:31], v[60:63], v[132:135], v[28:31]
    ds_read_b128 v[60:63], v4 offset:41984
    v_mfma_f32_16x16x32_bf16 v[32:35], v[64:67], v[128:131], v[32:35]
    v_mfma_f32_16x16x32_bf16 v[36:39], v[64:67], v[132:135], v[36:39]
    ds_read_b128 v[64:67], v5 offset:43008
    v_mfma_f32_16x16x32_bf16 v[40:43], v[68:71], v[128:131], v[40:43]
    buffer_load_dwordx4 v[116:119], v6, s[20:23], s49 offen offset:256 sc1
    v_mfma_f32_16x16x32_bf16 v[44:47], v[68:71], v[132:135], v[44:47]
    ds_read_b128 v[68:71], v5 offset:44032
    v_mfma_f32_16x16x32_bf16 v[48:51], v[72:75], v[128:131], v[48:51]
    v_mfma_f32_16x16x32_bf16 v[52:55], v[72:75], v[132:135], v[52:55]
    s_waitcnt vmcnt(10) lgkmcnt(4)
    v_mfma_f32_16x16x32_bf16 v[16:19], v[76:79], v[136:139], v[16:19]
    ds_read_b128 v[72:75], v5 offset:45056
    v_add_u32 v4, 51200, v4
    v_add_u32 v5, 51200, v5
    v_mfma_f32_16x16x32_bf16 v[20:23], v[76:79], v[140:143], v[20:23]
    ds_read_b128 v[76:79], v4 offset:0
    v_mfma_f32_16x16x32_bf16 v[24:27], v[80:83], v[136:139], v[24:27]
    v_mfma_f32_16x16x32_bf16 v[28:31], v[80:83], v[140:143], v[28:31]
    ds_read_b128 v[80:83], v4 offset:1024
    v_mfma_f32_16x16x32_bf16 v[32:35], v[84:87], v[136:139], v[32:35]
    v_mfma_f32_16x16x32_bf16 v[36:39], v[84:87], v[140:143], v[36:39]
    ds_read_b128 v[84:87], v5 offset:2048
    v_mfma_f32_16x16x32_bf16 v[40:43], v[88:91], v[136:139], v[40:43]
    v_mfma_f32_16x16x32_bf16 v[44:47], v[88:91], v[140:143], v[44:47]
    ds_read_b128 v[88:91], v5 offset:3072
    v_mfma_f32_16x16x32_bf16 v[48:51], v[92:95], v[136:139], v[48:51]
    v_mfma_f32_16x16x32_bf16 v[52:55], v[92:95], v[140:143], v[52:55]
    s_waitcnt vmcnt(8) lgkmcnt(4)
    v_mfma_f32_16x16x32_bf16 v[16:19], v[56:59], v[144:147], v[16:19]
    ds_read_b128 v[92:95], v5 offset:4096
    v_mfma_f32_16x16x32_bf16 v[20:23], v[56:59], v[148:151], v[20:23]
    ds_read_b128 v[56:59], v4 offset:10240
    v_mfma_f32_16x16x32_bf16 v[24:27], v[60:63], v[144:147], v[24:27]
    v_mfma_f32_16x16x32_bf16 v[28:31], v[60:63], v[148:151], v[28:31]
    ds_read_b128 v[60:63], v4 offset:11264
    v_mfma_f32_16x16x32_bf16 v[32:35], v[64:67], v[144:147], v[32:35]
    v_mfma_f32_16x16x32_bf16 v[36:39], v[64:67], v[148:151], v[36:39]
    ds_read_b128 v[64:67], v5 offset:12288
    v_mfma_f32_16x16x32_bf16 v[40:43], v[68:71], v[144:147], v[40:43]
    v_mfma_f32_16x16x32_bf16 v[44:47], v[68:71], v[148:151], v[44:47]
    ds_read_b128 v[68:71], v5 offset:13312
    v_mfma_f32_16x16x32_bf16 v[48:51], v[72:75], v[144:147], v[48:51]
    v_mfma_f32_16x16x32_bf16 v[52:55], v[72:75], v[148:151], v[52:55]
    s_waitcnt vmcnt(6) lgkmcnt(4)
    v_mfma_f32_16x16x32_bf16 v[16:19], v[76:79], v[152:155], v[16:19]
    ds_read_b128 v[72:75], v5 offset:14336
    v_mfma_f32_16x16x32_bf16 v[20:23], v[76:79], v[156:159], v[20:23]
    ds_read_b128 v[76:79], v4 offset:20480
    v_mfma_f32_16x16x32_bf16 v[24:27], v[80:83], v[152:155], v[24:27]
    v_mfma_f32_16x16x32_bf16 v[28:31], v[80:83], v[156:159], v[28:31]
    ds_read_b128 v[80:83], v4 offset:21504
    v_mfma_f32_16x16x32_bf16 v[32:35], v[84:87], v[152:155], v[32:35]
    v_mfma_f32_16x16x32_bf16 v[36:39], v[84:87], v[156:159], v[36:39]
    ds_read_b128 v[84:87], v5 offset:22528
    v_mfma_f32_16x16x32_bf16 v[40:43], v[88:91], v[152:155], v[40:43]
    v_mfma_f32_16x16x32_bf16 v[44:47], v[88:91], v[156:159], v[44:47]
    ds_read_b128 v[88:91], v5 offset:23552
    v_mfma_f32_16x16x32_bf16 v[48:51], v[92:95], v[152:155], v[48:51]
    v_mfma_f32_16x16x32_bf16 v[52:55], v[92:95], v[156:159], v[52:55]
    s_waitcnt vmcnt(4) lgkmcnt(4)
    v_mfma_f32_16x16x32_bf16 v[16:19], v[56:59], v[96:99], v[16:19]
    ds_read_b128 v[92:95], v5 offset:24576
    v_mfma_f32_16x16x32_bf16 v[20:23], v[56:59], v[100:103], v[20:23]
    ds_read_b128 v[56:59], v4 offset:30720
    v_mfma_f32_16x16x32_bf16 v[24:27], v[60:63], v[96:99], v[24:27]
    v_mfma_f32_16x16x32_bf16 v[28:31], v[60:63], v[100:103], v[28:31]
    ds_read_b128 v[60:63], v4 offset:31744
    v_mfma_f32_16x16x32_bf16 v[32:35], v[64:67], v[96:99], v[32:35]
    v_mfma_f32_16x16x32_bf16 v[36:39], v[64:67], v[100:103], v[36:39]
    ds_read_b128 v[64:67], v5 offset:32768
    v_mfma_f32_16x16x32_bf16 v[40:43], v[68:71], v[96:99], v[40:43]
    v_mfma_f32_16x16x32_bf16 v[44:47], v[68:71], v[100:103], v[44:47]
    ds_read_b128 v[68:71], v5 offset:33792
    v_mfma_f32_16x16x32_bf16 v[48:51], v[72:75], v[96:99], v[48:51]
    v_mfma_f32_16x16x32_bf16 v[52:55], v[72:75], v[100:103], v[52:55]
    ds_read_b128 v[72:75], v5 offset:34816
    s_waitcnt vmcnt(2) lgkmcnt(5)
    v_mfma_f32_16x16x32_bf16 v[40:43], v[88:91], v[104:107], v[40:43]
    v_mfma_f32_16x16x32_bf16 v[44:47], v[88:91], v[108:111], v[44:47]
    v_mfma_f32_16x16x32_bf16 v[48:51], v[92:95], v[104:107], v[48:51]
    v_mfma_f32_16x16x32_bf16 v[52:55], v[92:95], v[108:111], v[52:55]
    v_mfma_f32_16x16x32_bf16 v[32:35], v[84:87], v[104:107], v[32:35]
    v_mfma_f32_16x16x32_bf16 v[36:39], v[84:87], v[108:111], v[36:39]
    s_waitcnt vmcnt(0) lgkmcnt(0)
    v_mfma_f32_16x16x32_bf16 v[40:43], v[68:71], v[112:115], v[40:43]
    v_mfma_f32_16x16x32_bf16 v[44:47], v[68:71], v[116:119], v[44:47]
    v_mfma_f32_16x16x32_bf16 v[48:51], v[72:75], v[112:115], v[48:51]
    v_mfma_f32_16x16x32_bf16 v[52:55], v[72:75], v[116:119], v[52:55]
    v_mfma_f32_16x16x32_bf16 v[32:35], v[64:67], v[112:115], v[32:35]
    v_mfma_f32_16x16x32_bf16 v[36:39], v[64:67], v[116:119], v[36:39]
    v_mfma_f32_16x16x32_bf16 v[16:19], v[76:79], v[104:107], v[16:19]
    v_mfma_f32_16x16x32_bf16 v[20:23], v[76:79], v[108:111], v[20:23]
    v_mfma_f32_16x16x32_bf16 v[24:27], v[80:83], v[104:107], v[24:27]
    v_mfma_f32_16x16x32_bf16 v[28:31], v[80:83], v[108:111], v[28:31]
    ds_write_b128 v14, v[40:43] offset:2048
    v_mfma_f32_16x16x32_bf16 v[16:19], v[56:59], v[112:115], v[16:19]
    ds_write_b128 v14, v[44:47] offset:3072
    v_mfma_f32_16x16x32_bf16 v[20:23], v[56:59], v[116:119], v[20:23]
    ds_write_b128 v14, v[48:51] offset:4096
    v_mfma_f32_16x16x32_bf16 v[24:27], v[60:63], v[112:115], v[24:27]
    ds_write_b128 v14, v[52:55] offset:5120
    v_mfma_f32_16x16x32_bf16 v[28:31], v[60:63], v[116:119], v[28:31]
    s_cmp_eq_u32 s44, 0
    s_cbranch_scc1 L_f2_x
    ds_write_b128 v14, v[32:35] offset:0
    ds_write_b128 v14, v[36:39] offset:1024
L_f2_x:
    s_waitcnt lgkmcnt(0)
    s_barrier
    ds_read_b128 v[56:59], v15 offset:0
    ds_read_b128 v[60:63], v15 offset:1024
    ds_read_b128 v[64:67], v15 offset:2048
    ds_read_b128 v[68:71], v15 offset:3072
    ds_read_b128 v[72:75], v15 offset:4096
    ds_read_b128 v[76:79], v15 offset:5120
    s_waitcnt lgkmcnt(4)
    v_pk_add_f32 v[16:17], v[16:17], v[56:57]
    v_pk_add_f32 v[18:19], v[18:19], v[58:59]
    v_pk_add_f32 v[20:21], v[20:21], v[60:61]
    v_pk_add_f32 v[22:23], v[22:23], v[62:63]
    v_pk_fma_f32 v[192:193], v[16:17], v[160:161], v[192:193]
    v_pk_fma_f32 v[194:195], v[18:19], v[162:163], v[194:195]
    v_pk_fma_f32 v[196:197], v[20:21], v[164:165], v[196:197]
    v_pk_fma_f32 v[198:199], v[22:23], v[166:167], v[198:199]
    v_cvt_pk_bf16_f32 v96, v192, v193
    v_cvt_pk_bf16_f32 v97, v194, v195
    v_cvt_pk_bf16_f32 v98, v196, v197
    v_cvt_pk_bf16_f32 v99, v198, v199
    s_nop 0
    v_permlane16_swap_b32 v96, v98
    v_permlane16_swap_b32 v97, v99
    buffer_store_dwordx4 v[96:99], v7, s[28:31], s54 offen offset:0
    s_waitcnt lgkmcnt(2)
    v_pk_add_f32 v[24:25], v[24:25], v[64:65]
    v_pk_add_f32 v[26:27], v[26:27], v[66:67]
    v_pk_add_f32 v[28:29], v[28:29], v[68:69]
    v_pk_add_f32 v[30:31], v[30:31], v[70:71]
    v_pk_fma_f32 v[200:201], v[24:25], v[168:169], v[200:201]
    v_pk_fma_f32 v[202:203], v[26:27], v[170:171], v[202:203]
    v_pk_fma_f32 v[204:205], v[28:29], v[172:173], v[204:205]
    v_pk_fma_f32 v[206:207], v[30:31], v[174:175], v[206:207]
    v_cvt_pk_bf16_f32 v100, v200, v201
    v_cvt_pk_bf16_f32 v101, v202, v203
    v_cvt_pk_bf16_f32 v102, v204, v205
    v_cvt_pk_bf16_f32 v103, v206, v207
    s_nop 0
    v_permlane16_swap_b32 v100, v102
    v_permlane16_swap_b32 v101, v103
    buffer_store_dwordx4 v[100:103], v7, s[28:31], s54 offen offset:32
    s_cmp_eq_u32 s44, 1
    s_cbranch_scc1 L_f2_two
    s_waitcnt lgkmcnt(0)
    v_pk_add_f32 v[32:33], v[32:33], v[72:73]
    v_pk_add_f32 v[34:35], v[34:35], v[74:75]
    v_pk_add_f32 v[36:37], v[36:37], v[76:77]
    v_pk_add_f32 v[38:39], v[38:39], v[78:79]
    v_pk_fma_f32 v[208:209], v[32:33], v[176:177], v[208:209]
    v_pk_fma_f32 v[210:211], v[34:35], v[178:179], v[210:211]
    v_pk_fma_f32 v[212:213], v[36:37], v[180:181], v[212:213]
    v_pk_fma_f32 v[214:215], v[38:39], v[182:183], v[214:215]
    v_cvt_pk_bf16_f32 v104, v208, v209
    v_cvt_pk_bf16_f32 v105, v210, v211
    v_cvt_pk_bf16_f32 v106, v212, v213
    v_cvt_pk_bf16_f32 v107, v214, v215
    s_nop 0
    v_permlane16_swap_b32 v104, v106
    v_permlane16_swap_b32 v105, v107
    buffer_store_dwordx4 v[104:107], v7, s[28:31], s54 offen offset:64
L_f2_two:
    s_or_b32 s52, s2, s40
    s_cmp_eq_u32 s52, 0
    s_cbranch_scc0 L_end
    s_mov_b32 s52, 81920
    v_mov_b32 v12, s3
    v_mov_b32 v13, s52
    s_mov_b64 exec, 1
    buffer_store_dword v12, v13, s[20:23], 0 offen sc0 sc1
    s_mov_b64 exec, -1
L_end:
    s_endpgm
L_vec:
    v_subrev_u32 v2, 64, v0
    v_min_u32 v2, 159, v2
    v_lshlrev_b32 v3, 3, v2
    v_lshlrev_b32 v2, 4, v2
    v_add_u32 v3, 114688, v3
    s_and_b32 s4, s3, 0xff
    s_bfe_u32 s5, s3, 0x80008
    s_bfe_u32 s6, s3, 0x80010
    s_lshr_b32 s7, s3, 24
    s_mov_b32 s62, 0
L_gatherb:
    s_mov_b32 s61, 7680
    buffer_load_dwordx4 v[48:51], v2, s[20:23], s61 offen sc0 sc1
    s_mov_b32 s61, 23040
    buffer_load_dwordx4 v[52:55], v2, s[20:23], s61 offen sc0 sc1
    s_mov_b32 s61, 38400
    buffer_load_dwordx4 v[56:59], v2, s[20:23], s61 offen sc0 sc1
    s_mov_b32 s61, 53760
    buffer_load_dwordx4 v[60:63], v2, s[20:23], s61 offen sc0 sc1
    s_mov_b32 s61, 10240
    buffer_load_dwordx4 v[64:67], v2, s[20:23], s61 offen sc0 sc1
    s_mov_b32 s61, 25600
    buffer_load_dwordx4 v[68:71], v2, s[20:23], s61 offen sc0 sc1
    s_mov_b32 s61, 40960
    buffer_load_dwordx4 v[72:75], v2, s[20:23], s61 offen sc0 sc1
    s_mov_b32 s61, 56320
    buffer_load_dwordx4 v[76:79], v2, s[20:23], s61 offen sc0 sc1
    s_add_u32 s62, s62, 1
    s_waitcnt vmcnt(7)
    v_xor_b32 v48, s4, v48
    v_xor_b32 v49, s5, v49
    v_xor_b32 v50, s6, v50
    v_xor_b32 v51, s7, v51
    v_or3_b32 v10, v48, v49, 0
    v_or3_b32 v10, v50, v51, v10
    s_waitcnt vmcnt(6)
    v_xor_b32 v52, s4, v52
    v_xor_b32 v53, s5, v53
    v_xor_b32 v54, s6, v54
    v_xor_b32 v55, s7, v55
    v_or3_b32 v10, v52, v53, v10
    v_or3_b32 v10, v54, v55, v10
    s_waitcnt vmcnt(5)
    v_xor_b32 v56, s4, v56
    v_xor_b32 v57, s5, v57
    v_xor_b32 v58, s6, v58
    v_xor_b32 v59, s7, v59
    v_or3_b32 v10, v56, v57, v10
    v_or3_b32 v10, v58, v59, v10
    s_waitcnt vmcnt(4)
    v_xor_b32 v60, s4, v60
    v_xor_b32 v61, s5, v61
    v_xor_b32 v62, s6, v62
    v_xor_b32 v63, s7, v63
    v_or3_b32 v10, v60, v61, v10
    v_or3_b32 v10, v62, v63, v10
    s_waitcnt vmcnt(3)
    v_xor_b32 v64, s4, v64
    v_xor_b32 v65, s5, v65
    v_xor_b32 v66, s6, v66
    v_xor_b32 v67, s7, v67
    v_or3_b32 v10, v64, v65, v10
    v_or3_b32 v10, v66, v67, v10
    s_waitcnt vmcnt(2)
    v_xor_b32 v68, s4, v68
    v_xor_b32 v69, s5, v69
    v_xor_b32 v70, s6, v70
    v_xor_b32 v71, s7, v71
    v_or3_b32 v10, v68, v69, v10
    v_or3_b32 v10, v70, v71, v10
    s_waitcnt vmcnt(1)
    v_xor_b32 v72, s4, v72
    v_xor_b32 v73, s5, v73
    v_xor_b32 v74, s6, v74
    v_xor_b32 v75, s7, v75
    v_or3_b32 v10, v72, v73, v10
    v_or3_b32 v10, v74, v75, v10
    s_waitcnt vmcnt(0)
    v_xor_b32 v76, s4, v76
    v_xor_b32 v77, s5, v77
    v_xor_b32 v78, s6, v78
    v_xor_b32 v79, s7, v79
    v_or3_b32 v10, v76, v77, v10
    v_or3_b32 v10, v78, v79, v10
    v_and_b32 v10, 0xff, v10
    v_cmp_ne_u32 vcc, 0, v10
    s_cmp_gt_u32 s62, 400000
    s_cbranch_scc1 L_gatherb_done
    s_cbranch_vccz L_gatherb_done
    s_sleep 6
    s_branch L_gatherb
L_gatherb_done:
    v_pk_add_f32 v[48:49], v[48:49], v[52:53]
    v_pk_add_f32 v[56:57], v[56:57], v[60:61]
    v_pk_add_f32 v[50:51], v[50:51], v[54:55]
    v_pk_add_f32 v[58:59], v[58:59], v[62:63]
    v_pk_add_f32 v[48:49], v[48:49], v[56:57]
    v_pk_add_f32 v[50:51], v[50:51], v[58:59]
    v_cvt_pk_bf16_f32 v52, v48, v49
    v_cvt_pk_bf16_f32 v53, v50, v51
    v_lshlrev_b32 v48, 16, v52
    v_and_b32 v49, 0xffff0000, v52
    v_lshlrev_b32 v50, 16, v53
    v_and_b32 v51, 0xffff0000, v53
    v_pk_add_f32 v[64:65], v[64:65], v[68:69]
    v_pk_add_f32 v[72:73], v[72:73], v[76:77]
    v_pk_add_f32 v[66:67], v[66:67], v[70:71]
    v_pk_add_f32 v[74:75], v[74:75], v[78:79]
    v_pk_add_f32 v[64:65], v[64:65], v[72:73]
    v_pk_add_f32 v[66:67], v[66:67], v[74:75]
    v_cvt_pk_bf16_f32 v68, v64, v65
    v_cvt_pk_bf16_f32 v69, v66, v67
    v_lshlrev_b32 v64, 16, v68
    v_and_b32 v65, 0xffff0000, v68
    v_lshlrev_b32 v66, 16, v69
    v_and_b32 v67, 0xffff0000, v69
    v_add_f32 v64, 1.0, v64
    v_add_f32 v65, 1.0, v65
    v_add_f32 v66, 1.0, v66
    v_add_f32 v67, 1.0, v67
    v_cvt_pk_bf16_f32 v68, v64, v65
    v_cvt_pk_bf16_f32 v69, v66, v67
    v_lshlrev_b32 v64, 16, v68
    v_and_b32 v65, 0xffff0000, v68
    v_lshlrev_b32 v66, 16, v69
    v_and_b32 v67, 0xffff0000, v69
    ds_write_b64 v3, v[52:53] offset:1280
    ds_write_b64 v3, v[68:69]
    s_waitcnt lgkmcnt(0)
    s_branch L_vec_done
L_f1_skip:
    v_bfe_u32 v10, v1, 4, 1
    v_mul_u32_u24 v10, 1280, v10
    v_lshrrev_b32 v11, 5, v1
    v_lshl_add_u32 v10, v11, 4, v10
    v_and_b32 v11, 15, v1
    v_lshl_add_u32 v10, v11, 5, v10
    v_add_u32 v10, 114688, v10
    ds_read_b128 v[216:219], v10 offset:0
    ds_read_b128 v[220:223], v10 offset:512
    ds_read_b128 v[224:227], v10 offset:1024
    s_and_b32 s58, s41, 8
    s_lshl_b32 s58, s58, 10
    s_xor_b32 s58, s58, s99
    s_lshl_b32 s59, s42, 9
    s_add_u32 s58, s58, s59
    s_add_u32 s58, s58, 29917184
    v_lshrrev_b32 v10, 5, v1
    v_lshl_add_u32 v10, v10, 14, s58
    v_and_b32 v11, 31, v1
    v_lshl_add_u32 v126, v11, 2, v10
    v_and_b32 v11, 3, v1
    v_lshlrev_b32 v11, 3, v11
    v_bfe_u32 v127, s3, v11, 8
    s_lshl_b32 s54, s40, 6
    v_xor_b32 v4, s54, v4
    v_add_u32 v4, 131072, v4
    ds_read_b64_tr_b16 v[80:81], v4 offset:0
    ds_read_b64_tr_b16 v[82:83], v4 offset:1024
    ds_read_b64_tr_b16 v[84:85], v4 offset:4096
    ds_read_b64_tr_b16 v[86:87], v4 offset:5120
    ds_read_b64_tr_b16 v[88:89], v4 offset:8192
    ds_read_b64_tr_b16 v[90:91], v4 offset:9216
    ds_read_b64_tr_b16 v[92:93], v4 offset:12288
    ds_read_b64_tr_b16 v[94:95], v4 offset:13312
    s_waitcnt lgkmcnt(8)
    v_mov_b32_dpp v128, v216 row_newbcast:0 row_mask:0xf bank_mask:0xf
    v_mov_b32_dpp v129, v217 row_newbcast:0 row_mask:0xf bank_mask:0xf
    v_mov_b32_dpp v130, v218 row_newbcast:0 row_mask:0xf bank_mask:0xf
    v_mov_b32_dpp v131, v219 row_newbcast:0 row_mask:0xf bank_mask:0xf
    s_nop 0
    s_waitcnt lgkmcnt(6)
    s_barrier
    v_mfma_f32_32x32x16_bf16 v[16:31], v[128:131], v[80:83], 0
    v_mov_b32_dpp v132, v216 row_newbcast:1 row_mask:0xf bank_mask:0xf
    v_mov_b32_dpp v133, v217 row_newbcast:1 row_mask:0xf bank_mask:0xf
    v_mov_b32_dpp v134, v218 row_newbcast:1 row_mask:0xf bank_mask:0xf
    v_mov_b32_dpp v135, v219 row_newbcast:1 row_mask:0xf bank_mask:0xf
    ds_read_b64_tr_b16 v[80:81], v4 offset:16384
    ds_read_b64_tr_b16 v[82:83], v4 offset:17408
    s_waitcnt lgkmcnt(6)
    v_mfma_f32_32x32x16_bf16 v[16:31], v[132:135], v[84:87], v[16:31]
    v_mov_b32_dpp v128, v216 row_newbcast:2 row_mask:0xf bank_mask:0xf
    v_mov_b32_dpp v129, v217 row_newbcast:2 row_mask:0xf bank_mask:0xf
    v_mov_b32_dpp v130, v218 row_newbcast:2 row_mask:0xf bank_mask:0xf
    v_mov_b32_dpp v131, v219 row_newbcast:2 row_mask:0xf bank_mask:0xf
    ds_read_b64_tr_b16 v[84:85], v4 offset:20480
    ds_read_b64_tr_b16 v[86:87], v4 offset:21504
    s_waitcnt lgkmcnt(6)
    v_mfma_f32_32x32x16_bf16 v[16:31], v[128:131], v[88:91], v[16:31]
    v_mov_b32_dpp v132, v216 row_newbcast:3 row_mask:0xf bank_mask:0xf
    v_mov_b32_dpp v133, v217 row_newbcast:3 row_mask:0xf bank_mask:0xf
    v_mov_b32_dpp v134, v218 row_newbcast:3 row_mask:0xf bank_mask:0xf
    v_mov_b32_dpp v135, v219 row_newbcast:3 row_mask:0xf bank_mask:0xf
    ds_read_b64_tr_b16 v[88:89], v4 offset:24576
    ds_read_b64_tr_b16 v[90:91], v4 offset:25600
    s_waitcnt lgkmcnt(6)
    v_mfma_f32_32x32x16_bf16 v[16:31], v[132:135], v[92:95], v[16:31]
    v_mov_b32_dpp v128, v216 row_newbcast:4 row_mask:0xf bank_mask:0xf
    v_mov_b32_dpp v129, v217 row_newbcast:4 row_mask:0xf bank_mask:0xf
    v_mov_b32_dpp v130, v218 row_newbcast:4 row_mask:0xf bank_mask:0xf
    v_mov_b32_dpp v131, v219 row_newbcast:4 row_mask:0xf bank_mask:0xf
    ds_read_b64_tr_b16 v[92:93], v4 offset:28672
    ds_read_b64_tr_b16 v[94:95], v4 offset:29696
    s_waitcnt lgkmcnt(6)
    v_mfma_f32_32x32x16_bf16 v[16:31], v[128:131], v[80:83], v[16:31]
    v_mov_b32_dpp v132, v216 row_newbcast:5 row_mask:0xf bank_mask:0xf
    v_mov_b32_dpp v133, v217 row_newbcast:5 row_mask:0xf bank_mask:0xf
    v_mov_b32_dpp v134, v218 row_newbcast:5 row_mask:0xf bank_mask:0xf
    v_mov_b32_dpp v135, v219 row_newbcast:5 row_mask:0xf bank_mask:0xf
    v_subrev_u32 v4, 131072, v4
    ds_read_b64_tr_b16 v[80:81], v4 offset:0
    ds_read_b64_tr_b16 v[82:83], v4 offset:1024
    s_waitcnt lgkmcnt(6)
    v_mfma_f32_32x32x16_bf16 v[16:31], v[132:135], v[84:87], v[16:31]
    v_mov_b32_dpp v128, v216 row_newbcast:6 row_mask:0xf bank_mask:0xf
    v_mov_b32_dpp v129, v217 row_newbcast:6 row_mask:0xf bank_mask:0xf
    v_mov_b32_dpp v130, v218 row_newbcast:6 row_mask:0xf bank_mask:0xf
    v_mov_b32_dpp v131, v219 row_newbcast:6 row_mask:0xf bank_mask:0xf
    ds_read_b64_tr_b16 v[84:85], v4 offset:4096
    ds_read_b64_tr_b16 v[86:87], v4 offset:5120
    s_waitcnt lgkmcnt(6)
    v_mfma_f32_32x32x16_bf16 v[16:31], v[128:131], v[88:91], v[16:31]
    v_mov_b32_dpp v132, v216 row_newbcast:7 row_mask:0xf bank_mask:0xf
    v_mov_b32_dpp v133, v217 row_newbcast:7 row_mask:0xf bank_mask:0xf
    v_mov_b32_dpp v134, v218 row_newbcast:7 row_mask:0xf bank_mask:0xf
    v_mov_b32_dpp v135, v219 row_newbcast:7 row_mask:0xf bank_mask:0xf
    ds_read_b64_tr_b16 v[88:89], v4 offset:8192
    ds_read_b64_tr_b16 v[90:91], v4 offset:9216
    s_waitcnt lgkmcnt(6)
    v_mfma_f32_32x32x16_bf16 v[16:31], v[132:135], v[92:95], v[16:31]
    v_mov_b32_dpp v128, v216 row_newbcast:8 row_mask:0xf bank_mask:0xf
    v_mov_b32_dpp v129, v217 row_newbcast:8 row_mask:0xf bank_mask:0xf
    v_mov_b32_dpp v130, v218 row_newbcast:8 row_mask:0xf bank_mask:0xf
    v_mov_b32_dpp v131, v219 row_newbcast:8 row_mask:0xf bank_mask:0xf
    ds_read_b64_tr_b16 v[92:93], v4 offset:12288
    ds_read_b64_tr_b16 v[94:95], v4 offset:13312
    s_waitcnt lgkmcnt(6)
    v_mfma_f32_32x32x16_bf16 v[16:31], v[128:131], v[80:83], v[16:31]
    v_mov_b32_dpp v132, v216 row_newbcast:9 row_mask:0xf bank_mask:0xf
    v_mov_b32_dpp v133, v217 row_newbcast:9 row_mask:0xf bank_mask:0xf
    v_mov_b32_dpp v134, v218 row_newbcast:9 row_mask:0xf bank_mask:0xf
    v_mov_b32_dpp v135, v219 row_newbcast:9 row_mask:0xf bank_mask:0xf
    ds_read_b64_tr_b16 v[80:81], v4 offset:16384
    ds_read_b64_tr_b16 v[82:83], v4 offset:17408
    s_waitcnt lgkmcnt(6)
    v_mfma_f32_32x32x16_bf16 v[16:31], v[132:135], v[84:87], v[16:31]
    v_mov_b32_dpp v128, v216 row_newbcast:10 row_mask:0xf bank_mask:0xf
    v_mov_b32_dpp v129, v217 row_newbcast:10 row_mask:0xf bank_mask:0xf
    v_mov_b32_dpp v130, v218 row_newbcast:10 row_mask:0xf bank_mask:0xf
    v_mov_b32_dpp v131, v219 row_newbcast:10 row_mask:0xf bank_mask:0xf
    ds_read_b64_tr_b16 v[84:85], v4 offset:20480
    ds_read_b64_tr_b16 v[86:87], v4 offset:21504
    s_waitcnt lgkmcnt(6)
    v_mfma_f32_32x32x16_bf16 v[16:31], v[128:131], v[88:91], v[16:31]
    v_mov_b32_dpp v132, v216 row_newbcast:11 row_mask:0xf bank_mask:0xf
    v_mov_b32_dpp v133, v217 row_newbcast:11 row_mask:0xf bank_mask:0xf
    v_mov_b32_dpp v134, v218 row_newbcast:11 row_mask:0xf bank_mask:0xf
    v_mov_b32_dpp v135, v219 row_newbcast:11 row_mask:0xf bank_mask:0xf
    ds_read_b64_tr_b16 v[88:89], v4 offset:24576
    ds_read_b64_tr_b16 v[90:91], v4 offset:25600
    s_waitcnt lgkmcnt(6)
    v_mfma_f32_32x32x16_bf16 v[16:31], v[132:135], v[92:95], v[16:31]
    v_mov_b32_dpp v128, v216 row_newbcast:12 row_mask:0xf bank_mask:0xf
    v_mov_b32_dpp v129, v217 row_newbcast:12 row_mask:0xf bank_mask:0xf
    v_mov_b32_dpp v130, v218 row_newbcast:12 row_mask:0xf bank_mask:0xf
    v_mov_b32_dpp v131, v219 row_newbcast:12 row_mask:0xf bank_mask:0xf
    ds_read_b64_tr_b16 v[92:93], v4 offset:28672
    ds_read_b64_tr_b16 v[94:95], v4 offset:29696
    s_waitcnt lgkmcnt(6)
    v_mfma_f32_32x32x16_bf16 v[16:31], v[128:131], v[80:83], v[16:31]
    v_mov_b32_dpp v132, v216 row_newbcast:13 row_mask:0xf bank_mask:0xf
    v_mov_b32_dpp v133, v217 row_newbcast:13 row_mask:0xf bank_mask:0xf
    v_mov_b32_dpp v134, v218 row_newbcast:13 row_mask:0xf bank_mask:0xf
    v_mov_b32_dpp v135, v219 row_newbcast:13 row_mask:0xf bank_mask:0xf
    ds_read_b64_tr_b16 v[80:81], v4 offset:32768
    ds_read_b64_tr_b16 v[82:83], v4 offset:33792
    s_waitcnt lgkmcnt(6)
    v_mfma_f32_32x32x16_bf16 v[16:31], v[132:135], v[84:87], v[16:31]
    v_mov_b32_dpp v128, v216 row_newbcast:14 row_mask:0xf bank_mask:0xf
    v_mov_b32_dpp v129, v217 row_newbcast:14 row_mask:0xf bank_mask:0xf
    v_mov_b32_dpp v130, v218 row_newbcast:14 row_mask:0xf bank_mask:0xf
    v_mov_b32_dpp v131, v219 row_newbcast:14 row_mask:0xf bank_mask:0xf
    ds_read_b64_tr_b16 v[84:85], v4 offset:36864
    ds_read_b64_tr_b16 v[86:87], v4 offset:37888
    s_waitcnt lgkmcnt(6)
    v_mfma_f32_32x32x16_bf16 v[16:31], v[128:131], v[88:91], v[16:31]
    v_mov_b32_dpp v132, v216 row_newbcast:15 row_mask:0xf bank_mask:0xf
    v_mov_b32_dpp v133, v217 row_newbcast:15 row_mask:0xf bank_mask:0xf
    v_mov_b32_dpp v134, v218 row_newbcast:15 row_mask:0xf bank_mask:0xf
    v_mov_b32_dpp v135, v219 row_newbcast:15 row_mask:0xf bank_mask:0xf
    ds_read_b64_tr_b16 v[88:89], v4 offset:40960
    ds_read_b64_tr_b16 v[90:91], v4 offset:41984
    s_waitcnt lgkmcnt(6)
    v_mfma_f32_32x32x16_bf16 v[16:31], v[132:135], v[92:95], v[16:31]
    v_mov_b32_dpp v128, v220 row_newbcast:0 row_mask:0xf bank_mask:0xf
    v_mov_b32_dpp v129, v221 row_newbcast:0 row_mask:0xf bank_mask:0xf
    v_mov_b32_dpp v130, v222 row_newbcast:0 row_mask:0xf bank_mask:0xf
    v_mov_b32_dpp v131, v223 row_newbcast:0 row_mask:0xf bank_mask:0xf
    ds_read_b64_tr_b16 v[92:93], v4 offset:45056
    ds_read_b64_tr_b16 v[94:95], v4 offset:46080
    s_waitcnt lgkmcnt(6)
    v_mfma_f32_32x32x16_bf16 v[16:31], v[128:131], v[80:83], v[16:31]
    v_mov_b32_dpp v132, v220 row_newbcast:1 row_mask:0xf bank_mask:0xf
    v_mov_b32_dpp v133, v221 row_newbcast:1 row_mask:0xf bank_mask:0xf
    v_mov_b32_dpp v134, v222 row_newbcast:1 row_mask:0xf bank_mask:0xf
    v_mov_b32_dpp v135, v223 row_newbcast:1 row_mask:0xf bank_mask:0xf
    ds_read_b64_tr_b16 v[80:81], v4 offset:49152
    ds_read_b64_tr_b16 v[82:83], v4 offset:50176
    s_waitcnt lgkmcnt(6)
    v_mfma_f32_32x32x16_bf16 v[16:31], v[132:135], v[84:87], v[16:31]
    v_mov_b32_dpp v128, v220 row_newbcast:2 row_mask:0xf bank_mask:0xf
    v_mov_b32_dpp v129, v221 row_newbcast:2 row_mask:0xf bank_mask:0xf
    v_mov_b32_dpp v130, v222 row_newbcast:2 row_mask:0xf bank_mask:0xf
    v_mov_b32_dpp v131, v223 row_newbcast:2 row_mask:0xf bank_mask:0xf
    ds_read_b64_tr_b16 v[84:85], v4 offset:53248
    ds_read_b64_tr_b16 v[86:87], v4 offset:54272
    s_waitcnt lgkmcnt(6)
    v_mfma_f32_32x32x16_bf16 v[16:31], v[128:131], v[88:91], v[16:31]
    v_mov_b32_dpp v132, v220 row_newbcast:3 row_mask:0xf bank_mask:0xf
    v_mov_b32_dpp v133, v221 row_newbcast:3 row_mask:0xf bank_mask:0xf
    v_mov_b32_dpp v134, v222 row_newbcast:3 row_mask:0xf bank_mask:0xf
    v_mov_b32_dpp v135, v223 row_newbcast:3 row_mask:0xf bank_mask:0xf
    ds_read_b64_tr_b16 v[88:89], v4 offset:57344
    ds_read_b64_tr_b16 v[90:91], v4 offset:58368
    s_waitcnt lgkmcnt(6)
    v_mfma_f32_32x32x16_bf16 v[16:31], v[132:135], v[92:95], v[16:31]
    v_mov_b32_dpp v128, v220 row_newbcast:4 row_mask:0xf bank_mask:0xf
    v_mov_b32_dpp v129, v221 row_newbcast:4 row_mask:0xf bank_mask:0xf
    v_mov_b32_dpp v130, v222 row_newbcast:4 row_mask:0xf bank_mask:0xf
    v_mov_b32_dpp v131, v223 row_newbcast:4 row_mask:0xf bank_mask:0xf
    ds_read_b64_tr_b16 v[92:93], v4 offset:61440
    ds_read_b64_tr_b16 v[94:95], v4 offset:62464
    s_waitcnt lgkmcnt(6)
    v_mfma_f32_32x32x16_bf16 v[16:31], v[128:131], v[80:83], v[16:31]
    v_mov_b32_dpp v132, v220 row_newbcast:5 row_mask:0xf bank_mask:0xf
    v_mov_b32_dpp v133, v221 row_newbcast:5 row_mask:0xf bank_mask:0xf
    v_mov_b32_dpp v134, v222 row_newbcast:5 row_mask:0xf bank_mask:0xf
    v_mov_b32_dpp v135, v223 row_newbcast:5 row_mask:0xf bank_mask:0xf
    v_add_u32 v4, 65536, v4
    ds_read_b64_tr_b16 v[80:81], v4 offset:0
    ds_read_b64_tr_b16 v[82:83], v4 offset:1024
    s_waitcnt lgkmcnt(6)
    v_mfma_f32_32x32x16_bf16 v[16:31], v[132:135], v[84:87], v[16:31]
    v_mov_b32_dpp v128, v220 row_newbcast:6 row_mask:0xf bank_mask:0xf
    v_mov_b32_dpp v129, v221 row_newbcast:6 row_mask:0xf bank_mask:0xf
    v_mov_b32_dpp v130, v222 row_newbcast:6 row_mask:0xf bank_mask:0xf
    v_mov_b32_dpp v131, v223 row_newbcast:6 row_mask:0xf bank_mask:0xf
    ds_read_b64_tr_b16 v[84:85], v4 offset:4096
    ds_read_b64_tr_b16 v[86:87], v4 offset:5120
    s_waitcnt lgkmcnt(6)
    v_mfma_f32_32x32x16_bf16 v[16:31], v[128:131], v[88:91], v[16:31]
    v_mov_b32_dpp v132, v220 row_newbcast:7 row_mask:0xf bank_mask:0xf
    v_mov_b32_dpp v133, v221 row_newbcast:7 row_mask:0xf bank_mask:0xf
    v_mov_b32_dpp v134, v222 row_newbcast:7 row_mask:0xf bank_mask:0xf
    v_mov_b32_dpp v135, v223 row_newbcast:7 row_mask:0xf bank_mask:0xf
    ds_read_b64_tr_b16 v[88:89], v4 offset:8192
    ds_read_b64_tr_b16 v[90:91], v4 offset:9216
    s_waitcnt lgkmcnt(6)
    v_mfma_f32_32x32x16_bf16 v[16:31], v[132:135], v[92:95], v[16:31]
    v_mov_b32_dpp v128, v220 row_newbcast:8 row_mask:0xf bank_mask:0xf
    v_mov_b32_dpp v129, v221 row_newbcast:8 row_mask:0xf bank_mask:0xf
    v_mov_b32_dpp v130, v222 row_newbcast:8 row_mask:0xf bank_mask:0xf
    v_mov_b32_dpp v131, v223 row_newbcast:8 row_mask:0xf bank_mask:0xf
    ds_read_b64_tr_b16 v[92:93], v4 offset:12288
    ds_read_b64_tr_b16 v[94:95], v4 offset:13312
    s_waitcnt lgkmcnt(6)
    s_barrier
    v_mfma_f32_32x32x16_bf16 v[16:31], v[128:131], v[80:83], v[16:31]
    v_mov_b32_dpp v132, v220 row_newbcast:9 row_mask:0xf bank_mask:0xf
    v_mov_b32_dpp v133, v221 row_newbcast:9 row_mask:0xf bank_mask:0xf
    v_mov_b32_dpp v134, v222 row_newbcast:9 row_mask:0xf bank_mask:0xf
    v_mov_b32_dpp v135, v223 row_newbcast:9 row_mask:0xf bank_mask:0xf
    ds_read_b64_tr_b16 v[80:81], v4 offset:16384
    ds_read_b64_tr_b16 v[82:83], v4 offset:17408
    s_waitcnt lgkmcnt(6)
    v_mfma_f32_32x32x16_bf16 v[16:31], v[132:135], v[84:87], v[16:31]
    v_mov_b32_dpp v128, v220 row_newbcast:10 row_mask:0xf bank_mask:0xf
    v_mov_b32_dpp v129, v221 row_newbcast:10 row_mask:0xf bank_mask:0xf
    v_mov_b32_dpp v130, v222 row_newbcast:10 row_mask:0xf bank_mask:0xf
    v_mov_b32_dpp v131, v223 row_newbcast:10 row_mask:0xf bank_mask:0xf
    ds_read_b64_tr_b16 v[84:85], v4 offset:20480
    ds_read_b64_tr_b16 v[86:87], v4 offset:21504
    s_waitcnt lgkmcnt(6)
    v_mfma_f32_32x32x16_bf16 v[16:31], v[128:131], v[88:91], v[16:31]
    v_mov_b32_dpp v132, v220 row_newbcast:11 row_mask:0xf bank_mask:0xf
    v_mov_b32_dpp v133, v221 row_newbcast:11 row_mask:0xf bank_mask:0xf
    v_mov_b32_dpp v134, v222 row_newbcast:11 row_mask:0xf bank_mask:0xf
    v_mov_b32_dpp v135, v223 row_newbcast:11 row_mask:0xf bank_mask:0xf
    ds_read_b64_tr_b16 v[88:89], v4 offset:24576
    ds_read_b64_tr_b16 v[90:91], v4 offset:25600
    s_waitcnt lgkmcnt(6)
    v_mfma_f32_32x32x16_bf16 v[16:31], v[132:135], v[92:95], v[16:31]
    v_mov_b32_dpp v128, v220 row_newbcast:12 row_mask:0xf bank_mask:0xf
    v_mov_b32_dpp v129, v221 row_newbcast:12 row_mask:0xf bank_mask:0xf
    v_mov_b32_dpp v130, v222 row_newbcast:12 row_mask:0xf bank_mask:0xf
    v_mov_b32_dpp v131, v223 row_newbcast:12 row_mask:0xf bank_mask:0xf
    ds_read_b64_tr_b16 v[92:93], v4 offset:28672
    ds_read_b64_tr_b16 v[94:95], v4 offset:29696
    s_waitcnt lgkmcnt(6)
    v_mfma_f32_32x32x16_bf16 v[16:31], v[128:131], v[80:83], v[16:31]
    v_mov_b32_dpp v132, v220 row_newbcast:13 row_mask:0xf bank_mask:0xf
    v_mov_b32_dpp v133, v221 row_newbcast:13 row_mask:0xf bank_mask:0xf
    v_mov_b32_dpp v134, v222 row_newbcast:13 row_mask:0xf bank_mask:0xf
    v_mov_b32_dpp v135, v223 row_newbcast:13 row_mask:0xf bank_mask:0xf
    ds_read_b64_tr_b16 v[80:81], v4 offset:32768
    ds_read_b64_tr_b16 v[82:83], v4 offset:33792
    s_waitcnt lgkmcnt(6)
    v_mfma_f32_32x32x16_bf16 v[16:31], v[132:135], v[84:87], v[16:31]
    v_mov_b32_dpp v128, v220 row_newbcast:14 row_mask:0xf bank_mask:0xf
    v_mov_b32_dpp v129, v221 row_newbcast:14 row_mask:0xf bank_mask:0xf
    v_mov_b32_dpp v130, v222 row_newbcast:14 row_mask:0xf bank_mask:0xf
    v_mov_b32_dpp v131, v223 row_newbcast:14 row_mask:0xf bank_mask:0xf
    ds_read_b64_tr_b16 v[84:85], v4 offset:36864
    ds_read_b64_tr_b16 v[86:87], v4 offset:37888
    s_waitcnt lgkmcnt(6)
    v_mfma_f32_32x32x16_bf16 v[16:31], v[128:131], v[88:91], v[16:31]
    v_mov_b32_dpp v132, v220 row_newbcast:15 row_mask:0xf bank_mask:0xf
    v_mov_b32_dpp v133, v221 row_newbcast:15 row_mask:0xf bank_mask:0xf
    v_mov_b32_dpp v134, v222 row_newbcast:15 row_mask:0xf bank_mask:0xf
    v_mov_b32_dpp v135, v223 row_newbcast:15 row_mask:0xf bank_mask:0xf
    ds_read_b64_tr_b16 v[88:89], v4 offset:40960
    ds_read_b64_tr_b16 v[90:91], v4 offset:41984
    s_waitcnt lgkmcnt(6)
    v_mfma_f32_32x32x16_bf16 v[16:31], v[132:135], v[92:95], v[16:31]
    v_mov_b32_dpp v128, v224 row_newbcast:0 row_mask:0xf bank_mask:0xf
    v_mov_b32_dpp v129, v225 row_newbcast:0 row_mask:0xf bank_mask:0xf
    v_mov_b32_dpp v130, v226 row_newbcast:0 row_mask:0xf bank_mask:0xf
    v_mov_b32_dpp v131, v227 row_newbcast:0 row_mask:0xf bank_mask:0xf
    ds_read_b64_tr_b16 v[92:93], v4 offset:45056
    ds_read_b64_tr_b16 v[94:95], v4 offset:46080
    s_waitcnt lgkmcnt(6)
    v_mfma_f32_32x32x16_bf16 v[16:31], v[128:131], v[80:83], v[16:31]
    v_mov_b32_dpp v132, v224 row_newbcast:1 row_mask:0xf bank_mask:0xf
    v_mov_b32_dpp v133, v225 row_newbcast:1 row_mask:0xf bank_mask:0xf
    v_mov_b32_dpp v134, v226 row_newbcast:1 row_mask:0xf bank_mask:0xf
    v_mov_b32_dpp v135, v227 row_newbcast:1 row_mask:0xf bank_mask:0xf
    ds_read_b64_tr_b16 v[80:81], v4 offset:49152
    ds_read_b64_tr_b16 v[82:83], v4 offset:50176
    s_waitcnt lgkmcnt(6)
    v_mfma_f32_32x32x16_bf16 v[16:31], v[132:135], v[84:87], v[16:31]
    v_mov_b32_dpp v128, v224 row_newbcast:2 row_mask:0xf bank_mask:0xf
    v_mov_b32_dpp v129, v225 row_newbcast:2 row_mask:0xf bank_mask:0xf
    v_mov_b32_dpp v130, v226 row_newbcast:2 row_mask:0xf bank_mask:0xf
    v_mov_b32_dpp v131, v227 row_newbcast:2 row_mask:0xf bank_mask:0xf
    ds_read_b64_tr_b16 v[84:85], v4 offset:53248
    ds_read_b64_tr_b16 v[86:87], v4 offset:54272
    s_waitcnt lgkmcnt(6)
    v_mfma_f32_32x32x16_bf16 v[16:31], v[128:131], v[88:91], v[16:31]
    v_mov_b32_dpp v132, v224 row_newbcast:3 row_mask:0xf bank_mask:0xf
    v_mov_b32_dpp v133, v225 row_newbcast:3 row_mask:0xf bank_mask:0xf
    v_mov_b32_dpp v134, v226 row_newbcast:3 row_mask:0xf bank_mask:0xf
    v_mov_b32_dpp v135, v227 row_newbcast:3 row_mask:0xf bank_mask:0xf
    ds_read_b64_tr_b16 v[88:89], v4 offset:57344
    ds_read_b64_tr_b16 v[90:91], v4 offset:58368
    s_waitcnt lgkmcnt(6)
    v_mfma_f32_32x32x16_bf16 v[16:31], v[132:135], v[92:95], v[16:31]
    v_mov_b32_dpp v128, v224 row_newbcast:4 row_mask:0xf bank_mask:0xf
    v_mov_b32_dpp v129, v225 row_newbcast:4 row_mask:0xf bank_mask:0xf
    v_mov_b32_dpp v130, v226 row_newbcast:4 row_mask:0xf bank_mask:0xf
    v_mov_b32_dpp v131, v227 row_newbcast:4 row_mask:0xf bank_mask:0xf
    ds_read_b64_tr_b16 v[92:93], v4 offset:61440
    ds_read_b64_tr_b16 v[94:95], v4 offset:62464
    s_waitcnt lgkmcnt(6)
    v_mfma_f32_32x32x16_bf16 v[16:31], v[128:131], v[80:83], v[16:31]
    v_mov_b32_dpp v132, v224 row_newbcast:5 row_mask:0xf bank_mask:0xf
    v_mov_b32_dpp v133, v225 row_newbcast:5 row_mask:0xf bank_mask:0xf
    v_mov_b32_dpp v134, v226 row_newbcast:5 row_mask:0xf bank_mask:0xf
    v_mov_b32_dpp v135, v227 row_newbcast:5 row_mask:0xf bank_mask:0xf
    s_nop 0
    s_waitcnt lgkmcnt(4)
    v_mfma_f32_32x32x16_bf16 v[16:31], v[132:135], v[84:87], v[16:31]
    v_mov_b32_dpp v128, v224 row_newbcast:6 row_mask:0xf bank_mask:0xf
    v_mov_b32_dpp v129, v225 row_newbcast:6 row_mask:0xf bank_mask:0xf
    v_mov_b32_dpp v130, v226 row_newbcast:6 row_mask:0xf bank_mask:0xf
    v_mov_b32_dpp v131, v227 row_newbcast:6 row_mask:0xf bank_mask:0xf
    s_nop 0
    s_waitcnt lgkmcnt(2)
    v_mfma_f32_32x32x16_bf16 v[16:31], v[128:131], v[88:91], v[16:31]
    v_mov_b32_dpp v132, v224 row_newbcast:7 row_mask:0xf bank_mask:0xf
    v_mov_b32_dpp v133, v225 row_newbcast:7 row_mask:0xf bank_mask:0xf
    v_mov_b32_dpp v134, v226 row_newbcast:7 row_mask:0xf bank_mask:0xf
    v_mov_b32_dpp v135, v227 row_newbcast:7 row_mask:0xf bank_mask:0xf
    s_nop 0
    s_waitcnt lgkmcnt(0)
    v_mfma_f32_32x32x16_bf16 v[16:31], v[132:135], v[92:95], v[16:31]
    s_nop 0
    s_lshl_b32 s54, s40, 7
    s_mov_b32 s59, 0xffffff00
    v_cmp_gt_u32 vcc, 32, v1
    s_nop 8
    v_cndmask_b32 v14, v24, v16, vcc
    v_add_u32 v14, 0x80, v14
    v_and_or_b32 v14, v14, s59, v127
    buffer_store_dword v14, v126, s[20:23], s54 offen sc0 sc1
    s_bfe_u32 s57, s48, 0x40001
    s_lshl_b32 s57, s57, 14
    s_and_b32 s60, s48, 1
    s_lshl_b32 s60, s60, 12
    s_add_u32 s57, s57, s60
    s_and_b32 s60, s48, 32
    s_lshl_b32 s60, s60, 8
    s_xor_b32 s60, s60, s99
    s_add_u32 s57, s57, s60
    s_add_u32 s57, s57, 29622272
    v_lshrrev_b32 v10, 5, v1
    v_and_b32 v13, 31, v1
    v_lshlrev_b32 v13, 3, v13
    v_lshl_add_u32 v13, v10, 11, v13
    buffer_load_dwordx2 v[160:161], v13, s[20:23], s57 offen offset:0 sc1
    buffer_load_dwordx2 v[162:163], v13, s[20:23], s57 offen offset:256 sc1
    buffer_load_dwordx2 v[164:165], v13, s[20:23], s57 offen offset:512 sc1
    buffer_load_dwordx2 v[166:167], v13, s[20:23], s57 offen offset:768 sc1
    buffer_load_dwordx2 v[168:169], v13, s[20:23], s57 offen offset:1024 sc1
    buffer_load_dwordx2 v[170:171], v13, s[20:23], s57 offen offset:1280 sc1
    buffer_load_dwordx2 v[172:173], v13, s[20:23], s57 offen offset:1536 sc1
    buffer_load_dwordx2 v[174:175], v13, s[20:23], s57 offen offset:1792 sc1
    s_waitcnt vmcnt(0)
    v_add_f32 v160, v160, v162
    v_add_f32 v161, v161, v163
    v_add_f32 v160, v160, v164
    v_add_f32 v161, v161, v165
    v_add_f32 v160, v160, v166
    v_add_f32 v161, v161, v167
    v_add_f32 v160, v160, v168
    v_add_f32 v161, v161, v169
    v_add_f32 v160, v160, v170
    v_add_f32 v161, v161, v171
    v_add_f32 v160, v160, v172
    v_add_f32 v161, v161, v173
    v_add_f32 v160, v160, v174
    v_add_f32 v161, v161, v175
    v_mov_b32 v162, v160
    v_mov_b32 v163, v161
    s_nop 0
    v_permlane32_swap_b32 v160, v162
    v_permlane32_swap_b32 v161, v163
    v_add_f32 v160, v160, v162
    v_add_f32 v161, v161, v163
    v_mul_f32 v2, 0x3acccccd, v160
    v_mul_f32 v161, 0x3acccccd, v161
    v_fma_f32 v161, -v2, v2, v161
    v_max_f32 v161, 0, v161
    v_add_f32 v161, 0x3727c5ac, v161
    v_sqrt_f32 v120, v161
    s_branch L_f1_done
L_tail_helper:
    s_bfe_u32 s41, s2, 0x20001
    s_lshl_b32 s41, s41, 2
    s_bfe_u32 s42, s2, 0x20003
    s_add_u32 s41, s41, s42
    s_lshl_b32 s41, s41, 1
    s_bfe_u32 s42, s2, 0x10005
    s_add_u32 s41, s41, s42
    s_lshr_b32 s42, s2, 6
    s_and_b32 s60, s2, 1
    s_lshl_b32 s60, s60, 2
    s_add_u32 s42, s42, s60
    s_and_b32 s43, s40, 1
    s_bfe_u32 s44, s40, 0x10001
    s_lshl_b32 s48, s41, 1
    s_add_u32 s48, s48, s43
    s_sub_u32 s6, s40, 4
    s_lshl_b32 s6, s6, 10
    v_lshlrev_b32 v12, 4, v1
    s_mul_i32 s5, s42, 102400
    s_add_u32 s5, s5, 23265280
    s_add_u32 s5, s5, s6
    s_mul_i32 s4, s42, 276480
    s_add_u32 s4, s4, 24084480
    s_add_u32 s4, s4, s6
    v_add_u32 v14, s6, v12
    v_add_u32 v15, 0x10000, v14
    v_add_u32 v16, 0x20000, v14
    s_mul_i32 s52, s42, 320
    s_bfe_u32 s41, s2, 0x20001
    s_lshl_b32 s41, s41, 2
    s_bfe_u32 s44, s2, 0x20003
    s_add_u32 s41, s41, s44
    s_and_b32 s42, s2, 1
    s_mul_i32 s42, s42, 7
    s_lshr_b32 s44, s2, 5
    s_and_b32 s43, s41, 7
    s_min_u32 s43, s43, 6
    s_cmp_eq_u32 s44, 7
    s_cselect_b32 s44, s43, s44
    s_add_u32 s42, s42, s44
    s_mov_b32 s43, 3456
    s_lshl_b32 s46, s42, 8
    s_mov_b32 s8, s32
    s_mov_b32 s9, s33
    s_mov_b32 s10, 2211840
    s_mov_b32 s11, 0x20000
    s_sub_u32 s50, s40, 4
    v_lshrrev_b32 v10, 4, v1
    s_lshl_b32 s61, s50, 4
    v_add_u32 v11, s61, v10
    v_mul_lo_u32 v11, v11, s43
    v_lshlrev_b32 v10, 2, v10
    v_xor_b32 v10, v10, v1
    v_and_b32 v10, 15, v10
    v_lshl_add_u32 v11, v10, 4, v11
    v_add_u32 v240, s46, v11
    s_lshl_b32 s50, s50, 12
    s_lshl_b32 s61, s43, 2
    s_sub_u32 s61, s61, 1024
    v_add_u32 v241, s61, v240
    v_add_u32 v242, s61, v241
    v_add_u32 v243, s61, v242
    s_lshl_b32 s51, s43, 6
    v_add_u32 v17, s50, v12
    v_add_u32 v18, 0x10000, v17
    s_setprio 2
    s_mul_i32 s60, s51, 2
    buffer_load_dwordx4 v[144:147], v240, s[8:11], s60 offen offset:0
    buffer_load_dwordx4 v[148:151], v241, s[8:11], s60 offen offset:1024
    buffer_load_dwordx4 v[152:155], v242, s[8:11], s60 offen offset:2048
    buffer_load_dwordx4 v[156:159], v243, s[8:11], s60 offen offset:3072
    s_mul_i32 s60, s51, 3
    buffer_load_dwordx4 v[160:163], v240, s[8:11], s60 offen offset:0
    buffer_load_dwordx4 v[164:167], v241, s[8:11], s60 offen offset:1024
    buffer_load_dwordx4 v[168:171], v242, s[8:11], s60 offen offset:2048
    buffer_load_dwordx4 v[172:175], v243, s[8:11], s60 offen offset:3072
    s_mul_i32 s60, s51, 4
    buffer_load_dwordx4 v[176:179], v240, s[8:11], s60 offen offset:0
    buffer_load_dwordx4 v[180:183], v241, s[8:11], s60 offen offset:1024
    buffer_load_dwordx4 v[184:187], v242, s[8:11], s60 offen offset:2048
    buffer_load_dwordx4 v[188:191], v243, s[8:11], s60 offen offset:3072
    s_mul_i32 s60, s51, 5
    buffer_load_dwordx4 v[192:195], v240, s[8:11], s60 offen offset:0
    buffer_load_dwordx4 v[196:199], v241, s[8:11], s60 offen offset:1024
    buffer_load_dwordx4 v[200:203], v242, s[8:11], s60 offen offset:2048
    buffer_load_dwordx4 v[204:207], v243, s[8:11], s60 offen offset:3072
    s_mul_i32 s60, s51, 6
    buffer_load_dwordx4 v[208:211], v240, s[8:11], s60 offen offset:0
    buffer_load_dwordx4 v[212:215], v241, s[8:11], s60 offen offset:1024
    buffer_load_dwordx4 v[216:219], v242, s[8:11], s60 offen offset:2048
    buffer_load_dwordx4 v[220:223], v243, s[8:11], s60 offen offset:3072
    s_setprio 0
    s_barrier
    s_mul_i32 s60, s51, 7
    buffer_load_dwordx4 v[224:227], v240, s[8:11], s60 offen offset:0
    buffer_load_dwordx4 v[228:231], v241, s[8:11], s60 offen offset:1024
    buffer_load_dwordx4 v[232:235], v242, s[8:11], s60 offen offset:2048
    buffer_load_dwordx4 v[236:239], v243, s[8:11], s60 offen offset:3072
    s_waitcnt vmcnt(24)
    s_barrier
    s_add_u32 m0, s6, 90112
    s_add_u32 s60, s5, 90112
    buffer_load_dwordx4 v12, s[20:23], s60 offen sc1 lds
    s_add_u32 m0, s6, 94208
    s_add_u32 s60, s5, 94208
    buffer_load_dwordx4 v12, s[20:23], s60 offen sc1 lds
    s_add_u32 m0, s6, 98304
    s_add_u32 s60, s5, 98304
    buffer_load_dwordx4 v12, s[20:23], s60 offen sc1 lds
    v_subrev_u32 v13, 256, v0
    v_min_u32 v13, 79, v13
    v_lshlrev_b32 v13, 2, v13
    s_add_u32 s53, s52, 5120
    buffer_load_dword v20, v13, s[20:23], s53 offen sc1
    s_add_u32 s53, s52, 20480
    buffer_load_dword v21, v13, s[20:23], s53 offen sc1
    s_add_u32 s53, s52, 35840
    buffer_load_dword v22, v13, s[20:23], s53 offen sc1
    s_add_u32 s53, s52, 51200
    buffer_load_dword v23, v13, s[20:23], s53 offen sc1
    s_add_u32 s53, s52, 10240
    buffer_load_dword v24, v13, s[20:23], s53 offen sc1
    s_add_u32 s53, s52, 25600
    buffer_load_dword v25, v13, s[20:23], s53 offen sc1
    s_add_u32 s53, s52, 40960
    buffer_load_dword v26, v13, s[20:23], s53 offen sc1
    s_add_u32 s53, s52, 56320
    buffer_load_dword v27, v13, s[20:23], s53 offen sc1
    s_add_u32 s53, s52, 12800
    buffer_load_dword v28, v13, s[20:23], s53 offen sc1
    s_add_u32 s53, s52, 28160
    buffer_load_dword v29, v13, s[20:23], s53 offen sc1
    s_add_u32 s53, s52, 43520
    buffer_load_dword v30, v13, s[20:23], s53 offen sc1
    s_add_u32 s53, s52, 58880
    buffer_load_dword v31, v13, s[20:23], s53 offen sc1
    s_add_u32 m0, s50, 131072
    s_mul_i32 s60, s51, 0
    buffer_load_dwordx4 v240, s[8:11], s60 offen offset:0 lds
    buffer_load_dwordx4 v241, s[8:11], s60 offen offset:1024 lds
    buffer_load_dwordx4 v242, s[8:11], s60 offen offset:2048 lds
    buffer_load_dwordx4 v243, s[8:11], s60 offen offset:3072 lds
    s_add_u32 m0, s50, 147456
    s_mul_i32 s60, s51, 1
    buffer_load_dwordx4 v240, s[8:11], s60 offen offset:0 lds
    buffer_load_dwordx4 v241, s[8:11], s60 offen offset:1024 lds
    buffer_load_dwordx4 v242, s[8:11], s60 offen offset:2048 lds
    buffer_load_dwordx4 v243, s[8:11], s60 offen offset:3072 lds
    s_add_u32 s60, s4, 163840
    buffer_load_dwordx4 v[32:35], v12, s[20:23], s60 offen sc1
    s_add_u32 s60, s4, 167936
    buffer_load_dwordx4 v[36:39], v12, s[20:23], s60 offen sc1
    s_add_u32 s60, s4, 172032
    buffer_load_dwordx4 v[40:43], v12, s[20:23], s60 offen sc1
    s_add_u32 s60, s4, 176128
    buffer_load_dwordx4 v[44:47], v12, s[20:23], s60 offen sc1
    s_add_u32 s60, s4, 180224
    buffer_load_dwordx4 v[48:51], v12, s[20:23], s60 offen sc1
    s_add_u32 s60, s4, 184320
    buffer_load_dwordx4 v[52:55], v12, s[20:23], s60 offen sc1
    s_add_u32 s60, s4, 188416
    buffer_load_dwordx4 v[56:59], v12, s[20:23], s60 offen sc1
    s_add_u32 s60, s4, 192512
    buffer_load_dwordx4 v[60:63], v12, s[20:23], s60 offen sc1
    s_add_u32 s60, s4, 196608
    buffer_load_dwordx4 v[64:67], v12, s[20:23], s60 offen sc1
    s_add_u32 s60, s4, 200704
    buffer_load_dwordx4 v[68:71], v12, s[20:23], s60 offen sc1
    s_waitcnt vmcnt(10)
    v_and_b32 v20, 0xffffff00, v20
    v_and_b32 v21, 0xffffff00, v21
    v_and_b32 v22, 0xffffff00, v22
    v_and_b32 v23, 0xffffff00, v23
    v_and_b32 v24, 0xffffff00, v24
    v_and_b32 v25, 0xffffff00, v25
    v_and_b32 v26, 0xffffff00, v26
    v_and_b32 v27, 0xffffff00, v27
    v_and_b32 v28, 0xffffff00, v28
    v_and_b32 v29, 0xffffff00, v29
    v_and_b32 v30, 0xffffff00, v30
    v_and_b32 v31, 0xffffff00, v31
    v_add_f32 v20, v20, v21
    v_add_f32 v22, v22, v23
    v_add_f32 v20, v20, v22
    v_cvt_pk_bf16_f32 v20, v20, v20
    v_and_b32 v20, 0xffff0000, v20
    v_add_f32 v24, v24, v25
    v_add_f32 v26, v26, v27
    v_add_f32 v24, v24, v26
    v_cvt_pk_bf16_f32 v24, v24, v24
    v_and_b32 v24, 0xffff0000, v24
    v_add_f32 v24, 1.0, v24
    v_cvt_pk_bf16_f32 v24, v24, v24
    v_and_b32 v24, 0xffff0000, v24
    v_add_f32 v28, v28, v29
    v_add_f32 v30, v30, v31
    v_add_f32 v28, v28, v30
    v_cvt_pk_bf16_f32 v28, v28, v28
    v_and_b32 v28, 0xffff0000, v28
    v_add_u32 v13, 126976, v13
    ds_write_b32 v13, v20 offset:0
    ds_write_b32 v13, v24 offset:320
    ds_write_b32 v13, v28 offset:640
    s_waitcnt lgkmcnt(0)
    s_barrier
    s_barrier
    s_add_u32 s60, s4, 204800
    buffer_load_dwordx4 v[72:75], v12, s[20:23], s60 offen sc1
    s_add_u32 s60, s4, 208896
    buffer_load_dwordx4 v[76:79], v12, s[20:23], s60 offen sc1
    s_add_u32 s60, s4, 212992
    buffer_load_dwordx4 v[80:83], v12, s[20:23], s60 offen sc1
    s_add_u32 s60, s4, 217088
    buffer_load_dwordx4 v[84:87], v12, s[20:23], s60 offen sc1
    s_add_u32 s60, s4, 221184
    buffer_load_dwordx4 v[88:91], v12, s[20:23], s60 offen sc1
    s_add_u32 s60, s4, 225280
    buffer_load_dwordx4 v[92:95], v12, s[20:23], s60 offen sc1
    s_add_u32 s60, s4, 229376
    buffer_load_dwordx4 v[96:99], v12, s[20:23], s60 offen sc1
    s_add_u32 s60, s4, 233472
    buffer_load_dwordx4 v[100:103], v12, s[20:23], s60 offen sc1
    s_add_u32 s60, s4, 237568
    buffer_load_dwordx4 v[104:107], v12, s[20:23], s60 offen sc1
    s_add_u32 s60, s4, 241664
    buffer_load_dwordx4 v[108:111], v12, s[20:23], s60 offen sc1
    s_add_u32 s60, s4, 245760
    buffer_load_dwordx4 v[112:115], v12, s[20:23], s60 offen sc1
    s_add_u32 s60, s4, 249856
    buffer_load_dwordx4 v[116:119], v12, s[20:23], s60 offen sc1
    s_add_u32 s60, s4, 253952
    buffer_load_dwordx4 v[120:123], v12, s[20:23], s60 offen sc1
    s_add_u32 s60, s4, 258048
    buffer_load_dwordx4 v[124:127], v12, s[20:23], s60 offen sc1
    s_add_u32 s60, s4, 262144
    buffer_load_dwordx4 v[128:131], v12, s[20:23], s60 offen sc1
    s_add_u32 s60, s4, 266240
    buffer_load_dwordx4 v[132:135], v12, s[20:23], s60 offen sc1
    s_add_u32 s60, s4, 270336
    buffer_load_dwordx4 v[136:139], v12, s[20:23], s60 offen sc1
    s_add_u32 s60, s4, 274432
    buffer_load_dwordx4 v[140:143], v12, s[20:23], s60 offen sc1
    s_waitcnt vmcnt(28)
    s_barrier
    ds_write_b128 v17, v[144:147] offset:0
    ds_write_b128 v17, v[148:151] offset:1024
    ds_write_b128 v17, v[152:155] offset:2048
    ds_write_b128 v17, v[156:159] offset:3072
    ds_write_b128 v17, v[160:163] offset:16384
    ds_write_b128 v17, v[164:167] offset:17408
    ds_write_b128 v17, v[168:171] offset:18432
    ds_write_b128 v17, v[172:175] offset:19456
    ds_write_b128 v17, v[176:179] offset:32768
    ds_write_b128 v17, v[180:183] offset:33792
    ds_write_b128 v17, v[184:187] offset:34816
    ds_write_b128 v17, v[188:191] offset:35840
    ds_write_b128 v17, v[192:195] offset:49152
    ds_write_b128 v17, v[196:199] offset:50176
    ds_write_b128 v17, v[200:203] offset:51200
    ds_write_b128 v17, v[204:207] offset:52224
    ds_write_b128 v18, v[208:211] offset:0
    ds_write_b128 v18, v[212:215] offset:1024
    ds_write_b128 v18, v[216:219] offset:2048
    ds_write_b128 v18, v[220:223] offset:3072
    ds_write_b128 v18, v[224:227] offset:16384
    ds_write_b128 v18, v[228:231] offset:17408
    ds_write_b128 v18, v[232:235] offset:18432
    ds_write_b128 v18, v[236:239] offset:19456
    s_barrier
    s_add_u32 m0, s50, 98304
    s_mul_i32 s60, s51, 8
    buffer_load_dwordx4 v240, s[8:11], s60 offen offset:0 lds
    buffer_load_dwordx4 v241, s[8:11], s60 offen offset:1024 lds
    buffer_load_dwordx4 v242, s[8:11], s60 offen offset:2048 lds
    buffer_load_dwordx4 v243, s[8:11], s60 offen offset:3072 lds
    s_cmp_lt_u32 s2, 224
    s_cbranch_scc0 L_h_no9
    s_add_u32 m0, s50, 114688
    s_mul_i32 s60, s51, 9
    buffer_load_dwordx4 v240, s[8:11], s60 offen offset:0 lds
    buffer_load_dwordx4 v241, s[8:11], s60 offen offset:1024 lds
    buffer_load_dwordx4 v242, s[8:11], s60 offen offset:2048 lds
    buffer_load_dwordx4 v243, s[8:11], s60 offen offset:3072 lds
L_h_no9:
    s_waitcnt lgkmcnt(0)
    s_barrier
    s_lshl_b32 s52, s41, 2
    s_add_u32 s52, s52, s40
    s_sub_u32 s52, s52, 4
    s_bfe_u32 s57, s52, 0x40001
    s_lshl_b32 s57, s57, 14
    s_and_b32 s60, s52, 1
    s_lshl_b32 s60, s60, 12
    s_add_u32 s57, s57, s60
    s_and_b32 s60, s52, 32
    s_lshl_b32 s60, s60, 8
    s_xor_b32 s60, s60, s99
    s_add_u32 s57, s57, s60
    s_add_u32 s57, s57, 29622272
    v_lshrrev_b32 v10, 5, v1
    v_and_b32 v13, 31, v1
    v_lshlrev_b32 v13, 3, v13
    v_lshl_add_u32 v13, v10, 11, v13
    s_and_b32 s58, s41, 8
    s_lshl_b32 s58, s58, 10
    s_xor_b32 s58, s58, s99
    s_lshl_b32 s59, s42, 9
    s_add_u32 s58, s58, s59
    s_add_u32 s58, s58, 29917184
    v_lshrrev_b32 v10, 5, v1
    v_lshl_add_u32 v10, v10, 14, s58
    v_and_b32 v11, 31, v1
    v_lshl_add_u32 v180, v11, 2, v10
    v_and_b32 v11, 3, v1
    v_lshlrev_b32 v11, 3, v11
    v_bfe_u32 v181, s3, v11, 8
    s_lshr_b32 s53, s6, 3
    s_barrier
    s_cmp_lt_u32 s2, 224
    s_cbranch_scc1 L_h_had9
    s_add_u32 m0, s50, 114688
    s_mul_i32 s60, s51, 9
    buffer_load_dwordx4 v240, s[8:11], s60 offen offset:0 lds
    buffer_load_dwordx4 v241, s[8:11], s60 offen offset:1024 lds
    buffer_load_dwordx4 v242, s[8:11], s60 offen offset:2048 lds
    buffer_load_dwordx4 v243, s[8:11], s60 offen offset:3072 lds
    s_branch L_st_skip
L_h_had9:
    buffer_load_dwordx2 v[160:161], v13, s[20:23], s57 offen offset:0 sc1
    buffer_load_dwordx2 v[162:163], v13, s[20:23], s57 offen offset:256 sc1
    buffer_load_dwordx2 v[164:165], v13, s[20:23], s57 offen offset:512 sc1
    buffer_load_dwordx2 v[166:167], v13, s[20:23], s57 offen offset:768 sc1
    buffer_load_dwordx2 v[168:169], v13, s[20:23], s57 offen offset:1024 sc1
    buffer_load_dwordx2 v[170:171], v13, s[20:23], s57 offen offset:1280 sc1
    buffer_load_dwordx2 v[172:173], v13, s[20:23], s57 offen offset:1536 sc1
    buffer_load_dwordx2 v[174:175], v13, s[20:23], s57 offen offset:1792 sc1
    s_lshr_b32 s52, s6, 1
    s_add_u32 s52, s52, 131072
    v_lshl_add_u32 v182, v1, 3, s52
    s_lshr_b32 s52, s6, 2
    s_add_u32 s52, s52, 133120
    v_lshl_add_u32 v183, v1, 2, s52
    s_lshr_b32 s52, s6, 7
    s_add_u32 s52, s52, 134144
    v_lshl_add_u32 v184, v1, 5, s52
    s_waitcnt vmcnt(0)
    v_add_f32 v160, v160, v162
    v_add_f32 v161, v161, v163
    v_add_f32 v160, v160, v164
    v_add_f32 v161, v161, v165
    v_add_f32 v160, v160, v166
    v_add_f32 v161, v161, v167
    v_add_f32 v160, v160, v168
    v_add_f32 v161, v161, v169
    v_add_f32 v160, v160, v170
    v_add_f32 v161, v161, v171
    v_add_f32 v160, v160, v172
    v_add_f32 v161, v161, v173
    v_add_f32 v160, v160, v174
    v_add_f32 v161, v161, v175
    v_mov_b32 v162, v160
    v_mov_b32 v163, v161
    s_nop 0
    v_permlane32_swap_b32 v160, v162
    v_permlane32_swap_b32 v161, v163
    v_add_f32 v160, v160, v162
    v_add_f32 v161, v161, v163
    v_mul_f32 v2, 0x3acccccd, v160
    v_mul_f32 v161, 0x3acccccd, v161
    v_fma_f32 v161, -v2, v2, v161
    v_max_f32 v161, 0, v161
    v_add_f32 v161, 0x3727c5ac, v161
    v_sqrt_f32 v178, v161
    v_cmp_gt_u32 vcc, 32, v1
    v_sub_f32 v2, 0, v2
    s_nop 0
    v_cndmask_b32 v2, v178, v2, vcc
    v_cvt_pk_bf16_f32 v3, v2, v2
    v_and_b32 v10, 0xffff0000, v3
    v_sub_f32 v10, v2, v10
    v_cvt_pk_bf16_f32 v10, v10, 0
    v_and_b32 v177, 0xffff, v3
    v_lshl_or_b32 v176, v10, 16, v177
    ds_write_b64 v182, v[176:177]
    ds_write_b32 v183, v178
L_st_skip:
    s_waitcnt lgkmcnt(0)
    s_mov_b32 s62, 0
    s_cmp_lt_u32 s2, 224
    s_cbranch_scc0 L_ub_skip
    buffer_load_dword v160, v180, s[20:23], s53 offen sc1
    s_waitcnt vmcnt(0)
L_ub_spin:
    v_xor_b32 v160, v181, v160
    v_and_b32 v10, 0xff, v160
    v_cmp_ne_u32 vcc, 0, v10
    s_cmp_gt_u32 s62, 400000
    s_cbranch_scc1 L_ub_ok
    s_cbranch_vccz L_ub_ok
    s_sleep 4
    buffer_load_dword v160, v180, s[20:23], s53 offen sc1
    s_add_u32 s62, s62, 1
    s_waitcnt vmcnt(0)
    s_branch L_ub_spin
L_ub_ok:
    v_cvt_pk_bf16_f32 v162, v160, v160
    v_and_b32 v163, 0xffff0000, v162
    v_sub_f32 v163, v160, v163
    v_cvt_pk_bf16_f32 v163, v163, 0
    ds_write_b64 v184, v[162:163]
    s_waitcnt lgkmcnt(0)
L_ub_skip:
    s_waitcnt vmcnt(0)
    s_barrier
    s_add_u32 m0, s6, 143360
    s_add_u32 s60, s4, 0
    buffer_load_dwordx4 v12, s[20:23], s60 offen sc1 lds
    s_waitcnt vmcnt(8)
    s_add_u32 m0, s6, 147456
    s_add_u32 s60, s4, 4096
    buffer_load_dwordx4 v12, s[20:23], s60 offen sc1 lds
    s_waitcnt vmcnt(8)
    s_add_u32 m0, s6, 151552
    s_add_u32 s60, s4, 8192
    buffer_load_dwordx4 v12, s[20:23], s60 offen sc1 lds
    s_waitcnt vmcnt(8)
    s_add_u32 m0, s6, 155648
    s_add_u32 s60, s4, 12288
    buffer_load_dwordx4 v12, s[20:23], s60 offen sc1 lds
    s_waitcnt vmcnt(8)
    s_add_u32 m0, s6, 159744
    s_add_u32 s60, s4, 16384
    buffer_load_dwordx4 v12, s[20:23], s60 offen sc1 lds
    s_waitcnt vmcnt(8)
    s_add_u32 m0, s6, 0
    s_add_u32 s60, s4, 20480
    buffer_load_dwordx4 v12, s[20:23], s60 offen sc1 lds
    s_waitcnt vmcnt(8)
    s_add_u32 m0, s6, 4096
    s_add_u32 s60, s4, 24576
    buffer_load_dwordx4 v12, s[20:23], s60 offen sc1 lds
    s_waitcnt vmcnt(8)
    s_add_u32 m0, s6, 8192
    s_add_u32 s60, s4, 28672
    buffer_load_dwordx4 v12, s[20:23], s60 offen sc1 lds
    s_waitcnt vmcnt(8)
    s_add_u32 m0, s6, 12288
    s_add_u32 s60, s4, 32768
    buffer_load_dwordx4 v12, s[20:23], s60 offen sc1 lds
    s_waitcnt vmcnt(8)
    s_add_u32 m0, s6, 16384
    s_add_u32 s60, s4, 36864
    buffer_load_dwordx4 v12, s[20:23], s60 offen sc1 lds
    s_waitcnt vmcnt(8)
    s_add_u32 m0, s6, 20480
    s_add_u32 s60, s4, 40960
    buffer_load_dwordx4 v12, s[20:23], s60 offen sc1 lds
    s_waitcnt vmcnt(8)
    s_add_u32 m0, s6, 24576
    s_add_u32 s60, s4, 45056
    buffer_load_dwordx4 v12, s[20:23], s60 offen sc1 lds
    s_waitcnt vmcnt(8)
    s_add_u32 m0, s6, 28672
    s_add_u32 s60, s4, 49152
    buffer_load_dwordx4 v12, s[20:23], s60 offen sc1 lds
    s_waitcnt vmcnt(8)
    s_add_u32 m0, s6, 32768
    s_add_u32 s60, s4, 53248
    buffer_load_dwordx4 v12, s[20:23], s60 offen sc1 lds
    s_waitcnt vmcnt(8)
    s_add_u32 m0, s6, 36864
    s_add_u32 s60, s4, 57344
    buffer_load_dwordx4 v12, s[20:23], s60 offen sc1 lds
    s_waitcnt vmcnt(8)
    s_add_u32 m0, s6, 40960
    s_add_u32 s60, s4, 61440
    buffer_load_dwordx4 v12, s[20:23], s60 offen sc1 lds
    s_waitcnt vmcnt(8)
    s_add_u32 m0, s6, 45056
    s_add_u32 s60, s4, 65536
    buffer_load_dwordx4 v12, s[20:23], s60 offen sc1 lds
    s_waitcnt vmcnt(8)
    s_add_u32 m0, s6, 49152
    s_add_u32 s60, s4, 69632
    buffer_load_dwordx4 v12, s[20:23], s60 offen sc1 lds
    s_waitcnt vmcnt(8)
    s_add_u32 m0, s6, 53248
    s_add_u32 s60, s4, 73728
    buffer_load_dwordx4 v12, s[20:23], s60 offen sc1 lds
    s_waitcnt vmcnt(8)
    s_add_u32 m0, s6, 57344
    s_add_u32 s60, s4, 77824
    buffer_load_dwordx4 v12, s[20:23], s60 offen sc1 lds
    s_waitcnt vmcnt(8)
    s_add_u32 m0, s6, 61440
    s_add_u32 s60, s4, 81920
    buffer_load_dwordx4 v12, s[20:23], s60 offen sc1 lds
    s_waitcnt vmcnt(8)
    s_waitcnt vmcnt(0)
    s_barrier
    s_add_u32 m0, s6, 65536
    s_add_u32 s60, s4, 86016
    buffer_load_dwordx4 v12, s[20:23], s60 offen sc1 lds
    s_waitcnt vmcnt(8)
    s_add_u32 m0, s6, 69632
    s_add_u32 s60, s4, 90112
    buffer_load_dwordx4 v12, s[20:23], s60 offen sc1 lds
    s_waitcnt vmcnt(8)
    s_add_u32 m0, s6, 73728
    s_add_u32 s60, s4, 94208
    buffer_load_dwordx4 v12, s[20:23], s60 offen sc1 lds
    s_waitcnt vmcnt(8)
    s_add_u32 m0, s6, 77824
    s_add_u32 s60, s4, 98304
    buffer_load_dwordx4 v12, s[20:23], s60 offen sc1 lds
    s_waitcnt vmcnt(8)
    s_add_u32 m0, s6, 81920
    s_add_u32 s60, s4, 102400
    buffer_load_dwordx4 v12, s[20:23], s60 offen sc1 lds
    s_waitcnt vmcnt(8)
    s_add_u32 m0, s6, 86016
    s_add_u32 s60, s4, 106496
    buffer_load_dwordx4 v12, s[20:23], s60 offen sc1 lds
    s_waitcnt vmcnt(8)
    s_add_u32 m0, s6, 90112
    s_add_u32 s60, s4, 110592
    buffer_load_dwordx4 v12, s[20:23], s60 offen sc1 lds
    s_waitcnt vmcnt(8)
    s_add_u32 m0, s6, 94208
    s_add_u32 s60, s4, 114688
    buffer_load_dwordx4 v12, s[20:23], s60 offen sc1 lds
    s_waitcnt vmcnt(8)
    s_add_u32 m0, s6, 98304
    s_add_u32 s60, s4, 118784
    buffer_load_dwordx4 v12, s[20:23], s60 offen sc1 lds
    s_waitcnt vmcnt(8)
    s_add_u32 m0, s6, 102400
    s_add_u32 s60, s4, 122880
    buffer_load_dwordx4 v12, s[20:23], s60 offen sc1 lds
    s_waitcnt vmcnt(8)
    s_add_u32 m0, s6, 106496
    s_add_u32 s60, s4, 126976
    buffer_load_dwordx4 v12, s[20:23], s60 offen sc1 lds
    s_waitcnt vmcnt(8)
    s_add_u32 m0, s6, 110592
    s_add_u32 s60, s4, 131072
    buffer_load_dwordx4 v12, s[20:23], s60 offen sc1 lds
    s_waitcnt vmcnt(8)
    s_add_u32 m0, s6, 114688
    s_add_u32 s60, s4, 135168
    buffer_load_dwordx4 v12, s[20:23], s60 offen sc1 lds
    s_waitcnt vmcnt(8)
    s_add_u32 m0, s6, 118784
    s_add_u32 s60, s4, 139264
    buffer_load_dwordx4 v12, s[20:23], s60 offen sc1 lds
    s_waitcnt vmcnt(8)
    s_add_u32 m0, s6, 122880
    s_add_u32 s60, s4, 143360
    buffer_load_dwordx4 v12, s[20:23], s60 offen sc1 lds
    s_waitcnt vmcnt(8)
    s_add_u32 m0, s6, 126976
    s_add_u32 s60, s4, 147456
    buffer_load_dwordx4 v12, s[20:23], s60 offen sc1 lds
    s_waitcnt vmcnt(8)
    s_add_u32 m0, s6, 131072
    s_add_u32 s60, s4, 151552
    buffer_load_dwordx4 v12, s[20:23], s60 offen sc1 lds
    s_waitcnt vmcnt(8)
    s_add_u32 m0, s6, 135168
    s_add_u32 s60, s4, 155648
    buffer_load_dwordx4 v12, s[20:23], s60 offen sc1 lds
    s_waitcnt vmcnt(8)
    s_add_u32 m0, s6, 139264
    s_add_u32 s60, s4, 159744
    buffer_load_dwordx4 v12, s[20:23], s60 offen sc1 lds
    s_waitcnt vmcnt(8)
    s_barrier
    s_waitcnt vmcnt(8)
    s_barrier
    ds_write_b128 v16, v[32:35] offset:12288
    ds_write_b128 v16, v[36:39] offset:16384
    ds_write_b128 v16, v[40:43] offset:20480
    ds_write_b128 v16, v[44:47] offset:24576
    ds_write_b128 v16, v[48:51] offset:28672
    ds_write_b128 v14, v[52:55] offset:0
    ds_write_b128 v14, v[56:59] offset:4096
    ds_write_b128 v14, v[60:63] offset:8192
    ds_write_b128 v14, v[64:67] offset:12288
    ds_write_b128 v14, v[68:71] offset:16384
    ds_write_b128 v14, v[72:75] offset:20480
    ds_write_b128 v14, v[76:79] offset:24576
    ds_write_b128 v14, v[80:83] offset:28672
    ds_write_b128 v14, v[84:87] offset:32768
    ds_write_b128 v14, v[88:91] offset:36864
    s_waitcnt lgkmcnt(0)
    s_waitcnt vmcnt(0)
    s_barrier
    ds_write_b128 v14, v[92:95] offset:40960
    ds_write_b128 v14, v[96:99] offset:45056
    ds_write_b128 v14, v[100:103] offset:49152
    ds_write_b128 v14, v[104:107] offset:53248
    ds_write_b128 v14, v[108:111] offset:57344
    ds_write_b128 v14, v[112:115] offset:61440
    ds_write_b128 v15, v[116:119] offset:0
    ds_write_b128 v15, v[120:123] offset:4096
    ds_write_b128 v15, v[124:127] offset:8192
    ds_write_b128 v15, v[128:131] offset:12288
    ds_write_b128 v15, v[132:135] offset:16384
    ds_write_b128 v15, v[136:139] offset:20480
    ds_write_b128 v15, v[140:143] offset:24576
    s_waitcnt lgkmcnt(0)
    s_barrier
    s_barrier
    s_endpgm
L_tail_end:
L_att_fallback:
    v_mov_b32 v15, 0xff800000
    s_mov_b32 s49, 4276224
L_att_fb1:
    buffer_load_dwordx4 v[168:171], v4, s[20:23], s49 offen sc1
    buffer_load_dwordx2 v[172:173], v5, s[20:23], s49 offen sc1
    s_waitcnt vmcnt(0)
    v_mfma_f32_32x32x8_bf16 v[128:143], v[172:173], v[166:167], 0
    v_mfma_f32_32x32x16_bf16 v[128:143], v[168:171], v[156:159], v[128:143]
    s_nop 11
    v_max3_f32 v15, v15, v128, v129
    v_max3_f32 v15, v15, v130, v131
    v_max3_f32 v15, v15, v132, v133
    v_max3_f32 v15, v15, v134, v135
    v_max3_f32 v15, v15, v136, v137
    v_max3_f32 v15, v15, v138, v139
    v_max3_f32 v15, v15, v140, v141
    v_max3_f32 v15, v15, v142, v143
    s_xor_b32 s49, s49, 8192
    s_bitcmp0_b32 s49, 13
    s_cselect_b32 s48, 262144, 0
    s_add_u32 s49, s49, s48
    s_cmp_lt_u32 s49, 12582912
    s_cbranch_scc1 L_att_fb1
    v_mov_b32 v13, v15
    s_mov_b32 s49, 4276224
    s_nop 0
    v_permlane32_swap_b32 v13, v15
    v_max_f32 v15, v13, v15
    v_mov_b64 v[64:65], 0
    v_mov_b64 v[66:67], 0
    v_mov_b64 v[68:69], 0
    v_mov_b64 v[70:71], 0
    v_mov_b64 v[72:73], 0
    v_mov_b64 v[74:75], 0
    v_mov_b64 v[76:77], 0
    v_mov_b64 v[78:79], 0
L_att_fb2:
    buffer_load_dwordx4 v[168:171], v4, s[20:23], s49 offen sc1
    buffer_load_dwordx2 v[172:173], v5, s[20:23], s49 offen sc1
    buffer_load_dwordx4 v[174:177], v6, s[20:23], s49 offen sc1
    buffer_load_dwordx4 v[178:181], v7, s[20:23], s49 offen sc1
    s_waitcnt vmcnt(0)
    v_mfma_f32_32x32x8_bf16 v[128:143], v[172:173], v[166:167], 0
    v_mfma_f32_32x32x16_bf16 v[128:143], v[168:171], v[156:159], v[128:143]
    s_nop 11
    v_sub_f32 v128, v128, v15
    v_sub_f32 v129, v129, v15
    v_sub_f32 v130, v130, v15
    v_sub_f32 v131, v131, v15
    v_sub_f32 v132, v132, v15
    v_sub_f32 v133, v133, v15
    v_sub_f32 v134, v134, v15
    v_sub_f32 v135, v135, v15
    v_sub_f32 v136, v136, v15
    v_sub_f32 v137, v137, v15
    v_sub_f32 v138, v138, v15
    v_sub_f32 v139, v139, v15
    v_sub_f32 v140, v140, v15
    v_sub_f32 v141, v141, v15
    v_sub_f32 v142, v142, v15
    v_sub_f32 v143, v143, v15
    v_exp_f32 v128, v128
    v_exp_f32 v129, v129
    v_exp_f32 v130, v130
    v_exp_f32 v131, v131
    v_exp_f32 v132, v132
    v_exp_f32 v133, v133
    v_exp_f32 v134, v134
    v_exp_f32 v135, v135
    v_exp_f32 v136, v136
    v_exp_f32 v137, v137
    v_exp_f32 v138, v138
    v_exp_f32 v139, v139
    v_exp_f32 v140, v140
    v_exp_f32 v141, v141
    v_exp_f32 v142, v142
    v_exp_f32 v143, v143
    s_nop 1
    v_smfmac_f32_32x32x32_bf16 v[64:79], v[174:177], v[128:135], v8
    v_smfmac_f32_32x32x32_bf16 v[64:79], v[178:181], v[136:143], v8
    s_xor_b32 s49, s49, 8192
    s_bitcmp0_b32 s49, 13
    s_cselect_b32 s48, 262144, 0
    s_add_u32 s49, s49, s48
    s_cmp_lt_u32 s49, 12582912
    s_cbranch_scc1 L_att_fb2
    s_nop 8
    v_mov_b32 v13, v72
    v_mov_b32 v14, v72
    s_nop 1
    v_permlane32_swap_b32 v13, v14
    s_cmp_eq_u32 s43, 0
    s_cbranch_scc1 L_att_norm0
    s_branch L_att_norm1
L_code_end:
.section .rodata,"a"
.p2align 6
.amdhsa_kernel adaLN_cond__mha_block__dense_activation_relu__prompt_kernel
  .amdhsa_next_free_vgpr 252
  .amdhsa_next_free_sgpr 102
  .amdhsa_accum_offset 252
  .amdhsa_group_segment_fixed_size 0
  .amdhsa_kernarg_size 88
  .amdhsa_user_sgpr_count 2
  .amdhsa_user_sgpr_kernarg_segment_ptr 1
  .amdhsa_system_sgpr_workgroup_id_x 1
.end_amdhsa_kernel
```
